```python
import torch

def _softmax(x, axis=-1):
    return torch.softmax(x, dim=axis)
def _gelu(x):
    return torch.nn.functional.gelu(x, approximate="tanh")
def _silu(x):
    return torch.nn.functional.silu(x)
def _sigmoid(x):
    return torch.sigmoid(x)
def _layernorm(x, axis=-1, eps=1e-5):
    m = x.mean(dim=axis, keepdim=True)
    v = x.var(dim=axis, keepdim=True, unbiased=False)
    return (x - m) / torch.sqrt(v + eps)
def _scatter_add(tgt, idx, src, axis=0):
    return tgt.clone().index_add_(axis, idx, src)
def _segment_sum(src, seg, n):
    out = torch.zeros((n,) + src.shape[1:], dtype=src.dtype)
    return out.index_add_(0, seg, src)
def _pad(x, pw):
    flat = tuple(v for pair in reversed(pw) for v in pair)
    return torch.nn.functional.pad(x, flat)

kernel_name = 'parallel_sum__linear_kernel_hedgehog__glu_gated_swiglu__prompt'

def setup_inputs():

    _w = (lambda a: (lambda t: t.to(torch.bfloat16) if t.is_floating_point() else t)(torch.as_tensor(a)))
    def _A_setup():
        B, S, D, H = 1, 2048, 640, 32
        Dh = D // H
        return {
            "x": _w((lambda *s: torch.randn(*s, dtype=torch.bfloat16) * 0.05)(B, S, D)),
            "wqkv": _w((lambda *s: torch.randn(*s, dtype=torch.bfloat16) * 0.2)(D, 3 * D)),
            "w_phi": _w((lambda *s: torch.randn(*s, dtype=torch.bfloat16) * 0.2)(H, Dh, Dh) * (Dh ** -0.5)),
            "wo": _w((lambda *s: torch.randn(*s, dtype=torch.bfloat16) * 0.05)(D, D)),
        }
    _A_in = _A_setup()

    def _B_setup():
        B, S, D, F = 1, 2048, 640, 1536
        return {
            "x": _w((lambda *s: torch.randn(*s, dtype=torch.bfloat16) * 0.05)(B, S, D)),
            "w1": _w((lambda *s: torch.randn(*s, dtype=torch.bfloat16) * 0.4)(D, F) * (2.0 / D) ** 0.5),
            "w3": _w((lambda *s: torch.randn(*s, dtype=torch.bfloat16) * 0.4)(D, F) * (2.0 / D) ** 0.5),
            "w2": _w((lambda *s: torch.randn(*s, dtype=torch.bfloat16) * 0.4)(F, D) * (2.0 / F) ** 0.5),
        }
    _B_in = _B_setup()

    return {
        "A_x": _A_in["x"],
        "A_wqkv": _A_in["wqkv"],
        "A_w_phi": _A_in["w_phi"],
        "A_wo": _A_in["wo"],
        "B_x": _B_in["x"],
        "B_w1": _B_in["w1"],
        "B_w3": _B_in["w3"],
        "B_w2": _B_in["w2"],
    }

def reference(A_x, A_wqkv, A_w_phi, A_wo, B_x, B_w1, B_w3, B_w2):
    def _A_ref(x, wqkv, w_phi, wo):
        B, S, D = x.shape
        H = 32; Dh = D // H
        qkv = (lambda x, *d: x.permute(*d))((x @ wqkv).reshape(B, S, 3, H, Dh), 2, 0, 3, 1, 4)
        q, k, v = qkv[0], qkv[1], qkv[2]
        pq = torch.einsum("bhsd,hdf->bhsf", q, w_phi)
        pk = torch.einsum("bhsd,hdf->bhsf", k, w_phi)
        phi_q = torch.concatenate([_softmax(pq, axis=-1), _softmax(-pq, axis=-1)], axis=-1)
        phi_k = torch.concatenate([_softmax(pk, axis=-1), _softmax(-pk, axis=-1)], axis=-1)
        kv = torch.einsum("bhsf,bhsd->bhfd", phi_k, v)
        z  = torch.einsum("bhsf->bhf", phi_k)
        num = torch.einsum("bhqf,bhfd->bhqd", phi_q, kv)
        den = torch.einsum("bhqf,bhf->bhq", phi_q, z)[..., None] + 1e-6
        o = num / den
        return (lambda x, *d: x.permute(*d))(o, 0, 2, 1, 3).reshape(B, S, D) @ wo

    def _B_ref(x, w1, w3, w2):
        gate = torch.einsum("bsd,df->bsf", x, w1)
        up = torch.einsum("bsd,df->bsf", x, w3)
        h = _silu(gate) * up
        out = torch.einsum("bsf,fd->bsd", h, w2)
        return out

    x = A_x
    xn = _layernorm(x, axis=-1)
    return x + _A_ref(xn, A_wqkv, A_w_phi, A_wo) + _B_ref(xn, B_w1, B_w3, B_w2)
```

```asm
; @launch grid=(256,1,1) block=(256,1,1) lds=160256
.amdgcn_target "amdgcn-amd-amdhsa--gfx950"
.text
.globl parallel_sum__linear_kernel_hedgehog__glu_gated_swiglu__prompt_kernel
.p2align 8
.type parallel_sum__linear_kernel_hedgehog__glu_gated_swiglu__prompt_kernel,@function
parallel_sum__linear_kernel_hedgehog__glu_gated_swiglu__prompt_kernel:
    s_cmp_ge_u32 s2, 256
    s_cbranch_scc1 M_end
    s_load_dwordx8 s[4:11], s[0:1], 0
    s_load_dwordx4 s[12:15], s[0:1], 40
    s_load_dwordx4 s[16:19], s[0:1], 56
    s_load_dwordx2 s[20:21], s[0:1], 80
    v_lshrrev_b32 v1, 6, v0
    s_and_b32 s56, s2, 7
    s_lshr_b32 s57, s2, 3
    v_readfirstlane_b32 s64, v1
    s_getpc_b64 s[98:99]
M_pc:
    s_mul_i32 s82, s57, 14
    v_min_u32 v228, 13, v0
    v_add_u32 v228, s82, v228
    v_lshlrev_b32 v228, 7, v228
    v_min_u32 v228, M_tblend-M_pc-4, v228
    global_load_dword a223, v228, s[98:99]
    s_and_b32 s58, s56, 1
    s_lshr_b32 s59, s56, 1
    s_lshr_b32 s65, s57, 2
    s_and_b32 s66, s57, 3
    s_lshl3_add_u32 s60, s58, s65
    s_lshl2_add_u32 s61, s59, s66
    s_lshl3_add_u32 s62, s59, s65
    s_lshl2_add_u32 s63, s58, s66
    v_and_b32 v1, 63, v0
    s_add_u32 s69, s65, s66
    s_and_b32 s69, s69, 3
    s_lshl_b32 s69, s69, 2
    s_or_b32 s55, s69, 0x40000
    s_bfe_u32 s70, 1, s55
    v_lshlrev_b32 v2, 4, v1
    v_lshrrev_b32 v232, 3, v1
    v_and_b32 v233, 7, v1
    v_lshrrev_b32 v230, 4, v1
    v_xor_b32 v231, v233, v230
    v_mul_u32_u24 v4, 1280, v232
    v_lshl_add_u32 v4, v231, 4, v4
    v_xor_b32 v5, 64, v4
    v_add_u32 v6, 18432, v4
    v_add_u32 v7, 27648, v5
    v_add_u32 v5, 9216, v5
    v_and_b32 v230, 1, v230
    v_lshlrev_b32 v230, 2, v230
    v_xor_b32 v233, v233, v230
    v_mul_u32_u24 v8, 3072, v232
    v_lshl_add_u32 v8, v233, 4, v8
    v_add_u32 v9, 23552, v8
    v_add_u32 v10, 47104, v8
    v_add_u32 v11, 70656, v8
    s_lshl2_add_u32 s80, s60, s64
    s_mul_i32 s81, s80, 40960
    s_lshr_b32 s82, s64, 1
    s_mul_i32 s83, s82, 32*3072
    s_lshl_b32 s57, s61, 7
    s_add_u32 s83, s83, s57
    s_and_b32 s57, s64, 1
    s_lshl1_add_u32 s82, s57, s82
    s_lshl_b32 s82, s82, 12
    s_mul_i32 s3, s64, 12288
    s_mov_b32 s30, 640*3072
    s_mov_b32 s31, 0x20000
    s_mov_b32 s26, 2048*1280
    s_mov_b32 s27, 0x20000
    s_bitcmp1_b32 s64, 0
    s_waitcnt lgkmcnt(0)
    s_cselect_b32 s28, s14, s12
    s_cselect_b32 s29, s15, s13
    s_and_b32 s29, s29, 0xffff
    s_mov_b32 s24, s4
    s_and_b32 s25, s5, 0xffff
    s_lshl_b32 s4, s70, 7
    s_add_u32 m0, s3, 78336
    s_add_u32 s4, s4, s81
    buffer_load_dwordx4 v4, s[24:27], s4 offen offset:0 lds
    buffer_load_dwordx4 v5, s[24:27], s4 offen offset:1024 lds
    buffer_load_dwordx4 v6, s[24:27], s4 offen offset:2048 lds
    buffer_load_dwordx4 v7, s[24:27], s4 offen offset:3072 lds
    s_mul_i32 s5, s70, 64*3072
    s_add_u32 m0, s82, 12800
    s_add_u32 s5, s5, s83
    buffer_load_dwordx4 v8, s[28:31], s5 offen offset:0 lds
    buffer_load_dwordx4 v9, s[28:31], s5 offen offset:1024 lds
    buffer_load_dwordx4 v10, s[28:31], s5 offen offset:2048 lds
    buffer_load_dwordx4 v11, s[28:31], s5 offen offset:3072 lds
    s_mov_b32 s36, s6
    s_and_b32 s37, s7, 0xffff
    s_mov_b32 s38, 2457600
    s_mov_b32 s39, 0x20000
    v_lshrrev_b32 v176, 4, v1
    v_and_b32 v177, 15, v1
    v_mul_u32_u24 v178, 52, v177
    v_lshrrev_b32 v178, 8, v178
    v_mul_u32_u24 v179, 1200, v178
    v_lshl_add_u32 v179, v177, 4, v179
    v_add_u32 v179, 1280, v179
    v_subrev_u32 v180, 3840, v179
    v_cmp_lt_u32 vcc, 9, v177
    v_mov_b32 v181, 1073741824
    s_nop 0
    v_cndmask_b32 v179, v179, v180, vcc
    v_mul_u32_u24 v180, 3840, v176
    v_cmp_gt_u32 vcc, 15, v177
    v_add_u32 v179, v179, v180
    s_mul_i32 s57, s60, 40
    v_cndmask_b32 v179, v181, v179, vcc
    v_lshrrev_b32 v180, 2, v1
    v_mul_u32_u24 v180, 3072, v180
    v_and_b32 v178, 0x30, v2
    v_cmp_gt_u32 vcc, 32, v1
    v_add_u32 v180, v180, v178
    s_lshl2_add_u32 s58, s64, s57
    v_cndmask_b32 v181, v181, v180, vcc
    s_mul_i32 s91, s58, 3840
    s_mul_i32 s59, s61, 80
    s_add_u32 s91, s91, s59
    s_mul_i32 s57, s57, 3072
    s_lshl_b32 s56, s61, 6
    s_add_u32 s57, s57, s56
    s_add_u32 s90, s57, 2048
    s_lshl_b32 s92, s64, 10
    s_and_b32 s93, s64, 1
    s_mul_i32 s93, s93, 3072
    s_mov_b32 s65, 0x3f803f80
    v_xor_b32 v176, v176, v1
    v_and_b32 v176, 1, v176
    v_mov_b32 v177, s65
    v_cmp_eq_u32 vcc, 0, v176
    s_nop 1
    v_cndmask_b32 v216, 0, v177, vcc
    v_mov_b32 v217, v216
    v_mov_b32 v218, v216
    v_mov_b32 v219, v216
    s_bfe_u32 s71, 4384, s55
    v_add_u32 v3, 0x10000, v2
    v_add_u32 v47, 0x20000, v2
    v_and_b32 v228, 31, v1
    v_lshrrev_b32 v229, 5, v1
    v_bfe_u32 v230, v1, 1, 3
    v_xor_b32 v230, v230, v229
    v_lshlrev_b32 v230, 4, v230
    v_lshl_add_u32 v230, v228, 7, v230
    s_add_u32 s56, s3, 78336
    v_add_u32 v12, s56, v230
    v_xor_b32 v13, 32, v12
    v_xor_b32 v14, 64, v12
    v_xor_b32 v15, 96, v12
    v_mul_u32_u24 v232, 1280, v229
    v_lshl_add_u32 v233, v228, 4, v232
    v_lshl_add_u32 v232, v228, 3, v232
    s_lshl4_add_u32 s88, s60, s61
    s_lshl2_add_u32 s89, s88, s64
    s_mul_i32 s88, s89, 2560
    v_bfe_u32 v228, v1, 2, 2
    v_lshl_add_u32 v229, v229, 3, v228
    v_lshlrev_b32 v229, 7, v229
    v_lshrrev_b32 v228, 1, v228
    v_lshlrev_b32 v228, 6, v228
    v_bfe_u32 v230, v1, 4, 1
    v_lshl_add_u32 v228, v230, 5, v228
    v_and_b32 v230, 3, v1
    v_lshl_add_u32 v228, v230, 3, v228
    v_add_u32 v16, v228, v229
    s_and_b32 s57, s64, 1
    s_lshl_b32 s57, s57, 6
    v_xor_b32 v16, s57, v16
    v_xor_b32 v17, 64, v16
    v_add_u32 v18, 0x10000, v16
    v_add_u32 v19, 0x10000, v17
    s_mov_b32 s32, s20
    s_and_b32 s33, s21, 0xffff
    s_mov_b32 s34, 33554432
    s_mov_b32 s35, 0x20000
    s_add_u32 s56, s20, 21037056
    s_addc_u32 s57, s21, 0
    s_load_dword s22, s[56:57], 0
    s_add_u32 s98, s98, M_tbl-M_pc
    s_addc_u32 s99, s99, 0
    v_lshlrev_b32 v235, 4, v0
    s_bfe_u32 s72, 8978, s55
    s_bfe_u32 s73, 16947, s55
    s_bfe_u32 s74, 13381, s55
    s_bfe_u32 s75, 21860, s55
    s_bfe_u32 s76, 26454, s55
    s_bfe_u32 s77, 34423, s55
    s_bfe_u32 s78, 30857, s55
    s_bfe_u32 s79, 39320, s55
    s_add_u32 m0, s92, 127488
    s_nop 0
    buffer_load_dwordx4 v179, s[36:39], s91 offen nt lds
    s_add_u32 m0, s92, 131584
    s_add_u32 s91, s91, 16*3840
    buffer_load_dwordx4 v179, s[36:39], s91 offen nt lds
    s_waitcnt vmcnt(2)
    s_barrier
    ds_read_b128 a[0:3], v12 offset:0
    ds_read_b128 a[4:7], v13 offset:0
    ds_read_b128 a[8:11], v14 offset:0
    ds_read_b128 a[12:15], v15 offset:0
    ds_read_b64_tr_b16 a[224:225], v16 offset:12800
    ds_read_b64_tr_b16 a[226:227], v16 offset:13312
    ds_read_b64_tr_b16 a[228:229], v16 offset:20992
    ds_read_b64_tr_b16 a[230:231], v16 offset:21504
    ds_read_b64_tr_b16 a[232:233], v17 offset:12800
    ds_read_b64_tr_b16 a[234:235], v17 offset:13312
    ds_read_b64_tr_b16 a[236:237], v17 offset:20992
    ds_read_b64_tr_b16 a[238:239], v17 offset:21504
    ds_read_b64_tr_b16 a[240:241], v16 offset:14848
    ds_read_b64_tr_b16 a[242:243], v16 offset:15360
    ds_read_b64_tr_b16 a[244:245], v16 offset:23040
    s_waitcnt lgkmcnt(0)
    ds_read_b64_tr_b16 a[246:247], v16 offset:23552
    v_mfma_f32_32x32x16_bf16 v[48:63], a[224:227], a[0:3], 0
    ds_read_b64_tr_b16 a[248:249], v17 offset:14848
    ds_read_b64_tr_b16 a[250:251], v17 offset:15360
    s_cmp_lt_u32 s64, 2
    s_cbranch_scc0 SK_1
    s_add_u32 m0, s92, 135680
    s_add_u32 s91, s91, 16*3840
    buffer_load_dwordx4 v179, s[36:39], s91 offen nt lds
SK_1:
    s_cmp_ge_u32 s64, 2
    s_cbranch_scc0 SK_2
    s_add_u32 m0, s93, 139776
    s_add_u32 s12, s90, 32*3072
    buffer_load_dwordx4 v181, s[28:31], s12 offen nt lds
SK_2:
    v_mfma_f32_32x32x16_bf16 v[64:79], a[228:231], a[0:3], 0
    s_bitcmp0_b32 s64, 1
    s_cbranch_scc0 TK_3
    v_mfma_f32_16x16x32_bf16 v[220:223], v[216:219], a[224:227], 0
    v_mfma_f32_16x16x32_bf16 v[224:227], v[216:219], a[228:231], 0
TK_3:
    ds_read_b64_tr_b16 a[252:253], v17 offset:23040
    ds_read_b64_tr_b16 a[254:255], v17 offset:23552
    s_lshr_b32 s12, s64, 1
    s_lshl_b32 s13, s12, 10
    s_add_u32 s13, s13, s93
    s_mul_i32 s12, s12, 16*3072
    s_add_u32 m0, s13, 137728
    s_add_u32 s12, s12, s90
    buffer_load_dwordx4 v180, s[28:31], s12 offen nt lds
    s_add_u32 s100, s98, 0
    s_addc_u32 s101, s99, 0
    global_load_dwordx4 v[240:243], v235, s[100:101]
    v_mfma_f32_32x32x16_bf16 v[80:95], a[232:235], a[0:3], 0
    ds_read_b64_tr_b16 a[224:225], v16 offset:16896
    ds_read_b64_tr_b16 a[226:227], v16 offset:17408
    s_add_u32 s100, s98, 4096
    s_addc_u32 s101, s99, 0
    global_load_dwordx4 v[20:23], v235, s[100:101]
    s_lshl_b32 s4, s71, 7
    s_add_u32 m0, s3, 82432
    s_add_u32 s4, s4, s81
    buffer_load_dwordx4 v4, s[24:27], s4 offen offset:0 lds
    v_mfma_f32_32x32x16_bf16 v[96:111], a[236:239], a[0:3], 0
    ds_read_b64_tr_b16 a[228:229], v16 offset:25088
    ds_read_b64_tr_b16 a[230:231], v16 offset:25600
    buffer_load_dwordx4 v5, s[24:27], s4 offen offset:1024 lds
    buffer_load_dwordx4 v6, s[24:27], s4 offen offset:2048 lds
    s_mul_i32 s22, s22, 0x41c64e6d
    s_add_u32 s22, s22, 0x3039
    s_cmp_eq_u32 s64, 0
    s_cselect_b32 s23, s22, 0
    s_cmp_lt_u32 s64, 2
    s_cbranch_scc0 SK_4
    s_mov_b32 s48, s8
    s_and_b32 s49, s9, 0xffff
    s_mov_b32 s50, 25600
    s_mov_b32 s51, 0x20000
    s_mul_i32 s56, s61, 1600
    s_min_u32 s57, s64, 1
    s_mul_i32 s57, s57, 576
    s_add_u32 m0, s57, 0
    s_add_u32 s56, s56, s57
    buffer_load_dwordx4 v2, s[48:51], s56 offen lds
SK_4:
    s_waitcnt lgkmcnt(4)
    v_mfma_f32_32x32x16_bf16 v[48:63], a[240:243], a[4:7], v[48:63]
    ds_read_b64_tr_b16 a[232:233], v17 offset:16896
    ds_read_b64_tr_b16 a[234:235], v17 offset:17408
    s_add_u32 m0, s3, 82432
    s_nop 0
    buffer_load_dwordx4 v7, s[24:27], s4 offen offset:3072 lds
    s_mul_i32 s5, s71, 64*3072
    s_add_u32 m0, s82, 29184
    s_add_u32 s5, s5, s83
    buffer_load_dwordx4 v8, s[28:31], s5 offen offset:0 lds
    v_mfma_f32_32x32x16_bf16 v[64:79], a[244:247], a[4:7], v[64:79]
    s_bitcmp1_b32 s64, 1
    s_cbranch_scc0 TK_5
    v_mfma_f32_16x16x32_bf16 v[220:223], v[216:219], a[240:243], 0
    v_mfma_f32_16x16x32_bf16 v[224:227], v[216:219], a[244:247], 0
TK_5:
    ds_read_b64_tr_b16 a[236:237], v17 offset:25088
    ds_read_b64_tr_b16 a[238:239], v17 offset:25600
    s_waitcnt vmcnt(7)
    s_barrier
    s_add_u32 m0, s82, 29184
    s_nop 0
    buffer_load_dwordx4 v9, s[28:31], s5 offen offset:1024 lds
    buffer_load_dwordx4 v10, s[28:31], s5 offen offset:2048 lds
    v_mfma_f32_32x32x16_bf16 v[80:95], a[248:251], a[4:7], v[80:95]
    ds_read_b64_tr_b16 a[240:241], v16 offset:18944
    ds_read_b64_tr_b16 a[242:243], v16 offset:19456
    buffer_load_dwordx4 v11, s[28:31], s5 offen offset:3072 lds
    s_lshl_b32 s4, s72, 7
    s_add_u32 m0, s3, 86528
    s_add_u32 s4, s4, s81
    buffer_load_dwordx4 v4, s[24:27], s4 offen offset:0 lds
    v_mfma_f32_32x32x16_bf16 v[96:111], a[252:255], a[4:7], v[96:111]
    ds_read_b64_tr_b16 a[244:245], v16 offset:27136
    ds_read_b64_tr_b16 a[246:247], v16 offset:27648
    buffer_load_dwordx4 v5, s[24:27], s4 offen offset:1024 lds
    buffer_load_dwordx4 v6, s[24:27], s4 offen offset:2048 lds
    v_mov_b32 v42, s22
    v_and_b32 v30, 31, v1
    v_mov_b32 v228, 1073741824
    v_lshlrev_b32 v30, 2, v30
    s_waitcnt lgkmcnt(4)
    v_mfma_f32_32x32x16_bf16 v[48:63], a[224:227], a[8:11], v[48:63]
    ds_read_b64_tr_b16 a[248:249], v17 offset:18944
    ds_read_b64_tr_b16 a[250:251], v17 offset:19456
    s_waitcnt vmcnt(7)
    ds_read_b128 a[16:19], v12 offset:4096
    buffer_load_dwordx4 v7, s[24:27], s4 offen offset:3072 lds
    s_mul_i32 s5, s72, 64*3072
    s_add_u32 m0, s82, 45568
    s_add_u32 s5, s5, s83
    buffer_load_dwordx4 v8, s[28:31], s5 offen offset:0 lds
    v_mfma_f32_32x32x16_bf16 v[64:79], a[228:231], a[8:11], v[64:79]
    s_bitcmp0_b32 s64, 1
    s_cbranch_scc0 TK_6
    v_mfma_f32_16x16x32_bf16 v[220:223], v[216:219], a[224:227], v[220:223]
    v_mfma_f32_16x16x32_bf16 v[224:227], v[216:219], a[228:231], v[224:227]
TK_6:
    ds_read_b64_tr_b16 a[252:253], v17 offset:27136
    ds_read_b64_tr_b16 a[254:255], v17 offset:27648
    ds_read_b128 a[20:23], v13 offset:4096
    s_add_u32 m0, s82, 45568
    s_nop 0
    buffer_load_dwordx4 v9, s[28:31], s5 offen offset:1024 lds
    buffer_load_dwordx4 v10, s[28:31], s5 offen offset:2048 lds
    v_cmp_gt_u32 vcc, 64, v0
    v_mfma_f32_32x32x16_bf16 v[80:95], a[232:235], a[8:11], v[80:95]
    ds_read_b128 a[24:27], v14 offset:4096
    buffer_load_dwordx4 v11, s[28:31], s5 offen offset:3072 lds
    buffer_load_dwordx4 v[184:187], v233, s[24:27], s88 offen
    v_and_b32 v28, 60, v30
    v_cndmask_b32 v31, v228, v30, vcc
    v_cndmask_b32 v28, v228, v28, vcc
    v_cmp_eq_u32 vcc, 0, v0
    v_mfma_f32_32x32x16_bf16 v[96:111], a[236:239], a[8:11], v[96:111]
    s_waitcnt vmcnt(9)
    s_waitcnt lgkmcnt(2)
    s_barrier
    ds_read_b64_tr_b16 a[224:225], v16 offset:29184
    ds_read_b64_tr_b16 a[226:227], v16 offset:29696
    ds_read_b64_tr_b16 a[228:229], v16 offset:37376
    ds_read_b64_tr_b16 a[230:231], v16 offset:37888
    ds_read_b128 a[28:31], v15 offset:4096
    buffer_load_dwordx4 v[188:191], v233, s[24:27], s88 offen offset:512
    buffer_load_dwordx2 v[192:193], v232, s[24:27], s88 offen offset:1024
    v_mfma_f32_32x32x16_bf16 v[48:63], a[240:243], a[12:15], v[48:63]
    ds_read_b64_tr_b16 a[232:233], v17 offset:29184
    ds_read_b64_tr_b16 a[234:235], v17 offset:29696
    s_add_u32 s100, s98, 8192
    s_addc_u32 s101, s99, 0
    global_load_dwordx4 v[236:239], v235, s[100:101]
    s_add_u32 s100, s98, 12288
    s_addc_u32 s101, s99, 0
    global_load_dwordx4 v[244:247], v235, s[100:101]
    v_mfma_f32_32x32x16_bf16 v[64:79], a[244:247], a[12:15], v[64:79]
    s_bitcmp1_b32 s64, 1
    s_cbranch_scc0 TK_7
    v_mfma_f32_16x16x32_bf16 v[220:223], v[216:219], a[240:243], v[220:223]
    v_mfma_f32_16x16x32_bf16 v[224:227], v[216:219], a[244:247], v[224:227]
TK_7:
    ds_read_b64_tr_b16 a[236:237], v17 offset:37376
    ds_read_b64_tr_b16 a[238:239], v17 offset:37888
    s_mul_i32 s5, s73, 64*3072
    s_add_u32 m0, s82, 61952
    s_add_u32 s5, s5, s83
    buffer_load_dwordx4 v8, s[28:31], s5 offen offset:0 lds
    buffer_load_dwordx4 v9, s[28:31], s5 offen offset:1024 lds
    v_cndmask_b32 v29, v228, 0, vcc
    v_mov_b32 v208, -1
    v_mfma_f32_32x32x16_bf16 v[80:95], a[248:251], a[12:15], v[80:95]
    ds_read_b64_tr_b16 a[240:241], v16 offset:31232
    ds_read_b64_tr_b16 a[242:243], v16 offset:31744
    buffer_load_dwordx4 v10, s[28:31], s5 offen offset:2048 lds
    buffer_load_dwordx4 v11, s[28:31], s5 offen offset:3072 lds
    v_mov_b32 v209, -1
    v_mov_b32 v210, -1
    v_mov_b32 v211, -1
    v_mfma_f32_32x32x16_bf16 v[96:111], a[252:255], a[12:15], v[96:111]
    ds_read_b64_tr_b16 a[244:245], v16 offset:39424
    ds_read_b64_tr_b16 a[246:247], v16 offset:39936
    s_lshl_b32 s4, s73, 7
    s_add_u32 m0, s3, 78336
    s_add_u32 s4, s4, s81
    buffer_load_dwordx4 v4, s[24:27], s4 offen offset:0 lds
    buffer_load_dwordx4 v5, s[24:27], s4 offen offset:1024 lds
    v_mov_b32 v212, 0
    v_mov_b32 v213, 0
    v_mov_b32 v214, 0
    s_waitcnt lgkmcnt(4)
    v_mfma_f32_32x32x16_bf16 v[48:63], a[224:227], a[16:19], v[48:63]
    ds_read_b64_tr_b16 a[248:249], v17 offset:31232
    ds_read_b64_tr_b16 a[250:251], v17 offset:31744
    buffer_load_dwordx4 v6, s[24:27], s4 offen offset:2048 lds
    buffer_load_dwordx4 v7, s[24:27], s4 offen offset:3072 lds
    v_mov_b32 v215, 0
    ds_write_b128 v2, v[212:215] offset:2048
    s_mul_i32 s50, s61, 65536
    s_add_u32 s50, s50, 19922944
    s_mul_i32 s51, s60, 4096
    v_mfma_f32_32x32x16_bf16 v[64:79], a[228:231], a[16:19], v[64:79]
    s_bitcmp0_b32 s64, 1
    s_cbranch_scc0 TK_8
    v_mfma_f32_16x16x32_bf16 v[220:223], v[216:219], a[224:227], v[220:223]
    v_mfma_f32_16x16x32_bf16 v[224:227], v[216:219], a[228:231], v[224:227]
TK_8:
    ds_read_b64_tr_b16 a[252:253], v17 offset:39424
    ds_read_b64_tr_b16 a[254:255], v17 offset:39936
    s_mul_i32 s5, s74, 64*3072
    s_add_u32 m0, s82, 12800
    s_add_u32 s5, s5, s83
    buffer_load_dwordx4 v8, s[28:31], s5 offen offset:0 lds
    buffer_load_dwordx4 v9, s[28:31], s5 offen offset:1024 lds
    s_add_u32 s51, s51, s50
    s_lshr_b32 s56, s64, 1
    s_mul_i32 s56, s56, 2016
    s_add_u32 s51, s51, s56
    v_mfma_f32_32x32x16_bf16 v[80:95], a[232:235], a[16:19], v[80:95]
    ds_read_b64_tr_b16 a[224:225], v16 offset:33280
    ds_read_b64_tr_b16 a[226:227], v16 offset:33792
    buffer_load_dwordx4 v10, s[28:31], s5 offen offset:2048 lds
    buffer_load_dwordx4 v11, s[28:31], s5 offen offset:3072 lds
    buffer_store_dwordx4 v[208:211], v22, s[32:35], s51 offen sc1
    s_bitcmp0_b32 s64, 0
    s_cbranch_scc0 SK_9
    buffer_store_dwordx4 v[208:211], v23, s[32:35], s51 offen offset:672 sc1
SK_9:
    v_mfma_f32_32x32x16_bf16 v[96:111], a[236:239], a[16:19], v[96:111]
    ds_read_b64_tr_b16 a[228:229], v16 offset:41472
    ds_read_b64_tr_b16 a[230:231], v16 offset:41984
    s_lshl_b32 s4, s74, 7
    s_add_u32 m0, s3, 82432
    s_add_u32 s4, s4, s81
    buffer_load_dwordx4 v4, s[24:27], s4 offen offset:0 lds
    buffer_load_dwordx4 v5, s[24:27], s4 offen offset:1024 lds
    s_waitcnt lgkmcnt(4)
    v_mfma_f32_32x32x16_bf16 v[48:63], a[240:243], a[20:23], v[48:63]
    ds_read_b64_tr_b16 a[232:233], v17 offset:33280
    ds_read_b64_tr_b16 a[234:235], v17 offset:33792
    buffer_load_dwordx4 v6, s[24:27], s4 offen offset:2048 lds
    buffer_load_dwordx4 v7, s[24:27], s4 offen offset:3072 lds
    s_lshl_b32 s52, s61, 12
    s_lshl_b32 s56, s60, 8
    s_add_u32 s50, s50, s56
    s_add_u32 s52, s52, 21168128
    s_add_u32 s40, s52, s56
    v_mfma_f32_32x32x16_bf16 v[64:79], a[244:247], a[20:23], v[64:79]
    s_bitcmp1_b32 s64, 1
    s_cbranch_scc0 TK_10
    v_mfma_f32_16x16x32_bf16 v[220:223], v[216:219], a[240:243], v[220:223]
    v_mfma_f32_16x16x32_bf16 v[224:227], v[216:219], a[244:247], v[224:227]
TK_10:
    ds_read_b64_tr_b16 a[236:237], v17 offset:41472
    ds_read_b64_tr_b16 a[238:239], v17 offset:41984
    v_mov_b32 v0, v242
    buffer_store_dwordx2 v[208:209], v0, s[32:35], s40 offen sc1
    s_mul_i32 s94, s60, 5
    s_mul_i32 s95, s61, 245760
    s_lshl4_add_u32 s59, s61, s60
    s_mul_i32 s59, s59, 768
    s_add_u32 s59, s59, 4325376
    s_cmp_eq_u32 s64, 2
    s_cselect_b32 s57, 1, 4
    s_lshl_b32 s57, s57, 8
    s_lshl_b32 s58, s57, 1
    s_cmp_eq_u32 s64, 3
    s_cbranch_scc1 Mr_j
    v_add_u32 v134, s57, v240
    ds_read_b64_tr_b16 v[112:113], v240
    ds_read_b64_tr_b16 v[114:115], v134
    v_add_u32 v240, s58, v240
    v_add_u32 v134, s58, v134
    ds_read_b64_tr_b16 v[116:117], v240
    ds_read_b64_tr_b16 v[118:119], v134
    v_add_u32 v240, s58, v240
    v_add_u32 v134, s58, v134
    ds_read_b64_tr_b16 v[120:121], v240
    ds_read_b64_tr_b16 v[122:123], v134
    v_add_u32 v240, s58, v240
    v_add_u32 v134, s58, v134
    ds_read_b64_tr_b16 v[124:125], v240
    s_waitcnt lgkmcnt(13)
    ds_read_b64_tr_b16 v[126:127], v134
    v_add_u32 v240, s58, v240
    v_add_u32 v134, s58, v134
    ds_read_b64_tr_b16 v[128:129], v240
    s_waitcnt lgkmcnt(13)
    ds_read_b64_tr_b16 v[130:131], v134
    s_waitcnt lgkmcnt(0)
    v_dot2_f32_bf16 v132, v112, s65, 0
    v_dot2_f32_bf16 v133, v113, s65, 0
    v_dot2_f32_bf16 v132, v114, s65, v132
    v_dot2_f32_bf16 v133, v115, s65, v133
    v_dot2_f32_bf16 v132, v116, s65, v132
    v_dot2_f32_bf16 v133, v117, s65, v133
    v_dot2_f32_bf16 v132, v118, s65, v132
    v_dot2_f32_bf16 v133, v119, s65, v133
    v_dot2_f32_bf16 v132, v120, s65, v132
    v_dot2_f32_bf16 v133, v121, s65, v133
    v_dot2_f32_bf16 v132, v122, s65, v132
    v_dot2_f32_bf16 v133, v123, s65, v133
    v_dot2_f32_bf16 v132, v124, s65, v132
    v_dot2_f32_bf16 v133, v125, s65, v133
    v_dot2_f32_bf16 v132, v126, s65, v132
    v_dot2_f32_bf16 v133, v127, s65, v133
    v_dot2_f32_bf16 v132, v128, s65, v132
    v_dot2_f32_bf16 v133, v129, s65, v133
    v_dot2_f32_bf16 v132, v130, s65, v132
    v_dot2_f32_bf16 v133, v131, s65, v133
    s_nop 2
    v_add_f32 v132, v132, v133
    buffer_store_dword v132, v243, s[32:35], s59 offen sc1
Mr_j:
    s_cmp_lg_u32 s64, 3
    s_cbranch_scc0 SK_11
    s_add_u32 s12, s94, 0
    s_lshr_b32 s13, s12, 1
    s_and_b32 s12, s12, 1
    s_mul_i32 s13, s13, 3072
    s_lshl_b32 s12, s12, 9
    s_add_u32 s12, s12, s95
    s_add_u32 s12, s12, s13
    buffer_store_dwordx4 v[112:115], v241, s[32:35], s12 offen sc1
SK_11:
    v_mfma_f32_32x32x16_bf16 v[80:95], a[248:251], a[20:23], v[80:95]
    ds_read_b64_tr_b16 a[240:241], v16 offset:35328
    ds_read_b64_tr_b16 a[242:243], v16 offset:35840
    s_lshl_b32 s41, s61, 8
    s_add_u32 s41, s41, 20971520
    s_lshl2_add_u32 s42, s60, s41
    s_mul_i32 s36, s61, 245760
    s_mul_i32 s37, s64, 3072
    s_add_u32 s36, s36, s37
    s_add_u32 s39, s36, 122880
    s_lshl_b32 s47, s80, 9
    s_add_u32 s47, s47, 4718592
    s_mul_i32 s48, s80, 139264
    s_add_u32 s48, s48, 10485760
    s_lshl_b32 s49, s61, 1
    s_and_b32 s56, s64, 1
    v_mfma_f32_32x32x16_bf16 v[96:111], a[252:255], a[20:23], v[96:111]
    ds_read_b64_tr_b16 a[244:245], v16 offset:43520
    ds_read_b64_tr_b16 a[246:247], v16 offset:44032
    s_add_u32 s49, s49, s56
    s_xor_b32 s38, s49, 1
    s_lshl_b32 s49, s49, 10
    s_lshl_b32 s38, s38, 10
    s_add_u32 s49, s49, s48
    s_add_u32 s38, s38, s48
    s_lshl_b32 s43, s60, 8
    s_lshl2_add_u32 s43, s61, s43
    s_add_u32 s43, s43, 20987904
    s_lshr_b32 s44, s62, 1
    s_lshl_b32 s44, s44, 8
    s_add_u32 s44, s44, 20987904
    v_mov_b32 v43, 0
    v_mov_b32 v45, 0
    v_mov_b32 v46, 0
    s_waitcnt lgkmcnt(4)
    v_mfma_f32_32x32x16_bf16 v[48:63], a[224:227], a[24:27], v[48:63]
    ds_read_b64_tr_b16 a[248:249], v17 offset:35328
    ds_read_b64_tr_b16 a[250:251], v17 offset:35840
    s_waitcnt vmcnt(27)
    ds_read_b128 a[32:35], v12 offset:8192
    v_mfma_f32_32x32x16_bf16 v[64:79], a[228:231], a[24:27], v[64:79]
    s_bitcmp0_b32 s64, 1
    s_cbranch_scc0 TK_12
    v_mfma_f32_16x16x32_bf16 v[220:223], v[216:219], a[224:227], v[220:223]
    v_mfma_f32_16x16x32_bf16 v[224:227], v[216:219], a[228:231], v[224:227]
TK_12:
    ds_read_b64_tr_b16 a[252:253], v17 offset:43520
    ds_read_b64_tr_b16 a[254:255], v17 offset:44032
    ds_read_b128 a[36:39], v13 offset:8192
    v_mfma_f32_32x32x16_bf16 v[80:95], a[232:235], a[24:27], v[80:95]
    ds_read_b128 a[40:43], v14 offset:8192
    s_cmp_lg_u32 s64, 3
    s_cbranch_scc0 SK_13
    s_add_u32 s12, s94, 1
    s_lshr_b32 s13, s12, 1
    s_and_b32 s12, s12, 1
    s_mul_i32 s13, s13, 3072
    s_lshl_b32 s12, s12, 9
    s_add_u32 s12, s12, s95
    s_add_u32 s12, s12, s13
    buffer_store_dwordx4 v[116:119], v241, s[32:35], s12 offen sc1
SK_13:
    v_mfma_f32_32x32x16_bf16 v[96:111], a[236:239], a[24:27], v[96:111]
    s_waitcnt vmcnt(23)
    s_waitcnt lgkmcnt(2)
    s_barrier
    ds_read_b64_tr_b16 a[224:225], v16 offset:45568
    ds_read_b64_tr_b16 a[226:227], v16 offset:46080
    ds_read_b64_tr_b16 a[228:229], v16 offset:53760
    ds_read_b64_tr_b16 a[230:231], v16 offset:54272
    ds_read_b128 a[44:47], v15 offset:8192
    v_mfma_f32_32x32x16_bf16 v[48:63], a[240:243], a[28:31], v[48:63]
    ds_read_b64_tr_b16 a[232:233], v17 offset:45568
    ds_read_b64_tr_b16 a[234:235], v17 offset:46080
    s_mul_i32 s5, s75, 64*3072
    s_add_u32 m0, s82, 29184
    s_add_u32 s5, s5, s83
    buffer_load_dwordx4 v8, s[28:31], s5 offen offset:0 lds
    v_mfma_f32_32x32x16_bf16 v[64:79], a[244:247], a[28:31], v[64:79]
    s_bitcmp1_b32 s64, 1
    s_cbranch_scc0 TK_14
    v_mfma_f32_16x16x32_bf16 v[220:223], v[216:219], a[240:243], v[220:223]
    v_mfma_f32_16x16x32_bf16 v[224:227], v[216:219], a[244:247], v[224:227]
TK_14:
    ds_read_b64_tr_b16 a[236:237], v17 offset:53760
    ds_read_b64_tr_b16 a[238:239], v17 offset:54272
    v_mfma_f32_32x32x16_bf16 v[80:95], a[248:251], a[28:31], v[80:95]
    ds_read_b64_tr_b16 a[240:241], v16 offset:47616
    ds_read_b64_tr_b16 a[242:243], v16 offset:48128
    s_cmp_lg_u32 s64, 3
    s_cbranch_scc0 SK_15
    s_add_u32 s12, s94, 2
    s_lshr_b32 s13, s12, 1
    s_and_b32 s12, s12, 1
    s_mul_i32 s13, s13, 3072
    s_lshl_b32 s12, s12, 9
    s_add_u32 s12, s12, s95
    s_add_u32 s12, s12, s13
    buffer_store_dwordx4 v[120:123], v241, s[32:35], s12 offen sc1
SK_15:
    v_mfma_f32_32x32x16_bf16 v[96:111], a[252:255], a[28:31], v[96:111]
    ds_read_b64_tr_b16 a[244:245], v16 offset:55808
    ds_read_b64_tr_b16 a[246:247], v16 offset:56320
    s_waitcnt lgkmcnt(4)
    v_mfma_f32_32x32x16_bf16 v[48:63], a[224:227], a[32:35], v[48:63]
    ds_read_b64_tr_b16 a[248:249], v17 offset:47616
    ds_read_b64_tr_b16 a[250:251], v17 offset:48128
    s_add_u32 m0, s82, 29184
    s_nop 0
    buffer_load_dwordx4 v9, s[28:31], s5 offen offset:1024 lds
    v_mfma_f32_32x32x16_bf16 v[64:79], a[228:231], a[32:35], v[64:79]
    s_bitcmp0_b32 s64, 1
    s_cbranch_scc0 TK_16
    v_mfma_f32_16x16x32_bf16 v[220:223], v[216:219], a[224:227], v[220:223]
    v_mfma_f32_16x16x32_bf16 v[224:227], v[216:219], a[228:231], v[224:227]
TK_16:
    ds_read_b64_tr_b16 a[252:253], v17 offset:55808
    ds_read_b64_tr_b16 a[254:255], v17 offset:56320
    v_mfma_f32_32x32x16_bf16 v[80:95], a[232:235], a[32:35], v[80:95]
    ds_read_b64_tr_b16 a[224:225], v16 offset:49664
    ds_read_b64_tr_b16 a[226:227], v16 offset:50176
    s_add_u32 m0, s82, 29184
    s_nop 0
    buffer_load_dwordx4 v10, s[28:31], s5 offen offset:2048 lds
    v_mfma_f32_32x32x16_bf16 v[96:111], a[236:239], a[32:35], v[96:111]
    ds_read_b64_tr_b16 a[228:229], v16 offset:57856
    ds_read_b64_tr_b16 a[230:231], v16 offset:58368
    s_waitcnt lgkmcnt(4)
    v_mfma_f32_32x32x16_bf16 v[48:63], a[240:243], a[36:39], v[48:63]
    ds_read_b64_tr_b16 a[232:233], v17 offset:49664
    ds_read_b64_tr_b16 a[234:235], v17 offset:50176
    buffer_load_dwordx4 v11, s[28:31], s5 offen offset:3072 lds
    v_mfma_f32_32x32x16_bf16 v[64:79], a[244:247], a[36:39], v[64:79]
    s_bitcmp1_b32 s64, 1
    s_cbranch_scc0 TK_17
    v_mfma_f32_16x16x32_bf16 v[220:223], v[216:219], a[240:243], v[220:223]
    v_mfma_f32_16x16x32_bf16 v[224:227], v[216:219], a[244:247], v[224:227]
TK_17:
    ds_read_b64_tr_b16 a[236:237], v17 offset:57856
    ds_read_b64_tr_b16 a[238:239], v17 offset:58368
    v_mfma_f32_32x32x16_bf16 v[80:95], a[248:251], a[36:39], v[80:95]
    ds_read_b64_tr_b16 a[240:241], v16 offset:51712
    ds_read_b64_tr_b16 a[242:243], v16 offset:52224
    s_cmp_lg_u32 s64, 3
    s_cbranch_scc0 SK_18
    s_add_u32 s12, s94, 3
    s_lshr_b32 s13, s12, 1
    s_and_b32 s12, s12, 1
    s_mul_i32 s13, s13, 3072
    s_lshl_b32 s12, s12, 9
    s_add_u32 s12, s12, s95
    s_add_u32 s12, s12, s13
    buffer_store_dwordx4 v[124:127], v241, s[32:35], s12 offen sc1
SK_18:
    v_mfma_f32_32x32x16_bf16 v[96:111], a[252:255], a[36:39], v[96:111]
    ds_read_b64_tr_b16 a[244:245], v16 offset:59904
    ds_read_b64_tr_b16 a[246:247], v16 offset:60416
    s_waitcnt lgkmcnt(4)
    v_mfma_f32_32x32x16_bf16 v[48:63], a[224:227], a[40:43], v[48:63]
    ds_read_b64_tr_b16 a[248:249], v17 offset:51712
    ds_read_b64_tr_b16 a[250:251], v17 offset:52224
    s_waitcnt vmcnt(14)
    ds_read_b128 a[48:51], v12 offset:0
    s_lshl_b32 s4, s75, 7
    s_add_u32 m0, s3, 86528
    s_add_u32 s4, s4, s81
    buffer_load_dwordx4 v4, s[24:27], s4 offen offset:0 lds
    v_mfma_f32_32x32x16_bf16 v[64:79], a[228:231], a[40:43], v[64:79]
    s_bitcmp0_b32 s64, 1
    s_cbranch_scc0 TK_19
    v_mfma_f32_16x16x32_bf16 v[220:223], v[216:219], a[224:227], v[220:223]
    v_mfma_f32_16x16x32_bf16 v[224:227], v[216:219], a[228:231], v[224:227]
TK_19:
    ds_read_b64_tr_b16 a[252:253], v17 offset:59904
    ds_read_b64_tr_b16 a[254:255], v17 offset:60416
    ds_read_b128 a[52:55], v13 offset:0
    v_mfma_f32_32x32x16_bf16 v[80:95], a[232:235], a[40:43], v[80:95]
    ds_read_b128 a[56:59], v14 offset:0
    s_add_u32 m0, s3, 86528
    s_nop 0
    buffer_load_dwordx4 v5, s[24:27], s4 offen offset:1024 lds
    v_mfma_f32_32x32x16_bf16 v[96:111], a[236:239], a[40:43], v[96:111]
    s_waitcnt lgkmcnt(2)
    s_barrier
    ds_read_b64_tr_b16 a[224:225], v16 offset:61952
    ds_read_b64_tr_b16 a[226:227], v16 offset:62464
    ds_read_b64_tr_b16 a[228:229], v18 offset:4608
    ds_read_b64_tr_b16 a[230:231], v18 offset:5120
    ds_read_b128 a[60:63], v15 offset:0
    s_lshl_b32 s59, s63, 7
    s_mul_i32 s56, s63, 96
    v_bfe_u32 v197, v2, 7, 1
    v_mul_u32_u24 v197, s56, v197
    v_sub_u32 v239, v239, v197
    s_mov_b32 s8, s10
    s_and_b32 s9, s11, 0xffff
    s_mov_b32 s10, 640*1280
    s_mov_b32 s11, 0x20000
    s_add_u32 s65, s62, 64
    s_and_b32 s57, s64, 1
    s_mul_i32 s66, s65, 205
    s_lshr_b32 s66, s66, 10
    s_mul_i32 s67, s66, 5
    s_sub_u32 s67, s65, s67
    s_lshl_b32 s68, s67, 3
    s_cmp_gt_u32 s67, 2
    s_cselect_b32 s69, 4, 0
    s_sub_u32 s68, s68, s69
    s_cmp_eq_u32 s67, 2
    s_cselect_b32 s69, 20, 4
    s_mul_i32 s69, s69, s57
    s_add_u32 s68, s68, s69
    s_mul_i32 s66, s66, 40
    s_add_u32 s68, s68, s66
    s_mul_i32 s68, s68, 1280
    s_add_u32 s68, s68, s59
    s_cmp_lt_u32 s62, 16
    s_cselect_b32 s56, s64, 9
    s_cmp_lt_u32 s56, 2
    s_cselect_b64 s[66:67], -1, 0
    s_lshl_b32 s56, s56, 10
    s_add_u32 s56, s56, 5376
    v_mov_b32 v196, 1073741824
    s_cmp_lg_u64 s[66:67], 0
    s_cselect_b32 m0, s56, 4352
    v_cndmask_b32 v196, v196, v239, s[66:67]
    s_cmp_lg_u64 s[66:67], 0
    s_cbranch_scc0 SK_20
    buffer_load_dwordx4 v196, s[8:11], s68 offen nt lds
SK_20:
    s_lshl_b32 s65, s64, 12
    s_add_u32 m0, s65, 143872
    s_lshr_b32 s56, s64, 1
    s_lshl1_add_u32 s56, s62, s56
    s_cmp_ge_u32 s62, 24
    s_cbranch_scc1 M_b2o
    s_mov_b32 s8, s16
    s_and_b32 s9, s17, 0xffff
    s_mov_b32 s10, 1536*1280
    s_lshl3_add_u32 s56, s56, s57
    s_mul_i32 s68, s56, 4*1280
    s_add_u32 s68, s68, s59
    buffer_load_dwordx4 v239, s[8:11], s68 offen offset:0 nt lds
    s_add_u32 s68, s68, 9216
    buffer_load_dwordx4 v239, s[8:11], s68 offen offset:1024 nt lds
    s_add_u32 s68, s68, 9216
    buffer_load_dwordx4 v239, s[8:11], s68 offen offset:2048 nt lds
    s_add_u32 s68, s68, 9216
    buffer_load_dwordx4 v239, s[8:11], s68 offen offset:3072 nt lds
M_b2o_back:
    v_mfma_f32_32x32x16_bf16 v[48:63], a[240:243], a[44:47], v[48:63]
    ds_read_b64_tr_b16 a[232:233], v17 offset:61952
    ds_read_b64_tr_b16 a[234:235], v17 offset:62464
    s_cmp_lg_u32 s64, 3
    s_cbranch_scc0 SK_21
    s_add_u32 s12, s94, 4
    s_lshr_b32 s13, s12, 1
    s_and_b32 s12, s12, 1
    s_mul_i32 s13, s13, 3072
    s_lshl_b32 s12, s12, 9
    s_add_u32 s12, s12, s95
    s_add_u32 s12, s12, s13
    buffer_store_dwordx4 v[128:131], v241, s[32:35], s12 offen sc1
SK_21:
    v_mfma_f32_32x32x16_bf16 v[64:79], a[244:247], a[44:47], v[64:79]
    s_bitcmp1_b32 s64, 1
    s_cbranch_scc0 TK_22
    v_mfma_f32_16x16x32_bf16 v[220:223], v[216:219], a[240:243], v[220:223]
    v_mfma_f32_16x16x32_bf16 v[224:227], v[216:219], a[244:247], v[224:227]
TK_22:
    ds_read_b64_tr_b16 a[236:237], v19 offset:4608
    ds_read_b64_tr_b16 a[238:239], v19 offset:5120
    s_add_u32 m0, s3, 86528
    s_nop 0
    buffer_load_dwordx4 v6, s[24:27], s4 offen offset:2048 lds
    v_mfma_f32_32x32x16_bf16 v[80:95], a[248:251], a[44:47], v[80:95]
    ds_read_b64_tr_b16 a[240:241], v16 offset:64000
    ds_read_b64_tr_b16 a[242:243], v16 offset:64512
    buffer_load_dwordx4 v7, s[24:27], s4 offen offset:3072 lds
    v_lshlrev_b32 v136, 16, v184
    v_and_b32 v137, 0xffff0000, v184
    v_lshlrev_b32 v138, 16, v185
    v_mfma_f32_32x32x16_bf16 v[96:111], a[252:255], a[44:47], v[96:111]
    ds_read_b64_tr_b16 a[244:245], v18 offset:6656
    ds_read_b64_tr_b16 a[246:247], v18 offset:7168
    s_mul_i32 s5, s76, 64*3072
    s_add_u32 m0, s82, 45568
    s_add_u32 s5, s5, s83
    buffer_load_dwordx4 v8, s[28:31], s5 offen offset:0 lds
    v_and_b32 v139, 0xffff0000, v185
    v_lshlrev_b32 v140, 16, v186
    s_waitcnt lgkmcnt(4)
    v_mfma_f32_32x32x16_bf16 v[48:63], a[224:227], a[48:51], v[48:63]
    ds_read_b64_tr_b16 a[248:249], v17 offset:64000
    ds_read_b64_tr_b16 a[250:251], v17 offset:64512
    buffer_load_dwordx4 v9, s[28:31], s5 offen offset:1024 lds
    v_and_b32 v141, 0xffff0000, v186
    v_lshlrev_b32 v142, 16, v187
    v_and_b32 v143, 0xffff0000, v187
    v_lshlrev_b32 v144, 16, v188
    v_mfma_f32_32x32x16_bf16 v[64:79], a[228:231], a[48:51], v[64:79]
    s_bitcmp0_b32 s64, 1
    s_cbranch_scc0 TK_23
    v_mfma_f32_16x16x32_bf16 v[220:223], v[216:219], a[224:227], v[220:223]
    v_mfma_f32_16x16x32_bf16 v[224:227], v[216:219], a[228:231], v[224:227]
TK_23:
    ds_read_b64_tr_b16 a[252:253], v19 offset:6656
    ds_read_b64_tr_b16 a[254:255], v19 offset:7168
    v_and_b32 v145, 0xffff0000, v188
    v_lshlrev_b32 v146, 16, v189
    v_and_b32 v147, 0xffff0000, v189
    v_lshlrev_b32 v148, 16, v190
    v_and_b32 v149, 0xffff0000, v190
    v_lshlrev_b32 v150, 16, v191
    v_mfma_f32_32x32x16_bf16 v[80:95], a[232:235], a[48:51], v[80:95]
    ds_read_b64_tr_b16 a[224:225], v18 offset:512
    ds_read_b64_tr_b16 a[226:227], v18 offset:1024
    s_add_u32 m0, s82, 45568
    s_nop 0
    buffer_load_dwordx4 v10, s[28:31], s5 offen offset:2048 lds
    v_and_b32 v151, 0xffff0000, v191
    v_lshlrev_b32 v152, 16, v192
    v_and_b32 v153, 0xffff0000, v192
    v_mfma_f32_32x32x16_bf16 v[96:111], a[236:239], a[48:51], v[96:111]
    ds_read_b64_tr_b16 a[228:229], v18 offset:8704
    ds_read_b64_tr_b16 a[230:231], v18 offset:9216
    v_lshlrev_b32 v154, 16, v193
    v_and_b32 v155, 0xffff0000, v193
    v_add_f32 v156, v136, v137
    v_add_f32 v157, v138, v139
    v_add_f32 v156, v156, v140
    v_add_f32 v157, v157, v141
    s_waitcnt lgkmcnt(4)
    v_mfma_f32_32x32x16_bf16 v[48:63], a[240:243], a[52:55], v[48:63]
    ds_read_b64_tr_b16 a[232:233], v19 offset:512
    ds_read_b64_tr_b16 a[234:235], v19 offset:1024
    buffer_load_dwordx4 v11, s[28:31], s5 offen offset:3072 lds
    v_add_f32 v156, v156, v142
    v_add_f32 v157, v157, v143
    v_add_f32 v156, v156, v144
    v_add_f32 v157, v157, v145
    v_mfma_f32_32x32x16_bf16 v[64:79], a[244:247], a[52:55], v[64:79]
    s_bitcmp1_b32 s64, 1
    s_cbranch_scc0 TK_24
    v_mfma_f32_16x16x32_bf16 v[220:223], v[216:219], a[240:243], v[220:223]
    v_mfma_f32_16x16x32_bf16 v[224:227], v[216:219], a[244:247], v[224:227]
TK_24:
    ds_read_b64_tr_b16 a[236:237], v19 offset:8704
    ds_read_b64_tr_b16 a[238:239], v19 offset:9216
    v_add_f32 v156, v156, v146
    v_add_f32 v157, v157, v147
    v_add_f32 v156, v156, v148
    v_add_f32 v157, v157, v149
    v_add_f32 v156, v156, v150
    v_add_f32 v157, v157, v151
    v_add_f32 v156, v156, v152
    v_mfma_f32_32x32x16_bf16 v[80:95], a[248:251], a[52:55], v[80:95]
    ds_read_b64_tr_b16 a[240:241], v18 offset:2560
    ds_read_b64_tr_b16 a[242:243], v18 offset:3072
    s_lshl_b32 s4, s76, 7
    s_add_u32 m0, s3, 78336
    s_add_u32 s4, s4, s81
    buffer_load_dwordx4 v4, s[24:27], s4 offen offset:0 lds
    v_add_f32 v157, v157, v153
    v_add_f32 v156, v156, v154
    v_mfma_f32_32x32x16_bf16 v[96:111], a[252:255], a[52:55], v[96:111]
    ds_read_b64_tr_b16 a[244:245], v18 offset:10752
    ds_read_b64_tr_b16 a[246:247], v18 offset:11264
    v_add_f32 v157, v157, v155
    v_add_f32 v156, v156, v157
    s_waitcnt lgkmcnt(4)
    v_mfma_f32_32x32x16_bf16 v[48:63], a[224:227], a[56:59], v[48:63]
    ds_read_b64_tr_b16 a[248:249], v19 offset:2560
    ds_read_b64_tr_b16 a[250:251], v19 offset:3072
    s_waitcnt vmcnt(18)
    ds_read_b128 a[64:67], v12 offset:4096
    buffer_load_dwordx4 v5, s[24:27], s4 offen offset:1024 lds
    v_add_f32_dpp v156, v156, v156 row_ror:8 row_mask:0xf bank_mask:0xf
    v_mfma_f32_32x32x16_bf16 v[64:79], a[228:231], a[56:59], v[64:79]
    s_bitcmp0_b32 s64, 1
    s_cbranch_scc0 TK_25
    v_mfma_f32_16x16x32_bf16 v[220:223], v[216:219], a[224:227], v[220:223]
    v_mfma_f32_16x16x32_bf16 v[224:227], v[216:219], a[228:231], v[224:227]
TK_25:
    ds_read_b64_tr_b16 a[252:253], v19 offset:10752
    ds_read_b64_tr_b16 a[254:255], v19 offset:11264
    ds_read_b128 a[68:71], v13 offset:4096
    v_add_f32_dpp v156, v156, v156 row_ror:4 row_mask:0xf bank_mask:0xf
    v_mfma_f32_32x32x16_bf16 v[80:95], a[232:235], a[56:59], v[80:95]
    ds_read_b128 a[72:75], v14 offset:4096
    s_add_u32 m0, s3, 78336
    s_nop 0
    buffer_load_dwordx4 v6, s[24:27], s4 offen offset:2048 lds
    v_add_f32_dpp v156, v156, v156 row_ror:2 row_mask:0xf bank_mask:0xf
    v_mfma_f32_32x32x16_bf16 v[96:111], a[236:239], a[56:59], v[96:111]
    s_waitcnt lgkmcnt(2)
    s_barrier
    ds_read_b64_tr_b16 a[224:225], v16 offset:12800
    ds_read_b64_tr_b16 a[226:227], v16 offset:13312
    ds_read_b64_tr_b16 a[228:229], v16 offset:20992
    ds_read_b64_tr_b16 a[230:231], v16 offset:21504
    ds_read_b128 a[76:79], v15 offset:4096
    v_add_f32_dpp v156, v156, v156 row_ror:1 row_mask:0xf bank_mask:0xf
    v_mov_b32 v157, v156
    v_mfma_f32_32x32x16_bf16 v[48:63], a[240:243], a[60:63], v[48:63]
    ds_read_b64_tr_b16 a[232:233], v17 offset:12800
    ds_read_b64_tr_b16 a[234:235], v17 offset:13312
    buffer_load_dwordx4 v7, s[24:27], s4 offen offset:3072 lds
    v_permlane16_swap_b32 v156, v157
    v_add_f32 v156, v156, v157
    v_mul_f32 v156, 0x3acccccd, v156
    v_sub_f32 v136, v136, v156
    v_mfma_f32_32x32x16_bf16 v[64:79], a[244:247], a[60:63], v[64:79]
    s_bitcmp1_b32 s64, 1
    s_cbranch_scc0 TK_26
    v_mfma_f32_16x16x32_bf16 v[220:223], v[216:219], a[240:243], v[220:223]
    v_mfma_f32_16x16x32_bf16 v[224:227], v[216:219], a[244:247], v[224:227]
TK_26:
    ds_read_b64_tr_b16 a[236:237], v17 offset:20992
    ds_read_b64_tr_b16 a[238:239], v17 offset:21504
    s_mul_i32 s5, s77, 64*3072
    s_add_u32 m0, s82, 61952
    s_add_u32 s5, s5, s83
    buffer_load_dwordx4 v8, s[28:31], s5 offen offset:0 lds
    v_sub_f32 v137, v137, v156
    v_sub_f32 v138, v138, v156
    v_mfma_f32_32x32x16_bf16 v[80:95], a[248:251], a[60:63], v[80:95]
    ds_read_b64_tr_b16 a[240:241], v16 offset:14848
    ds_read_b64_tr_b16 a[242:243], v16 offset:15360
    buffer_load_dwordx4 v9, s[28:31], s5 offen offset:1024 lds
    v_sub_f32 v139, v139, v156
    v_sub_f32 v140, v140, v156
    v_sub_f32 v141, v141, v156
    v_sub_f32 v142, v142, v156
    v_mfma_f32_32x32x16_bf16 v[96:111], a[252:255], a[60:63], v[96:111]
    ds_read_b64_tr_b16 a[244:245], v16 offset:23040
    ds_read_b64_tr_b16 a[246:247], v16 offset:23552
    v_sub_f32 v143, v143, v156
    v_sub_f32 v144, v144, v156
    v_sub_f32 v145, v145, v156
    v_sub_f32 v146, v146, v156
    v_sub_f32 v147, v147, v156
    v_sub_f32 v148, v148, v156
    v_sub_f32 v149, v149, v156
    s_waitcnt lgkmcnt(4)
    v_mfma_f32_32x32x16_bf16 v[48:63], a[224:227], a[64:67], v[48:63]
    ds_read_b64_tr_b16 a[248:249], v17 offset:14848
    ds_read_b64_tr_b16 a[250:251], v17 offset:15360
    buffer_load_dwordx4 v10, s[28:31], s5 offen offset:2048 lds
    v_sub_f32 v150, v150, v156
    v_sub_f32 v151, v151, v156
    v_sub_f32 v152, v152, v156
    v_sub_f32 v153, v153, v156
    v_mfma_f32_32x32x16_bf16 v[64:79], a[228:231], a[64:67], v[64:79]
    s_bitcmp0_b32 s64, 1
    s_cbranch_scc0 TK_27
    v_mfma_f32_16x16x32_bf16 v[220:223], v[216:219], a[224:227], v[220:223]
    v_mfma_f32_16x16x32_bf16 v[224:227], v[216:219], a[228:231], v[224:227]
TK_27:
    ds_read_b64_tr_b16 a[252:253], v17 offset:23040
    ds_read_b64_tr_b16 a[254:255], v17 offset:23552
    v_sub_f32 v154, v154, v156
    v_sub_f32 v155, v155, v156
    v_mul_f32 v157, v136, v136
    v_mul_f32 v158, v137, v137
    v_fmac_f32 v157, v138, v138
    v_fmac_f32 v158, v139, v139
    v_mfma_f32_32x32x16_bf16 v[80:95], a[232:235], a[64:67], v[80:95]
    ds_read_b64_tr_b16 a[224:225], v16 offset:16896
    ds_read_b64_tr_b16 a[226:227], v16 offset:17408
    s_add_u32 m0, s82, 61952
    s_nop 0
    buffer_load_dwordx4 v11, s[28:31], s5 offen offset:3072 lds
    v_fmac_f32 v157, v140, v140
    v_fmac_f32 v158, v141, v141
    v_fmac_f32 v157, v142, v142
    v_mfma_f32_32x32x16_bf16 v[96:111], a[236:239], a[64:67], v[96:111]
    ds_read_b64_tr_b16 a[228:229], v16 offset:25088
    ds_read_b64_tr_b16 a[230:231], v16 offset:25600
    v_fmac_f32 v158, v143, v143
    v_fmac_f32 v157, v144, v144
    v_fmac_f32 v158, v145, v145
    v_fmac_f32 v157, v146, v146
    v_fmac_f32 v158, v147, v147
    v_fmac_f32 v157, v148, v148
    s_waitcnt lgkmcnt(4)
    v_mfma_f32_32x32x16_bf16 v[48:63], a[240:243], a[68:71], v[48:63]
    ds_read_b64_tr_b16 a[232:233], v17 offset:16896
    ds_read_b64_tr_b16 a[234:235], v17 offset:17408
    s_lshl_b32 s4, s77, 7
    s_add_u32 m0, s3, 82432
    s_add_u32 s4, s4, s81
    buffer_load_dwordx4 v4, s[24:27], s4 offen offset:0 lds
    v_fmac_f32 v158, v149, v149
    v_fmac_f32 v157, v150, v150
    v_fmac_f32 v158, v151, v151
    v_mfma_f32_32x32x16_bf16 v[64:79], a[244:247], a[68:71], v[64:79]
    s_bitcmp1_b32 s64, 1
    s_cbranch_scc0 TK_28
    v_mfma_f32_16x16x32_bf16 v[220:223], v[216:219], a[240:243], v[220:223]
    v_mfma_f32_16x16x32_bf16 v[224:227], v[216:219], a[244:247], v[224:227]
TK_28:
    ds_read_b64_tr_b16 a[236:237], v17 offset:25088
    ds_read_b64_tr_b16 a[238:239], v17 offset:25600
    v_fmac_f32 v157, v152, v152
    v_fmac_f32 v158, v153, v153
    v_fmac_f32 v157, v154, v154
    v_fmac_f32 v158, v155, v155
    v_add_f32 v157, v157, v158
    v_mfma_f32_32x32x16_bf16 v[80:95], a[248:251], a[68:71], v[80:95]
    ds_read_b64_tr_b16 a[240:241], v16 offset:18944
    ds_read_b64_tr_b16 a[242:243], v16 offset:19456
    s_add_u32 m0, s3, 82432
    s_nop 0
    buffer_load_dwordx4 v5, s[24:27], s4 offen offset:1024 lds
    v_add_f32_dpp v157, v157, v157 row_ror:8 row_mask:0xf bank_mask:0xf
    v_mfma_f32_32x32x16_bf16 v[96:111], a[252:255], a[68:71], v[96:111]
    ds_read_b64_tr_b16 a[244:245], v16 offset:27136
    ds_read_b64_tr_b16 a[246:247], v16 offset:27648
    v_add_f32_dpp v157, v157, v157 row_ror:4 row_mask:0xf bank_mask:0xf
    s_waitcnt lgkmcnt(4)
    v_mfma_f32_32x32x16_bf16 v[48:63], a[224:227], a[72:75], v[48:63]
    ds_read_b64_tr_b16 a[248:249], v17 offset:18944
    ds_read_b64_tr_b16 a[250:251], v17 offset:19456
    s_waitcnt vmcnt(14)
    ds_read_b128 a[80:83], v12 offset:8192
    buffer_load_dwordx4 v6, s[24:27], s4 offen offset:2048 lds
    v_add_f32_dpp v157, v157, v157 row_ror:2 row_mask:0xf bank_mask:0xf
    v_mfma_f32_32x32x16_bf16 v[64:79], a[228:231], a[72:75], v[64:79]
    s_bitcmp0_b32 s64, 1
    s_cbranch_scc0 TK_29
    v_mfma_f32_16x16x32_bf16 v[220:223], v[216:219], a[224:227], v[220:223]
    v_mfma_f32_16x16x32_bf16 v[224:227], v[216:219], a[228:231], v[224:227]
TK_29:
    ds_read_b64_tr_b16 a[252:253], v17 offset:27136
    ds_read_b64_tr_b16 a[254:255], v17 offset:27648
    ds_read_b128 a[84:87], v13 offset:8192
    v_add_f32_dpp v157, v157, v157 row_ror:1 row_mask:0xf bank_mask:0xf
    v_mov_b32 v158, v157
    v_mfma_f32_32x32x16_bf16 v[80:95], a[232:235], a[72:75], v[80:95]
    ds_read_b128 a[88:91], v14 offset:8192
    s_add_u32 m0, s3, 82432
    s_nop 0
    buffer_load_dwordx4 v7, s[24:27], s4 offen offset:3072 lds
    v_permlane16_swap_b32 v157, v158
    v_add_f32 v157, v157, v158
    v_mul_f32 v157, 0x3acccccd, v157
    v_cvt_pk_bf16_f32 v160, -v156, -v156
    v_cvt_pk_bf16_f32 v157, v157, v157
    v_mfma_f32_32x32x16_bf16 v[96:111], a[236:239], a[72:75], v[96:111]
    s_waitcnt lgkmcnt(2)
    s_barrier
    s_cmp_eq_u32 s64, 0
    s_cbranch_scc0 SK_30
    s_add_u32 s14, s42, 0
    buffer_store_dword v42, v29, s[32:35], s14 offen sc1
SK_30:
    ds_read_b64_tr_b16 a[224:225], v16 offset:29184
    ds_read_b64_tr_b16 a[226:227], v16 offset:29696
    ds_read_b64_tr_b16 a[228:229], v16 offset:37376
    ds_read_b64_tr_b16 a[230:231], v16 offset:37888
    ds_read_b128 a[92:95], v15 offset:8192
    v_mfma_f32_32x32x16_bf16 v[48:63], a[240:243], a[76:79], v[48:63]
    ds_read_b64_tr_b16 a[232:233], v17 offset:29184
    ds_read_b64_tr_b16 a[234:235], v17 offset:29696
    s_mul_i32 s5, s78, 64*3072
    s_add_u32 m0, s82, 12800
    s_add_u32 s5, s5, s83
    buffer_load_dwordx4 v8, s[28:31], s5 offen offset:0 lds
    v_mfma_f32_32x32x16_bf16 v[64:79], a[244:247], a[76:79], v[64:79]
    s_bitcmp1_b32 s64, 1
    s_cbranch_scc0 TK_31
    v_mfma_f32_16x16x32_bf16 v[220:223], v[216:219], a[240:243], v[220:223]
    v_mfma_f32_16x16x32_bf16 v[224:227], v[216:219], a[244:247], v[224:227]
TK_31:
    ds_read_b64_tr_b16 a[236:237], v17 offset:37376
    ds_read_b64_tr_b16 a[238:239], v17 offset:37888
    v_and_b32 v158, 31, v1
    v_lshlrev_b32 v157, 16, v157
    v_add_f32 v157, 0x3727c5ac, v157
    v_cmp_eq_u32 vcc, 0, v158
    v_cvt_pk_bf16_f32 v157, v157, v157
    v_lshrrev_b32 v156, 1, v1
    v_mfma_f32_32x32x16_bf16 v[80:95], a[248:251], a[76:79], v[80:95]
    ds_read_b64_tr_b16 a[240:241], v16 offset:31232
    ds_read_b64_tr_b16 a[242:243], v16 offset:31744
    s_add_u32 m0, s82, 12800
    s_nop 0
    buffer_load_dwordx4 v9, s[28:31], s5 offen offset:1024 lds
    v_lshlrev_b32 v157, 16, v157
    v_mfma_f32_32x32x16_bf16 v[96:111], a[252:255], a[76:79], v[96:111]
    ds_read_b64_tr_b16 a[244:245], v16 offset:39424
    ds_read_b64_tr_b16 a[246:247], v16 offset:39936
    v_sqrt_f32 v157, v157
    v_mov_b32 v158, 1073741824
    v_cvt_pk_bf16_f32 v157, v157, v157
    v_cndmask_b32 v156, v158, v156, vcc
    v_lshlrev_b32 v157, 16, v157
    v_rcp_f32 v161, v157
    s_waitcnt lgkmcnt(4)
    v_mfma_f32_32x32x16_bf16 v[48:63], a[224:227], a[80:83], v[48:63]
    ds_read_b64_tr_b16 a[248:249], v17 offset:31232
    ds_read_b64_tr_b16 a[250:251], v17 offset:31744
    buffer_load_dwordx4 v10, s[28:31], s5 offen offset:2048 lds
    v_mov_b32 v163, s22
    v_mul_f32 v162, v157, v157
    s_lshl_b32 s56, s89, 5
    s_add_u32 s56, s56, 4718592
    v_mfma_f32_32x32x16_bf16 v[64:79], a[228:231], a[80:83], v[64:79]
    s_bitcmp0_b32 s64, 1
    s_cbranch_scc0 TK_32
    v_mfma_f32_16x16x32_bf16 v[220:223], v[216:219], a[224:227], v[220:223]
    v_mfma_f32_16x16x32_bf16 v[224:227], v[216:219], a[228:231], v[224:227]
TK_32:
    ds_read_b64_tr_b16 a[252:253], v17 offset:39424
    ds_read_b64_tr_b16 a[254:255], v17 offset:39936
    buffer_store_dwordx4 v[160:163], v156, s[32:35], s56 offen sc1
    v_mov_b32 v1, s22
    v_lshlrev_b32 v234, 2, v30
    s_mul_i32 s56, s62, 278528
    s_add_u32 s56, s56, 10485760
    s_mul_i32 s57, s63, 557056
    s_add_u32 s46, s57, 5242880
    s_lshl_b32 s58, s64, 13
    v_mfma_f32_32x32x16_bf16 v[80:95], a[232:235], a[80:83], v[80:95]
    ds_read_b64_tr_b16 a[224:225], v16 offset:33280
    ds_read_b64_tr_b16 a[226:227], v16 offset:33792
    s_add_u32 m0, s82, 12800
    s_nop 0
    buffer_load_dwordx4 v11, s[28:31], s5 offen offset:3072 lds
    s_add_u32 s92, s56, s58
    s_lshl_b32 s58, s64, 12
    s_add_u32 s93, s56, s58
    s_add_u32 s93, s93, 32768
    v_mfma_f32_32x32x16_bf16 v[96:111], a[236:239], a[80:83], v[96:111]
    ds_read_b64_tr_b16 a[228:229], v16 offset:41472
    ds_read_b64_tr_b16 a[230:231], v16 offset:41984
    s_mul_i32 s58, s64, 5120
    s_add_u32 s94, s56, s58
    s_add_u32 s94, s94, 49152
    s_add_u32 s91, s94, 4096
    s_lshl_b32 s58, s64, 16
    s_add_u32 s95, s46, s58
    s_lshl_b32 s58, s64, 15
    s_add_u32 s96, s46, s58
    s_add_u32 s96, s96, 262144
    s_mul_i32 s58, s64, 40960
    s_add_u32 s97, s46, s58
    s_add_u32 s97, s97, 393216
    v_bfe_u32 v206, v2, 4, 2
    s_waitcnt lgkmcnt(4)
    v_mfma_f32_32x32x16_bf16 v[48:63], a[240:243], a[84:87], v[48:63]
    ds_read_b64_tr_b16 a[232:233], v17 offset:33280
    ds_read_b64_tr_b16 a[234:235], v17 offset:33792
    s_lshl_b32 s4, s78, 7
    s_add_u32 m0, s3, 86528
    s_add_u32 s4, s4, s81
    buffer_load_dwordx4 v4, s[24:27], s4 offen offset:0 lds
    v_mul_u32_u24 v206, 24, v206
    v_sub_u32 v206, 96, v206
    v_mfma_f32_32x32x16_bf16 v[64:79], a[244:247], a[84:87], v[64:79]
    s_bitcmp1_b32 s64, 1
    s_cbranch_scc0 TK_33
    v_mfma_f32_16x16x32_bf16 v[220:223], v[216:219], a[240:243], v[220:223]
    v_mfma_f32_16x16x32_bf16 v[224:227], v[216:219], a[244:247], v[224:227]
TK_33:
    ds_read_b64_tr_b16 a[236:237], v17 offset:41472
    ds_read_b64_tr_b16 a[238:239], v17 offset:41984
    s_and_b32 s58, s64, 1
    v_mad_u32_u24 v206, v206, s58, v244
    ds_read_b64_tr_b16 v[188:189], v244 offset:0
    ds_read_b64_tr_b16 v[190:191], v244 offset:1024
    ds_read_b64_tr_b16 v[192:193], v206 offset:8
    ds_read_b64_tr_b16 v[194:195], v206 offset:1032
    ds_read_b64_tr_b16 v[196:197], v244 offset:16
    v_mfma_f32_32x32x16_bf16 v[80:95], a[248:251], a[84:87], v[80:95]
    ds_read_b64_tr_b16 a[240:241], v16 offset:35328
    ds_read_b64_tr_b16 a[242:243], v16 offset:35840
    s_add_u32 m0, s3, 86528
    s_nop 0
    buffer_load_dwordx4 v5, s[24:27], s4 offen offset:1024 lds
    s_waitcnt lgkmcnt(13)
    ds_read_b64_tr_b16 v[198:199], v244 offset:1040
    v_mfma_f32_32x32x16_bf16 v[96:111], a[252:255], a[84:87], v[96:111]
    ds_read_b64_tr_b16 a[244:245], v16 offset:43520
    s_waitcnt lgkmcnt(13)
    ds_read_b64_tr_b16 a[246:247], v16 offset:44032
    ds_read_b64_tr_b16 v[200:201], v246
    s_waitcnt lgkmcnt(13)
    ds_read_b64_tr_b16 v[202:203], v246 offset:1024
    s_lshl_b32 s68, s62, 14
    s_add_u32 s68, s68, s46
    s_lshr_b32 s69, s62, 2
    s_lshl_b32 s69, s69, 13
    s_and_b32 s58, s62, 3
    s_lshl_b32 s58, s58, 8
    s_add_u32 s69, s69, s58
    s_waitcnt lgkmcnt(12)
    v_mfma_f32_32x32x16_bf16 v[48:63], a[224:227], a[88:91], v[48:63]
    ds_read_b64_tr_b16 a[248:249], v17 offset:35328
    ds_read_b64_tr_b16 a[250:251], v17 offset:35840
    s_waitcnt vmcnt(15)
    ds_read_b128 a[96:99], v12 offset:0
    buffer_load_dwordx4 v6, s[24:27], s4 offen offset:2048 lds
    s_add_u32 s69, s69, s46
    s_add_u32 s69, s69, 524288
    s_cmp_lt_u32 s62, 16
    s_cselect_b64 s[66:67], -1, 0
    v_mfma_f32_32x32x16_bf16 v[64:79], a[228:231], a[88:91], v[64:79]
    s_bitcmp0_b32 s64, 1
    s_cbranch_scc0 TK_34
    v_mfma_f32_16x16x32_bf16 v[220:223], v[216:219], a[224:227], v[220:223]
    v_mfma_f32_16x16x32_bf16 v[224:227], v[216:219], a[228:231], v[224:227]
TK_34:
    s_waitcnt lgkmcnt(13)
    ds_read_b64_tr_b16 a[252:253], v17 offset:43520
    ds_read_b64_tr_b16 a[254:255], v17 offset:44032
    s_waitcnt lgkmcnt(13)
    ds_read_b128 a[100:103], v13 offset:0
    v_mov_b32 v205, 1073741824
    v_cndmask_b32 v205, v205, v247, s[66:67]
    s_bitcmp0_b32 s64, 0
    s_cselect_b64 s[66:67], -1, 0
    v_mfma_f32_32x32x16_bf16 v[80:95], a[232:235], a[88:91], v[80:95]
    ds_read_b128 a[104:107], v14 offset:0
    s_add_u32 m0, s3, 86528
    s_nop 0
    buffer_load_dwordx4 v7, s[24:27], s4 offen offset:3072 lds
    v_mov_b32 v204, 1073741824
    v_cndmask_b32 v204, v204, v245, s[66:67]
    s_cmp_lt_u32 s62, 16
    s_cselect_b32 s67, s64, 9
    v_mfma_f32_32x32x16_bf16 v[96:111], a[236:239], a[88:91], v[96:111]
    s_waitcnt lgkmcnt(2)
    s_barrier
    ds_read_b64_tr_b16 a[224:225], v16 offset:45568
    ds_read_b64_tr_b16 a[226:227], v16 offset:46080
    ds_read_b64_tr_b16 a[228:229], v16 offset:53760
    ds_read_b64_tr_b16 a[230:231], v16 offset:54272
    ds_read_b128 a[108:111], v15 offset:0
    v_mfma_f32_32x32x16_bf16 v[48:63], a[240:243], a[92:95], v[48:63]
    ds_read_b64_tr_b16 a[232:233], v17 offset:45568
    ds_read_b64_tr_b16 a[234:235], v17 offset:46080
    buffer_store_dwordx4 v[188:191], v245, s[32:35], s68 offen offset:0 sc1
    v_mfma_f32_32x32x16_bf16 v[64:79], a[244:247], a[92:95], v[64:79]
    s_bitcmp1_b32 s64, 1
    s_cbranch_scc0 TK_35
    v_mfma_f32_16x16x32_bf16 v[220:223], v[216:219], a[240:243], v[220:223]
    v_mfma_f32_16x16x32_bf16 v[224:227], v[216:219], a[244:247], v[224:227]
TK_35:
    ds_read_b64_tr_b16 a[236:237], v17 offset:53760
    ds_read_b64_tr_b16 a[238:239], v17 offset:54272
    v_mov_b32 v228, 0
    s_cmp_eq_u32 s64, 0
    s_cbranch_scc0 SK_36
    s_add_u32 s15, s41, 0
    buffer_load_dword v228, v28, s[32:35], s15 offen sc1
SK_36:
    s_mul_i32 s5, s79, 64*3072
    s_add_u32 m0, s82, 29184
    s_add_u32 s5, s5, s83
    buffer_load_dwordx4 v8, s[28:31], s5 offen offset:0 lds
    v_mfma_f32_32x32x16_bf16 v[80:95], a[248:251], a[92:95], v[80:95]
    ds_read_b64_tr_b16 a[240:241], v16 offset:47616
    ds_read_b64_tr_b16 a[242:243], v16 offset:48128
    buffer_load_dwordx4 v9, s[28:31], s5 offen offset:1024 lds
    v_mfma_f32_32x32x16_bf16 v[96:111], a[252:255], a[92:95], v[96:111]
    ds_read_b64_tr_b16 a[244:245], v16 offset:55808
    ds_read_b64_tr_b16 a[246:247], v16 offset:56320
    s_waitcnt lgkmcnt(4)
    v_mfma_f32_32x32x16_bf16 v[48:63], a[224:227], a[96:99], v[48:63]
    ds_read_b64_tr_b16 a[248:249], v17 offset:47616
    ds_read_b64_tr_b16 a[250:251], v17 offset:48128
    buffer_load_dwordx4 v10, s[28:31], s5 offen offset:2048 lds
    v_mfma_f32_32x32x16_bf16 v[64:79], a[228:231], a[96:99], v[64:79]
    s_bitcmp0_b32 s64, 1
    s_cbranch_scc0 TK_37
    v_mfma_f32_16x16x32_bf16 v[220:223], v[216:219], a[224:227], v[220:223]
    v_mfma_f32_16x16x32_bf16 v[224:227], v[216:219], a[228:231], v[224:227]
TK_37:
    ds_read_b64_tr_b16 a[252:253], v17 offset:55808
    ds_read_b64_tr_b16 a[254:255], v17 offset:56320
    v_mfma_f32_32x32x16_bf16 v[80:95], a[232:235], a[96:99], v[80:95]
    ds_read_b64_tr_b16 a[224:225], v16 offset:49664
    ds_read_b64_tr_b16 a[226:227], v16 offset:50176
    s_add_u32 m0, s82, 29184
    s_nop 0
    buffer_load_dwordx4 v11, s[28:31], s5 offen offset:3072 lds
    v_and_b32 v11, 0x200, v20
    v_lshrrev_b32 v10, 1, v11
    v_add_u32 v8, v20, v10
    v_lshrrev_b32 v10, 6, v11
    v_mfma_f32_32x32x16_bf16 v[96:111], a[236:239], a[96:99], v[96:111]
    ds_read_b64_tr_b16 a[228:229], v16 offset:57856
    ds_read_b64_tr_b16 a[230:231], v16 offset:58368
    v_sub_u32 v9, v20, v11
    v_add_u32 v9, v9, v10
    v_and_b32 v10, 0xf0, v2
    v_mul_u32_u24 v10, 80, v10
    v_lshrrev_b32 v11, 8, v2
    v_lshl_add_u32 v10, v11, 5, v10
    v_add_u32 v11, 4096, v2
    s_waitcnt lgkmcnt(4)
    v_mfma_f32_32x32x16_bf16 v[48:63], a[240:243], a[100:103], v[48:63]
    ds_read_b64_tr_b16 a[232:233], v17 offset:49664
    ds_read_b64_tr_b16 a[234:235], v17 offset:50176
    buffer_store_dwordx4 v[192:195], v245, s[32:35], s68 offen offset:1024 sc1
    s_lshl_b32 s56, s61, 10
    s_add_u32 s56, s56, s48
    s_add_u32 s53, s56, 32768
    s_mul_i32 s56, s61, 1280
    s_add_u32 s56, s56, s48
    s_add_u32 s54, s56, 49152
    v_mfma_f32_32x32x16_bf16 v[64:79], a[244:247], a[100:103], v[64:79]
    s_bitcmp1_b32 s64, 1
    s_cbranch_scc0 TK_38
    v_mfma_f32_16x16x32_bf16 v[220:223], v[216:219], a[240:243], v[220:223]
    v_mfma_f32_16x16x32_bf16 v[224:227], v[216:219], a[244:247], v[224:227]
TK_38:
    ds_read_b64_tr_b16 a[236:237], v17 offset:57856
    ds_read_b64_tr_b16 a[238:239], v17 offset:58368
    buffer_load_dwordx4 v[32:35], v234, s[32:35], s47 offen sc1
    v_mfma_f32_32x32x16_bf16 v[80:95], a[248:251], a[100:103], v[80:95]
    ds_read_b64_tr_b16 a[240:241], v16 offset:51712
    ds_read_b64_tr_b16 a[242:243], v16 offset:52224
    s_lshl_b32 s4, s79, 7
    s_add_u32 m0, s3, 78336
    s_add_u32 s4, s4, s81
    buffer_load_dwordx4 v4, s[24:27], s4 offen offset:0 lds
    v_mfma_f32_32x32x16_bf16 v[96:111], a[252:255], a[100:103], v[96:111]
    ds_read_b64_tr_b16 a[244:245], v16 offset:59904
    ds_read_b64_tr_b16 a[246:247], v16 offset:60416
    s_waitcnt lgkmcnt(4)
    v_mfma_f32_32x32x16_bf16 v[48:63], a[224:227], a[104:107], v[48:63]
    ds_read_b64_tr_b16 a[248:249], v17 offset:51712
    ds_read_b64_tr_b16 a[250:251], v17 offset:52224
    s_waitcnt vmcnt(17)
    ds_read_b128 a[112:115], v12 offset:4096
    buffer_load_dwordx4 v5, s[24:27], s4 offen offset:1024 lds
    v_mfma_f32_32x32x16_bf16 v[64:79], a[228:231], a[104:107], v[64:79]
    s_bitcmp0_b32 s64, 1
    s_cbranch_scc0 TK_39
    v_mfma_f32_16x16x32_bf16 v[220:223], v[216:219], a[224:227], v[220:223]
    v_mfma_f32_16x16x32_bf16 v[224:227], v[216:219], a[228:231], v[224:227]
TK_39:
    ds_read_b64_tr_b16 a[252:253], v17 offset:59904
    ds_read_b64_tr_b16 a[254:255], v17 offset:60416
    ds_read_b128 a[116:119], v13 offset:4096
    v_mfma_f32_32x32x16_bf16 v[80:95], a[232:235], a[104:107], v[80:95]
    ds_read_b128 a[120:123], v14 offset:4096
    s_add_u32 m0, s3, 78336
    s_nop 0
    buffer_load_dwordx4 v6, s[24:27], s4 offen offset:2048 lds
    v_mfma_f32_32x32x16_bf16 v[96:111], a[236:239], a[104:107], v[96:111]
    s_waitcnt lgkmcnt(2)
    s_waitcnt vmcnt(9)
    v_cmp_ne_u32 s[100:101], s23, v228
    s_nop 0
    s_cmp_lg_u64 s[100:101], 0
    s_cbranch_scc1 M_slow_s0
M_back_s0:
    s_barrier
    ds_read_b64_tr_b16 a[224:225], v16 offset:61952
    ds_read_b64_tr_b16 a[226:227], v16 offset:62464
    ds_read_b64_tr_b16 a[228:229], v18 offset:4608
    ds_read_b64_tr_b16 a[230:231], v18 offset:5120
    ds_read_b128 a[124:127], v15 offset:4096
    v_mfma_f32_32x32x16_bf16 v[48:63], a[240:243], a[108:111], v[48:63]
    ds_read_b64_tr_b16 a[232:233], v17 offset:61952
    ds_read_b64_tr_b16 a[234:235], v17 offset:62464
    s_bitcmp0_b32 s64, 0
    s_cbranch_scc0 SK_40
    buffer_store_dwordx4 v[196:199], v204, s[32:35], s68 offen offset:2048 sc1
SK_40:
    s_mul_i32 s56, s61, 16*768
    v_mfma_f32_32x32x16_bf16 v[64:79], a[244:247], a[108:111], v[64:79]
    s_bitcmp1_b32 s64, 1
    s_cbranch_scc0 TK_41
    v_mfma_f32_16x16x32_bf16 v[220:223], v[216:219], a[240:243], v[220:223]
    v_mfma_f32_16x16x32_bf16 v[224:227], v[216:219], a[244:247], v[224:227]
TK_41:
    ds_read_b64_tr_b16 a[236:237], v19 offset:4608
    ds_read_b64_tr_b16 a[238:239], v19 offset:5120
    s_add_u32 m0, s3, 78336
    s_nop 0
    buffer_load_dwordx4 v7, s[24:27], s4 offen offset:3072 lds
    s_add_u32 s45, s56, 4325376
    v_mfma_f32_32x32x16_bf16 v[80:95], a[248:251], a[108:111], v[80:95]
    ds_read_b64_tr_b16 a[240:241], v16 offset:64000
    ds_read_b64_tr_b16 a[242:243], v16 offset:64512
    s_mul_i32 s5, s70, 12288
    s_add_u32 m0, s37, 127488
    s_add_u32 s5, s5, s36
    buffer_load_dwordx4 v2, s[32:35], s5 offen offset:0 sc1 lds
    buffer_load_dwordx4 v[176:179], v236, s[32:35], s45 offen offset:0 sc1
    v_mfma_f32_32x32x16_bf16 v[96:111], a[252:255], a[108:111], v[96:111]
    ds_read_b64_tr_b16 a[244:245], v18 offset:6656
    ds_read_b64_tr_b16 a[246:247], v18 offset:7168
    buffer_load_dwordx4 v[180:183], v236, s[32:35], s45 offen offset:256 sc1
    buffer_load_dwordx4 v[184:187], v236, s[32:35], s45 offen offset:512 sc1
    s_waitcnt lgkmcnt(4)
    v_mfma_f32_32x32x16_bf16 v[48:63], a[224:227], a[112:115], v[48:63]
    ds_read_b64_tr_b16 a[248:249], v17 offset:64000
    ds_read_b64_tr_b16 a[250:251], v17 offset:64512
    buffer_load_dwordx4 v2, s[32:35], s5 offen offset:1024 sc1 lds
    v_mfma_f32_32x32x16_bf16 v[64:79], a[228:231], a[112:115], v[64:79]
    s_bitcmp0_b32 s64, 1
    s_cbranch_scc0 TK_42
    v_mfma_f32_16x16x32_bf16 v[220:223], v[216:219], a[224:227], v[220:223]
    v_mfma_f32_16x16x32_bf16 v[224:227], v[216:219], a[228:231], v[224:227]
TK_42:
    ds_read_b64_tr_b16 a[252:253], v19 offset:6656
    ds_read_b64_tr_b16 a[254:255], v19 offset:7168
    v_mfma_f32_32x32x16_bf16 v[80:95], a[232:235], a[112:115], v[80:95]
    ds_read_b64_tr_b16 a[224:225], v18 offset:512
    ds_read_b64_tr_b16 a[226:227], v18 offset:1024
    s_add_u32 m0, s37, 127488
    s_nop 0
    buffer_load_dwordx4 v2, s[32:35], s5 offen offset:2048 sc1 lds
    v_mfma_f32_32x32x16_bf16 v[96:111], a[236:239], a[112:115], v[96:111]
    ds_read_b64_tr_b16 a[228:229], v18 offset:8704
    ds_read_b64_tr_b16 a[230:231], v18 offset:9216
    s_waitcnt lgkmcnt(4)
    v_mfma_f32_32x32x16_bf16 v[48:63], a[240:243], a[116:119], v[48:63]
    ds_read_b64_tr_b16 a[232:233], v19 offset:512
    ds_read_b64_tr_b16 a[234:235], v19 offset:1024
    s_cmp_lt_u32 s67, 2
    s_cbranch_scc0 SK_43
    buffer_store_dwordx4 v[200:203], v205, s[32:35], s69 offen sc1
SK_43:
    v_mfma_f32_32x32x16_bf16 v[64:79], a[244:247], a[116:119], v[64:79]
    s_bitcmp1_b32 s64, 1
    s_cbranch_scc0 TK_44
    v_mfma_f32_16x16x32_bf16 v[220:223], v[216:219], a[240:243], v[220:223]
    v_mfma_f32_16x16x32_bf16 v[224:227], v[216:219], a[244:247], v[224:227]
TK_44:
    ds_read_b64_tr_b16 a[236:237], v19 offset:8704
    ds_read_b64_tr_b16 a[238:239], v19 offset:9216
    v_mfma_f32_32x32x16_bf16 v[80:95], a[248:251], a[116:119], v[80:95]
    ds_read_b64_tr_b16 a[240:241], v18 offset:2560
    ds_read_b64_tr_b16 a[242:243], v18 offset:3072
    s_mul_i32 s5, s71, 12288
    s_add_u32 m0, s37, 143872
    s_add_u32 s5, s5, s36
    buffer_load_dwordx4 v2, s[32:35], s5 offen offset:0 sc1 lds
    v_mfma_f32_32x32x16_bf16 v[96:111], a[252:255], a[116:119], v[96:111]
    ds_read_b64_tr_b16 a[244:245], v18 offset:10752
    ds_read_b64_tr_b16 a[246:247], v18 offset:11264
    s_waitcnt lgkmcnt(4)
    v_mfma_f32_32x32x16_bf16 v[48:63], a[224:227], a[120:123], v[48:63]
    ds_read_b64_tr_b16 a[248:249], v19 offset:2560
    ds_read_b64_tr_b16 a[250:251], v19 offset:3072
    ds_read_b128 a[128:131], v12 offset:8192
    buffer_load_dwordx4 v2, s[32:35], s5 offen offset:1024 sc1 lds
    v_mfma_f32_32x32x16_bf16 v[64:79], a[228:231], a[120:123], v[64:79]
    s_bitcmp0_b32 s64, 1
    s_cbranch_scc0 TK_45
    v_mfma_f32_16x16x32_bf16 v[220:223], v[216:219], a[224:227], v[220:223]
    v_mfma_f32_16x16x32_bf16 v[224:227], v[216:219], a[228:231], v[224:227]
TK_45:
    ds_read_b64_tr_b16 a[252:253], v19 offset:10752
    ds_read_b64_tr_b16 a[254:255], v19 offset:11264
    ds_read_b128 a[132:135], v13 offset:8192
    s_waitcnt vmcnt(6)
    v_permlane16_swap_b32 v176, v177
    v_permlane16_swap_b32 v178, v179
    s_waitcnt vmcnt(5)
    v_permlane16_swap_b32 v180, v181
    v_permlane16_swap_b32 v182, v183
    s_waitcnt vmcnt(4)
    v_permlane16_swap_b32 v184, v185
    v_mfma_f32_32x32x16_bf16 v[80:95], a[232:235], a[120:123], v[80:95]
    ds_read_b128 a[136:139], v14 offset:8192
    s_add_u32 m0, s37, 143872
    s_nop 0
    buffer_load_dwordx4 v2, s[32:35], s5 offen offset:2048 sc1 lds
    v_permlane16_swap_b32 v186, v187
    v_add_f32 v176, v176, v177
    v_add_f32 v178, v178, v179
    v_mfma_f32_32x32x16_bf16 v[96:111], a[236:239], a[120:123], v[96:111]
    s_waitcnt vmcnt(3)
    s_waitcnt lgkmcnt(2)
    s_barrier
    ds_read_b64_tr_b16 a[224:225], v16 offset:12800
    ds_read_b64_tr_b16 a[226:227], v16 offset:13312
    ds_read_b64_tr_b16 a[228:229], v16 offset:20992
    ds_read_b64_tr_b16 a[230:231], v16 offset:21504
    ds_read_b128 a[140:143], v15 offset:8192
    v_mfma_f32_32x32x16_bf16 v[48:63], a[240:243], a[124:127], v[48:63]
    ds_read_b64_tr_b16 a[232:233], v17 offset:12800
    ds_read_b64_tr_b16 a[234:235], v17 offset:13312
    buffer_store_dwordx4 v[208:211], v20, s[32:35], s53 offen offset:0 sc1
    v_add_f32 v180, v180, v181
    v_add_f32 v182, v182, v183
    v_add_f32 v184, v184, v185
    v_mfma_f32_32x32x16_bf16 v[64:79], a[244:247], a[124:127], v[64:79]
    s_bitcmp1_b32 s64, 1
    s_cbranch_scc0 TK_46
    v_mfma_f32_16x16x32_bf16 v[220:223], v[216:219], a[240:243], v[220:223]
    v_mfma_f32_16x16x32_bf16 v[224:227], v[216:219], a[244:247], v[224:227]
TK_46:
    ds_read_b64_tr_b16 a[236:237], v17 offset:20992
    ds_read_b64_tr_b16 a[238:239], v17 offset:21504
    v_add_f32 v186, v186, v187
    v_permlane32_swap_b32 v176, v178
    v_permlane32_swap_b32 v180, v182
    v_permlane32_swap_b32 v184, v186
    v_add_f32 v176, v176, v178
    v_add_f32 v180, v180, v182
    v_add_f32 v184, v184, v186
    v_mfma_f32_32x32x16_bf16 v[80:95], a[248:251], a[124:127], v[80:95]
    ds_read_b128 a[240:243], v3 offset:61952
    s_mul_i32 s5, s72, 12288
    s_add_u32 m0, s37, 45568
    s_add_u32 s5, s5, s36
    buffer_load_dwordx4 v2, s[32:35], s5 offen offset:0 sc1 lds
    ds_write_b32 v237, v176 offset:0
    ds_write_b32 v237, v180 offset:256
    ds_write_b32 v237, v184 offset:512
    v_mfma_f32_32x32x16_bf16 v[96:111], a[252:255], a[124:127], v[96:111]
    s_waitcnt lgkmcnt(13)
    ds_read_b128 a[244:247], v3 offset:62976
    s_waitcnt lgkmcnt(1)
    s_barrier
    ds_read_b64 v[176:177], v238 offset:7424
    ds_read_b64 v[178:179], v238 offset:8192
    ds_read_b64 v[180:181], v238 offset:8960
    ds_read_b64 v[182:183], v238 offset:9728
    s_waitcnt lgkmcnt(2)
    v_add_f32 v176, v176, v178
    v_mfma_f32_32x32x16_bf16 v[48:63], a[224:227], a[128:131], v[48:63]
    ds_read_b128 a[248:251], v3 offset:64000
    buffer_load_dwordx4 v2, s[32:35], s5 offen offset:1024 sc1 lds
    v_add_f32 v177, v177, v179
    s_waitcnt lgkmcnt(2)
    v_add_f32 v176, v176, v180
    v_add_f32 v177, v177, v181
    v_mfma_f32_32x32x16_bf16 v[64:79], a[228:231], a[128:131], v[64:79]
    s_bitcmp0_b32 s64, 1
    s_cbranch_scc0 TK_47
    v_mfma_f32_16x16x32_bf16 v[220:223], v[216:219], a[224:227], v[220:223]
    v_mfma_f32_16x16x32_bf16 v[224:227], v[216:219], a[228:231], v[224:227]
TK_47:
    ds_read_b64_tr_b16 a[252:253], v16 offset:14848
    ds_read_b64_tr_b16 a[254:255], v16 offset:15360
    s_waitcnt lgkmcnt(3)
    v_add_f32 v176, v176, v182
    v_add_f32 v177, v177, v183
    v_cvt_pk_bf16_f32 v178, v176, v177
    v_lshlrev_b32 v179, 16, v178
    v_and_b32 v180, 0xffff0000, v178
    v_mfma_f32_32x32x16_bf16 v[80:95], a[232:235], a[128:131], v[80:95]
    ds_read_b64_tr_b16 a[224:225], v16 offset:23040
    ds_read_b64_tr_b16 a[226:227], v16 offset:23552
    s_add_u32 m0, s37, 45568
    s_nop 0
    buffer_load_dwordx4 v2, s[32:35], s5 offen offset:2048 sc1 lds
    v_sub_f32 v176, v176, v179
    v_sub_f32 v177, v177, v180
    v_cvt_pk_bf16_f32 v176, v176, v177
    v_mfma_f32_32x32x16_bf16 v[96:111], a[236:239], a[128:131], v[96:111]
    ds_read_b64_tr_b16 a[228:229], v17 offset:14848
    ds_read_b64_tr_b16 a[230:231], v17 offset:15360
    v_and_b32 v177, 0xffff0000, v176
    v_lshrrev_b32 v180, 16, v180
    v_or_b32 v177, v177, v180
    v_and_b32 v178, 0xffff, v178
    v_lshl_or_b32 v176, v176, 16, v178
    ds_write_b64 v238, v[176:177] offset:3072
    s_waitcnt lgkmcnt(5)
    v_mfma_f32_32x32x16_bf16 v[112:127], a[240:243], a[0:3], 0
    ds_read_b64_tr_b16 a[232:233], v17 offset:23040
    ds_read_b64_tr_b16 a[234:235], v17 offset:23552
    buffer_store_dwordx4 v[208:211], v20, s[32:35], s53 offen offset:256 sc1
    v_mfma_f32_32x32x16_bf16 v[128:143], a[244:247], a[0:3], 0
    ds_read_b128 a[236:239], v3 offset:65024
    v_mfma_f32_32x32x16_bf16 v[144:159], a[248:251], a[0:3], 0
    ds_read_b128 a[240:243], v47 offset:512
    s_mul_i32 s5, s73, 12288
    s_add_u32 m0, s37, 61952
    s_add_u32 s5, s5, s36
    buffer_load_dwordx4 v2, s[32:35], s5 offen offset:0 sc1 lds
    v_mfma_f32_32x32x16_bf16 v[48:63], a[252:255], a[132:135], v[48:63]
    ds_read_b128 a[244:247], v47 offset:1536
    s_waitcnt lgkmcnt(2)
    v_mfma_f32_32x32x16_bf16 v[64:79], a[224:227], a[132:135], v[64:79]
    s_bitcmp1_b32 s64, 1
    s_cbranch_scc0 TK_48
    v_mfma_f32_16x16x32_bf16 v[220:223], v[216:219], a[252:255], v[220:223]
    v_mfma_f32_16x16x32_bf16 v[224:227], v[216:219], a[224:227], v[224:227]
TK_48:
    ds_read_b64_tr_b16 a[248:249], v16 offset:16896
    ds_read_b64_tr_b16 a[250:251], v16 offset:17408
    s_add_u32 m0, s37, 61952
    s_nop 0
    buffer_load_dwordx4 v2, s[32:35], s5 offen offset:1024 sc1 lds
    v_mfma_f32_32x32x16_bf16 v[80:95], a[228:231], a[132:135], v[80:95]
    ds_read_b64_tr_b16 a[252:253], v16 offset:25088
    ds_read_b64_tr_b16 a[254:255], v16 offset:25600
    v_mfma_f32_32x32x16_bf16 v[96:111], a[232:235], a[132:135], v[96:111]
    ds_read_b64_tr_b16 a[224:225], v17 offset:16896
    ds_read_b64_tr_b16 a[226:227], v17 offset:17408
    buffer_load_dwordx4 v2, s[32:35], s5 offen offset:2048 sc1 lds
    v_mfma_f32_32x32x16_bf16 v[112:127], a[236:239], a[4:7], v[112:127]
    ds_read_b64_tr_b16 a[228:229], v17 offset:25088
    ds_read_b64_tr_b16 a[230:231], v17 offset:25600
    s_waitcnt lgkmcnt(4)
    v_mfma_f32_32x32x16_bf16 v[128:143], a[240:243], a[4:7], v[128:143]
    ds_read_b128 a[232:235], v47 offset:2560
    v_mfma_f32_32x32x16_bf16 v[144:159], a[244:247], a[4:7], v[144:159]
    ds_read_b128 a[236:239], v47 offset:3584
    v_mfma_f32_32x32x16_bf16 v[48:63], a[248:251], a[136:139], v[48:63]
    ds_read_b128 a[240:243], v47 offset:4608
    ds_read_b128 a[144:147], v12 offset:0
    v_mfma_f32_32x32x16_bf16 v[64:79], a[252:255], a[136:139], v[64:79]
    s_bitcmp0_b32 s64, 1
    s_cbranch_scc0 TK_49
    v_mfma_f32_16x16x32_bf16 v[220:223], v[216:219], a[248:251], v[220:223]
    v_mfma_f32_16x16x32_bf16 v[224:227], v[216:219], a[252:255], v[224:227]
TK_49:
    ds_read_b64_tr_b16 a[244:245], v16 offset:18944
    ds_read_b64_tr_b16 a[246:247], v16 offset:19456
    ds_read_b128 a[148:151], v13 offset:0
    s_waitcnt lgkmcnt(5)
    v_mfma_f32_32x32x16_bf16 v[80:95], a[224:227], a[136:139], v[80:95]
    ds_read_b64_tr_b16 a[248:249], v16 offset:27136
    ds_read_b64_tr_b16 a[250:251], v16 offset:27648
    ds_read_b128 a[152:155], v14 offset:0
    buffer_store_dwordx4 v[208:211], v8, s[32:35], s54 offen offset:0 sc1
    v_mfma_f32_32x32x16_bf16 v[96:111], a[228:231], a[136:139], v[96:111]
    ds_read_b64_tr_b16 a[252:253], v17 offset:18944
    ds_read_b64_tr_b16 a[254:255], v17 offset:19456
    ds_read_b128 a[156:159], v15 offset:0
    v_mfma_f32_32x32x16_bf16 v[112:127], a[232:235], a[8:11], v[112:127]
    ds_read_b64_tr_b16 a[224:225], v17 offset:27136
    ds_read_b64_tr_b16 a[226:227], v17 offset:27648
    v_mfma_f32_32x32x16_bf16 v[128:143], a[236:239], a[8:11], v[128:143]
    ds_read_b128 a[228:231], v47 offset:5632
    s_waitcnt lgkmcnt(4)
    v_mfma_f32_32x32x16_bf16 v[144:159], a[240:243], a[8:11], v[144:159]
    ds_read_b128 a[232:235], v47 offset:6656
    v_mfma_f32_32x32x16_bf16 v[48:63], a[244:247], a[140:143], v[48:63]
    ds_read_b128 a[236:239], v47 offset:7680
    v_mfma_f32_32x32x16_bf16 v[64:79], a[248:251], a[140:143], v[64:79]
    s_bitcmp1_b32 s64, 1
    s_cbranch_scc0 TK_50
    v_mfma_f32_16x16x32_bf16 v[220:223], v[216:219], a[244:247], v[220:223]
    v_mfma_f32_16x16x32_bf16 v[224:227], v[216:219], a[248:251], v[224:227]
TK_50:
    v_mfma_f32_32x32x16_bf16 v[80:95], a[252:255], a[140:143], v[80:95]
    s_waitcnt vmcnt(9)
    s_waitcnt lgkmcnt(0)
    s_barrier
    s_cmp_eq_u32 s64, 0
    s_cbranch_scc0 SK_51
    s_lshl_b32 s14, s63, 8
    s_lshl2_add_u32 s14, s62, s14
    s_add_u32 s14, s14, 20979712
    buffer_store_dword v1, v29, s[32:35], s14 offen sc1
SK_51:
    ds_read_b64_tr_b16 a[240:241], v16 offset:29184
    ds_read_b64_tr_b16 a[242:243], v16 offset:29696
    ds_read_b64_tr_b16 a[244:245], v16 offset:37376
    ds_read_b64_tr_b16 a[246:247], v16 offset:37888
    v_mfma_f32_32x32x16_bf16 v[96:111], a[224:227], a[140:143], v[96:111]
    ds_read_b64_tr_b16 a[248:249], v17 offset:29184
    ds_read_b64_tr_b16 a[250:251], v17 offset:29696
    s_mul_i32 s5, s74, 12288
    s_add_u32 m0, s37, 127488
    s_add_u32 s5, s5, s36
    buffer_load_dwordx4 v2, s[32:35], s5 offen offset:0 sc1 lds
    v_mfma_f32_32x32x16_bf16 v[112:127], a[228:231], a[12:15], v[112:127]
    ds_read_b64_tr_b16 a[252:253], v17 offset:37376
    ds_read_b64_tr_b16 a[254:255], v17 offset:37888
    v_mfma_f32_32x32x16_bf16 v[128:143], a[232:235], a[12:15], v[128:143]
    ds_read_b128 a[224:227], v47 offset:12800
    buffer_load_dwordx4 v2, s[32:35], s5 offen offset:1024 sc1 lds
    v_mfma_f32_32x32x16_bf16 v[144:159], a[236:239], a[12:15], v[144:159]
    ds_read_b128 a[228:231], v47 offset:13824
    s_waitcnt lgkmcnt(2)
    v_mfma_f32_32x32x16_bf16 v[48:63], a[240:243], a[144:147], v[48:63]
    ds_read_b128 a[232:235], v47 offset:14848
    buffer_store_dwordx4 v[208:211], v8, s[32:35], s54 offen offset:256 sc1
    v_mfma_f32_32x32x16_bf16 v[64:79], a[244:247], a[144:147], v[64:79]
    s_bitcmp0_b32 s64, 1
    s_cbranch_scc0 TK_52
    v_mfma_f32_16x16x32_bf16 v[220:223], v[216:219], a[240:243], v[220:223]
    v_mfma_f32_16x16x32_bf16 v[224:227], v[216:219], a[244:247], v[224:227]
TK_52:
    ds_read_b64_tr_b16 a[236:237], v16 offset:31232
    ds_read_b64_tr_b16 a[238:239], v16 offset:31744
    v_mfma_f32_32x32x16_bf16 v[80:95], a[248:251], a[144:147], v[80:95]
    ds_read_b64_tr_b16 a[240:241], v16 offset:39424
    ds_read_b64_tr_b16 a[242:243], v16 offset:39936
    s_add_u32 m0, s37, 127488
    s_nop 0
    buffer_load_dwordx4 v2, s[32:35], s5 offen offset:2048 sc1 lds
    v_mfma_f32_32x32x16_bf16 v[96:111], a[252:255], a[144:147], v[96:111]
    ds_read_b64_tr_b16 a[244:245], v17 offset:31232
    ds_read_b64_tr_b16 a[246:247], v17 offset:31744
    s_waitcnt lgkmcnt(4)
    v_mfma_f32_32x32x16_bf16 v[112:127], a[224:227], a[16:19], v[112:127]
    ds_read_b64_tr_b16 a[248:249], v17 offset:39424
    ds_read_b64_tr_b16 a[250:251], v17 offset:39936
    s_mul_i32 s5, s75, 12288
    s_add_u32 m0, s37, 12800
    s_add_u32 s5, s5, s36
    buffer_load_dwordx4 v2, s[32:35], s5 offen offset:0 sc1 lds
    v_mfma_f32_32x32x16_bf16 v[128:143], a[228:231], a[16:19], v[128:143]
    ds_read_b128 a[252:255], v47 offset:15872
    v_mfma_f32_32x32x16_bf16 v[144:159], a[232:235], a[16:19], v[144:159]
    ds_read_b128 a[224:227], v47 offset:16896
    buffer_load_dwordx4 v2, s[32:35], s5 offen offset:1024 sc1 lds
    v_mfma_f32_32x32x16_bf16 v[48:63], a[236:239], a[148:151], v[48:63]
    ds_read_b128 a[228:231], v47 offset:17920
    s_waitcnt lgkmcnt(2)
    v_mfma_f32_32x32x16_bf16 v[64:79], a[240:243], a[148:151], v[64:79]
    s_bitcmp1_b32 s64, 1
    s_cbranch_scc0 TK_53
    v_mfma_f32_16x16x32_bf16 v[220:223], v[216:219], a[236:239], v[220:223]
    v_mfma_f32_16x16x32_bf16 v[224:227], v[216:219], a[240:243], v[224:227]
TK_53:
    ds_read_b64_tr_b16 a[232:233], v16 offset:33280
    ds_read_b64_tr_b16 a[234:235], v16 offset:33792
    s_add_u32 m0, s37, 12800
    s_nop 0
    buffer_load_dwordx4 v2, s[32:35], s5 offen offset:2048 sc1 lds
    v_mfma_f32_32x32x16_bf16 v[80:95], a[244:247], a[148:151], v[80:95]
    ds_read_b64_tr_b16 a[236:237], v16 offset:41472
    ds_read_b64_tr_b16 a[238:239], v16 offset:41984
    v_mfma_f32_32x32x16_bf16 v[96:111], a[248:251], a[148:151], v[96:111]
    ds_read_b64_tr_b16 a[240:241], v17 offset:33280
    ds_read_b64_tr_b16 a[242:243], v17 offset:33792
    buffer_store_dwordx2 v[208:209], v9, s[32:35], s54 offen offset:512 sc1
    v_mfma_f32_32x32x16_bf16 v[112:127], a[252:255], a[20:23], v[112:127]
    ds_read_b64_tr_b16 a[244:245], v17 offset:41472
    ds_read_b64_tr_b16 a[246:247], v17 offset:41984
    s_waitcnt lgkmcnt(4)
    v_mfma_f32_32x32x16_bf16 v[128:143], a[224:227], a[20:23], v[128:143]
    ds_read_b128 a[248:251], v47 offset:18944
    v_mfma_f32_32x32x16_bf16 v[144:159], a[228:231], a[20:23], v[144:159]
    ds_read_b128 a[252:255], v47 offset:19968
    v_mfma_f32_32x32x16_bf16 v[48:63], a[232:235], a[152:155], v[48:63]
    ds_read_b128 a[224:227], v47 offset:20992
    v_mfma_f32_32x32x16_bf16 v[64:79], a[236:239], a[152:155], v[64:79]
    s_bitcmp0_b32 s64, 1
    s_cbranch_scc0 TK_54
    v_mfma_f32_16x16x32_bf16 v[220:223], v[216:219], a[232:235], v[220:223]
    v_mfma_f32_16x16x32_bf16 v[224:227], v[216:219], a[236:239], v[224:227]
TK_54:
    ds_read_b64_tr_b16 a[228:229], v16 offset:35328
    ds_read_b64_tr_b16 a[230:231], v16 offset:35840
    s_waitcnt lgkmcnt(3)
    v_mfma_f32_32x32x16_bf16 v[80:95], a[240:243], a[152:155], v[80:95]
    ds_read_b64_tr_b16 a[232:233], v16 offset:43520
    ds_read_b64_tr_b16 a[234:235], v16 offset:44032
    v_mfma_f32_32x32x16_bf16 v[96:111], a[244:247], a[152:155], v[96:111]
    ds_read_b64_tr_b16 a[236:237], v17 offset:35328
    ds_read_b64_tr_b16 a[238:239], v17 offset:35840
    v_mfma_f32_32x32x16_bf16 v[112:127], a[248:251], a[24:27], v[112:127]
    ds_read_b64_tr_b16 a[240:241], v17 offset:43520
    ds_read_b64_tr_b16 a[242:243], v17 offset:44032
    v_mfma_f32_32x32x16_bf16 v[128:143], a[252:255], a[24:27], v[128:143]
    ds_read_b128 a[244:247], v47 offset:22016
    s_waitcnt lgkmcnt(3)
    v_mfma_f32_32x32x16_bf16 v[144:159], a[224:227], a[24:27], v[144:159]
    ds_read_b128 a[248:251], v47 offset:23040
    v_mfma_f32_32x32x16_bf16 v[48:63], a[228:231], a[156:159], v[48:63]
    ds_read_b128 a[252:255], v47 offset:24064
    s_add_u32 s100, s98, 24576
    s_addc_u32 s101, s99, 0
    global_load_dwordx4 v[16:19], v235, s[100:101]
    s_add_u32 s100, s98, 20480
    s_addc_u32 s101, s99, 0
    global_load_dwordx4 v[4:7], v235, s[100:101]
    s_add_u32 s100, s98, 16384
    s_addc_u32 s101, s99, 0
    global_load_dwordx4 v[24:27], v235, s[100:101]
    v_mfma_f32_32x32x16_bf16 v[64:79], a[232:235], a[156:159], v[64:79]
    s_bitcmp1_b32 s64, 1
    s_cbranch_scc0 TK_55
    v_mfma_f32_16x16x32_bf16 v[220:223], v[216:219], a[228:231], v[220:223]
    v_mfma_f32_16x16x32_bf16 v[224:227], v[216:219], a[232:235], v[224:227]
TK_55:
    v_mfma_f32_32x32x16_bf16 v[80:95], a[236:239], a[156:159], v[80:95]
    s_waitcnt vmcnt(12)
    s_waitcnt lgkmcnt(0)
    s_barrier
    ds_read_b128 a[224:227], v2 offset:45568
    ds_read_b128 a[228:231], v2 offset:46592
    s_mul_i32 s5, s76, 12288
    s_add_u32 m0, s37, 143872
    s_add_u32 s5, s5, s36
    buffer_load_dwordx4 v2, s[32:35], s5 offen offset:0 sc1 lds
    v_mfma_f32_32x32x16_bf16 v[96:111], a[240:243], a[156:159], v[96:111]
    ds_read_b128 a[232:235], v2 offset:47616
    v_and_b32 v228, 0x100, v2
    s_lshl_b32 s56, s64, 8
    v_cmp_eq_u32 vcc, 0, v228
    v_mfma_f32_32x32x16_bf16 v[112:127], a[244:247], a[28:31], v[112:127]
    ds_read_b128 a[236:239], v2 offset:48640
    buffer_load_dwordx4 v2, s[32:35], s5 offen offset:1024 sc1 lds
    v_add_u32 v229, s56, v30
    s_and_b32 s56, s56, 256
    v_add_u32 v230, s56, v30
    v_mfma_f32_32x32x16_bf16 v[128:143], a[248:251], a[28:31], v[128:143]
    ds_read_b128 a[240:243], v2 offset:49664
    v_cndmask_b32 v220, v221, v220, vcc
    v_cndmask_b32 v224, v225, v224, vcc
    v_xor_b32 v231, 256, v230
    ds_write_b32 v229, v220 offset:10496
    ds_write_b32 v229, v224 offset:10624
    buffer_load_dwordx4 v2, s[32:35], s5 offen offset:2048 sc1 lds
    v_mfma_f32_32x32x16_bf16 v[144:159], a[252:255], a[28:31], v[144:159]
    ds_read_b128 a[244:247], v2 offset:50688
    s_waitcnt lgkmcnt(4)
    v_mfma_f32_32x32x16_bf16 v[112:127], a[224:227], a[32:35], v[112:127]
    ds_read_b128 a[248:251], v2 offset:51712
    s_waitcnt lgkmcnt(2)
    s_barrier
    v_mov_b32 v233, 0
    s_cmp_eq_u32 s64, 0
    s_cbranch_scc0 SK_56
    s_lshl_b32 s9, s63, 8
    s_add_u32 s9, s9, 20979712
    buffer_load_dword v233, v31, s[32:35], s9 offen sc1
SK_56:
    v_mfma_f32_32x32x16_bf16 v[128:143], a[228:231], a[32:35], v[128:143]
    ds_read_b128 a[252:255], v2 offset:52736
    s_mul_i32 s5, s77, 12288
    s_add_u32 m0, s37, 29184
    s_add_u32 s5, s5, s36
    buffer_load_dwordx4 v2, s[32:35], s5 offen offset:0 sc1 lds
    v_mfma_f32_32x32x16_bf16 v[144:159], a[232:235], a[32:35], v[144:159]
    ds_read_b128 a[224:227], v2 offset:53760
    v_add_u32 v230, 10496, v230
    v_add_u32 v231, 10496, v231
    ds_read2_b32 v[212:213], v230 offset0:0 offset1:128
    ds_read2_b32 v[214:215], v230 offset0:32 offset1:160
    v_mfma_f32_32x32x16_bf16 v[112:127], a[236:239], a[36:39], v[112:127]
    ds_read_b128 a[228:231], v2 offset:54784
    buffer_load_dwordx4 v2, s[32:35], s5 offen offset:1024 sc1 lds
    ds_read2_b32 v[220:221], v231 offset0:0 offset1:128
    ds_read2_b32 v[222:223], v231 offset0:32 offset1:160
    s_waitcnt lgkmcnt(4)
    v_add_f32 v212, v212, v213
    v_mfma_f32_32x32x16_bf16 v[128:143], a[240:243], a[36:39], v[128:143]
    ds_read_b128 a[232:235], v2 offset:55808
    s_waitcnt lgkmcnt(4)
    v_add_f32 v213, v214, v215
    v_cvt_pk_bf16_f32 v214, v212, v213
    v_lshlrev_b32 v215, 16, v214
    v_mfma_f32_32x32x16_bf16 v[144:159], a[244:247], a[36:39], v[144:159]
    ds_read_b128 a[236:239], v2 offset:56832
    buffer_load_dwordx4 v2, s[32:35], s5 offen offset:2048 sc1 lds
    v_and_b32 v216, 0xffff0000, v214
    v_sub_f32 v212, v212, v215
    v_mfma_f32_32x32x16_bf16 v[112:127], a[248:251], a[40:43], v[112:127]
    ds_read_b128 a[240:243], v2 offset:61952
    v_sub_f32 v213, v213, v216
    v_cvt_pk_bf16_f32 v212, v212, v213
    v_and_b32 v213, 0xffff0000, v212
    v_lshrrev_b32 v216, 16, v216
    v_or_b32 v213, v213, v216
    v_mfma_f32_32x32x16_bf16 v[128:143], a[252:255], a[40:43], v[128:143]
    ds_read_b128 a[244:247], v2 offset:62976
    v_and_b32 v214, 0xffff, v214
    v_lshl_or_b32 v212, v212, 16, v214
    s_waitcnt lgkmcnt(5)
    v_add_f32 v220, v220, v221
    s_waitcnt lgkmcnt(4)
    v_add_f32 v221, v222, v223
    s_waitcnt lgkmcnt(2)
    v_mfma_f32_32x32x16_bf16 v[144:159], a[224:227], a[40:43], v[144:159]
    ds_read_b128 a[248:251], v2 offset:64000
    v_cvt_pk_bf16_f32 v222, v220, v221
    v_lshlrev_b32 v223, 16, v222
    v_and_b32 v224, 0xffff0000, v222
    v_sub_f32 v220, v220, v223
    v_sub_f32 v221, v221, v224
    v_mfma_f32_32x32x16_bf16 v[112:127], a[228:231], a[44:47], v[112:127]
    ds_read_b128 a[252:255], v2 offset:65024
    v_cvt_pk_bf16_f32 v220, v220, v221
    v_and_b32 v221, 0xffff0000, v220
    v_lshrrev_b32 v224, 16, v224
    v_or_b32 v221, v221, v224
    v_and_b32 v222, 0xffff, v222
    v_mfma_f32_32x32x16_bf16 v[128:143], a[232:235], a[44:47], v[128:143]
    ds_read_b128 a[224:227], v3 offset:512
    v_lshl_or_b32 v220, v220, 16, v222
    v_cmp_ne_u32 s[100:101], s22, v35
    s_nop 0
    s_cmp_lg_u64 s[100:101], 0
    s_cbranch_scc1 M_slow_st
M_back_st:
    s_mov_b32 s66, -1
    s_mov_b32 s67, 0
    v_mfma_f32_32x32x16_bf16 v[144:159], a[236:239], a[44:47], v[144:159]
    ds_read_b128 a[228:231], v3 offset:1536
    v_mov_b32 v36, v33
    v_mov_b32 v37, v34
    v_mul_f32 v38, 1069066811, v33
    v_mul_f32 v39, 3216550459, v33
    v_cndmask_b32 v32, 0, v32, s[66:67]
    s_waitcnt lgkmcnt(2)
    v_mfma_f32_32x32x16_bf16 v[112:127], a[240:243], a[48:51], v[112:127]
    ds_read_b128 a[232:235], v3 offset:2560
    v_mov_b32 v33, 0
    v_mov_b32 v34, 0
    v_mov_b32 v35, 0
    v_mov_b32 v42, v212
    v_mov_b32 v44, v213
    v_mfma_f32_32x32x16_bf16 v[128:143], a[244:247], a[48:51], v[128:143]
    ds_read_b128 a[236:239], v3 offset:3584
    v_mfma_f32_32x32x16_bf16 v[48:63], v[42:45], v[32:35], v[48:63]
    v_mfma_f32_32x32x16_bf16 v[64:79], v[44:47], v[32:35], v[64:79]
    v_mov_b32 v42, v220
    v_mov_b32 v44, v221
    v_mfma_f32_32x32x16_bf16 v[144:159], a[248:251], a[48:51], v[144:159]
    ds_read_b128 a[240:243], v3 offset:4608
    v_mfma_f32_32x32x16_bf16 v[80:95], v[42:45], v[32:35], v[80:95]
    v_mfma_f32_32x32x16_bf16 v[96:111], v[44:47], v[32:35], v[96:111]
    ds_read_b32 v42, v30 offset:3072
    ds_read_b32 v44, v30 offset:3200
    s_waitcnt lgkmcnt(0)
    v_mfma_f32_32x32x16_bf16 v[112:127], v[42:45], v[32:35], v[112:127]
    ds_read_b32 v42, v30 offset:3328
    v_mfma_f32_32x32x16_bf16 v[128:143], v[44:47], v[32:35], v[128:143]
    s_waitcnt lgkmcnt(0)
    v_mfma_f32_32x32x16_bf16 v[144:159], v[42:45], v[32:35], v[144:159]
    v_mul_f32 v228, v39, v48
    v_mul_f32 v229, v39, v49
    v_exp_f32 v228, v228
    v_mul_f32 v48, v48, v64
    v_exp_f32 v229, v229
    v_mul_f32 v49, v49, v65
    v_mfma_f32_32x32x16_bf16 v[112:127], a[252:255], a[52:55], v[112:127]
    ds_read_b128 a[244:247], v3 offset:5632
    v_fma_f32 v228, v228, v37, v37
    v_fma_f32 v229, v229, v37, v37
    v_rcp_f32 v228, v228
    v_mfma_f32_32x32x16_bf16 v[128:143], a[224:227], a[52:55], v[128:143]
    ds_read_b128 a[248:251], v3 offset:6656
    v_rcp_f32 v229, v229
    v_mul_f32 v48, v48, v228
    v_mul_f32 v49, v49, v229
    v_mul_f32 v230, v39, v50
    v_mul_f32 v231, v39, v51
    v_mfma_f32_32x32x16_bf16 v[144:159], a[228:231], a[52:55], v[144:159]
    ds_read_b128 a[252:255], v3 offset:7680
    v_exp_f32 v230, v230
    v_mul_f32 v50, v50, v66
    v_exp_f32 v231, v231
    v_mul_f32 v51, v51, v67
    v_mfma_f32_32x32x16_bf16 v[112:127], a[232:235], a[56:59], v[112:127]
    v_fma_f32 v230, v230, v37, v37
    v_fma_f32 v231, v231, v37, v37
    v_rcp_f32 v230, v230
    v_rcp_f32 v231, v231
    v_mfma_f32_32x32x16_bf16 v[128:143], a[236:239], a[56:59], v[128:143]
    s_waitcnt vmcnt(10)
    s_waitcnt lgkmcnt(0)
    s_waitcnt vmcnt(3)
    v_cmp_ne_u32 s[100:101], s23, v233
    s_nop 0
    s_cmp_lg_u64 s[100:101], 0
    s_cbranch_scc1 M_slow_s0b
M_back_s0b:
    s_barrier
    ds_read_b128 a[224:227], v3 offset:61952
    ds_read_b128 a[228:231], v3 offset:62976
    s_mul_i32 s5, s78, 12288
    s_add_u32 m0, s37, 61952
    s_add_u32 s5, s5, s36
    buffer_load_dwordx4 v2, s[32:35], s5 offen offset:0 sc1 lds
    v_mfma_f32_32x32x16_bf16 v[144:159], a[240:243], a[56:59], v[144:159]
    ds_read_b128 a[232:235], v3 offset:64000
    buffer_load_dwordx4 v2, s[32:35], s5 offen offset:1024 sc1 lds
    v_mfma_f32_32x32x16_bf16 v[112:127], a[244:247], a[60:63], v[112:127]
    ds_read_b128 a[236:239], v3 offset:65024
    buffer_load_dwordx4 v2, s[32:35], s5 offen offset:2048 sc1 lds
    v_cvt_pk_bf16_f32 v212, v48, v49
    v_mfma_f32_32x32x16_bf16 v[128:143], a[248:251], a[60:63], v[128:143]
    ds_read_b128 a[240:243], v47 offset:512
    s_mul_i32 s5, s79, 12288
    s_add_u32 m0, s37, 45568
    s_add_u32 s5, s5, s36
    buffer_load_dwordx4 v2, s[32:35], s5 offen offset:0 sc1 lds
    v_mul_f32 v50, v50, v230
    v_mfma_f32_32x32x16_bf16 v[144:159], a[252:255], a[60:63], v[144:159]
    ds_read_b128 a[244:247], v47 offset:1536
    v_mul_f32 v51, v51, v231
    v_mul_f32 v228, v39, v52
    v_mul_f32 v229, v39, v53
    v_exp_f32 v228, v228
    s_waitcnt lgkmcnt(2)
    v_mfma_f32_32x32x16_bf16 v[112:127], a[224:227], a[64:67], v[112:127]
    ds_read_b128 a[248:251], v47 offset:2560
    v_mul_f32 v52, v52, v68
    v_exp_f32 v229, v229
    v_mul_f32 v53, v53, v69
    v_fma_f32 v228, v228, v37, v37
    v_mfma_f32_32x32x16_bf16 v[128:143], a[228:231], a[64:67], v[128:143]
    ds_read_b128 a[252:255], v47 offset:3584
    v_fma_f32 v229, v229, v37, v37
    v_rcp_f32 v228, v228
    buffer_load_dwordx4 v2, s[32:35], s5 offen offset:1024 sc1 lds
    v_mfma_f32_32x32x16_bf16 v[144:159], a[232:235], a[64:67], v[144:159]
    ds_read_b128 a[224:227], v47 offset:4608
    buffer_load_dwordx4 v2, s[32:35], s5 offen offset:2048 sc1 lds
    v_rcp_f32 v229, v229
    v_mfma_f32_32x32x16_bf16 v[112:127], a[236:239], a[68:71], v[112:127]
    ds_read_b128 a[228:231], v47 offset:5632
    v_cvt_pk_bf16_f32 v213, v50, v51
    v_mul_f32 v52, v52, v228
    v_mul_f32 v53, v53, v229
    v_mul_f32 v230, v39, v54
    s_bfe_u32 s12, 1, s55
    s_lshl_b32 s12, s12, 13
    s_add_u32 s7, s12, s95
    buffer_load_dwordx4 a[160:163], v2, s[32:35], s7 offen offset:0 sc1
    s_waitcnt lgkmcnt(2)
    v_mfma_f32_32x32x16_bf16 v[128:143], a[240:243], a[68:71], v[128:143]
    ds_read_b128 a[232:235], v47 offset:6656
    v_mul_f32 v231, v39, v55
    v_mfma_f32_32x32x16_bf16 v[144:159], a[244:247], a[68:71], v[144:159]
    ds_read_b128 a[236:239], v47 offset:7680
    buffer_load_dwordx4 a[164:167], v2, s[32:35], s7 offen offset:1024 sc1
    v_exp_f32 v230, v230
    v_mul_f32 v54, v54, v70
    v_mfma_f32_32x32x16_bf16 v[112:127], a[248:251], a[72:75], v[112:127]
    ds_read_b128 a[240:243], v2 offset:12800
    v_exp_f32 v231, v231
    v_mul_f32 v55, v55, v71
    v_fma_f32 v230, v230, v37, v37
    v_fma_f32 v231, v231, v37, v37
    v_mfma_f32_32x32x16_bf16 v[128:143], a[252:255], a[72:75], v[128:143]
    ds_read_b128 a[244:247], v2 offset:13824
    buffer_load_dwordx4 a[168:171], v2, s[32:35], s7 offen offset:2048 sc1
    v_rcp_f32 v230, v230
    s_waitcnt lgkmcnt(2)
    v_mfma_f32_32x32x16_bf16 v[144:159], a[224:227], a[72:75], v[144:159]
    ds_read_b128 a[248:251], v2 offset:14848
    v_rcp_f32 v231, v231
    v_cvt_pk_bf16_f32 v214, v52, v53
    v_mul_f32 v54, v54, v230
    v_mul_f32 v55, v55, v231
    buffer_load_dwordx4 a[172:175], v2, s[32:35], s7 offen offset:3072 sc1
    v_mfma_f32_32x32x16_bf16 v[112:127], a[228:231], a[76:79], v[112:127]
    ds_read_b128 a[252:255], v2 offset:15872
    v_mul_f32 v228, v39, v56
    v_mul_f32 v229, v39, v57
    v_mfma_f32_32x32x16_bf16 v[128:143], a[232:235], a[76:79], v[128:143]
    ds_read_b128 a[224:227], v2 offset:16896
    v_exp_f32 v228, v228
    v_mul_f32 v56, v56, v72
    buffer_load_dwordx4 a[176:179], v11, s[32:35], s7 offen offset:0 sc1
    v_mfma_f32_32x32x16_bf16 v[144:159], a[236:239], a[76:79], v[144:159]
    ds_read_b128 a[228:231], v2 offset:17920
    v_exp_f32 v229, v229
    v_mul_f32 v57, v57, v73
    v_fma_f32 v228, v228, v37, v37
    v_fma_f32 v229, v229, v37, v37
    s_waitcnt lgkmcnt(2)
    v_mfma_f32_32x32x16_bf16 v[112:127], a[240:243], a[80:83], v[112:127]
    ds_read_b128 a[232:235], v2 offset:18944
    v_rcp_f32 v228, v228
    s_bfe_u32 s12, 4384, s55
    s_lshl_b32 s12, s12, 13
    s_add_u32 s7, s12, s95
    buffer_load_dwordx4 a[180:183], v2, s[32:35], s7 offen offset:0 sc1
    v_mfma_f32_32x32x16_bf16 v[128:143], a[244:247], a[80:83], v[128:143]
    ds_read_b128 a[236:239], v2 offset:19968
    v_rcp_f32 v229, v229
    v_cvt_pk_bf16_f32 v215, v54, v55
    v_mul_f32 v56, v56, v228
    v_mul_f32 v57, v57, v229
    v_mfma_f32_32x32x16_bf16 v[144:159], a[248:251], a[80:83], v[144:159]
    ds_read_b128 a[240:243], v2 offset:20992
    buffer_load_dwordx4 a[184:187], v2, s[32:35], s7 offen offset:1024 sc1
    v_mul_f32 v230, v39, v58
    v_mul_f32 v231, v39, v59
    v_mfma_f32_32x32x16_bf16 v[112:127], a[252:255], a[84:87], v[112:127]
    ds_read_b128 a[244:247], v2 offset:22016
    v_exp_f32 v230, v230
    v_mul_f32 v58, v58, v74
    v_exp_f32 v231, v231
    s_waitcnt lgkmcnt(2)
    v_mfma_f32_32x32x16_bf16 v[128:143], a[224:227], a[84:87], v[128:143]
    ds_read_b128 a[248:251], v2 offset:23040
    buffer_load_dwordx4 a[188:191], v2, s[32:35], s7 offen offset:2048 sc1
    v_mul_f32 v59, v59, v75
    v_fma_f32 v230, v230, v37, v37
    v_mfma_f32_32x32x16_bf16 v[144:159], a[228:231], a[84:87], v[144:159]
    ds_read_b128 a[252:255], v2 offset:24064
    v_fma_f32 v231, v231, v37, v37
    v_rcp_f32 v230, v230
    v_rcp_f32 v231, v231
    v_cvt_pk_bf16_f32 v216, v56, v57
    v_mfma_f32_32x32x16_bf16 v[112:127], a[232:235], a[88:91], v[112:127]
    buffer_load_dwordx4 a[192:195], v2, s[32:35], s7 offen offset:3072 sc1
    v_mul_f32 v58, v58, v230
    v_mul_f32 v59, v59, v231
    v_mul_f32 v228, v39, v60
    v_mfma_f32_32x32x16_bf16 v[128:143], a[236:239], a[88:91], v[128:143]
    s_waitcnt vmcnt(15)
    s_waitcnt lgkmcnt(0)
    s_barrier
    ds_read_b128 a[224:227], v47 offset:12800
    ds_read_b128 a[228:231], v47 offset:13824
    v_mfma_f32_32x32x16_bf16 v[144:159], a[240:243], a[88:91], v[144:159]
    ds_read_b128 a[232:235], v47 offset:14848
    v_mul_f32 v229, v39, v61
    v_exp_f32 v228, v228
    v_mul_f32 v60, v60, v76
    v_mfma_f32_32x32x16_bf16 v[112:127], a[244:247], a[92:95], v[112:127]
    ds_read_b128 a[236:239], v47 offset:15872
    v_exp_f32 v229, v229
    v_mul_f32 v61, v61, v77
    v_fma_f32 v228, v228, v37, v37
    s_mul_i32 s5, s70, 12288
    s_add_u32 m0, s37, 127488
    s_add_u32 s5, s5, s39
    buffer_load_dwordx4 v2, s[32:35], s5 offen offset:0 sc1 lds
    v_mfma_f32_32x32x16_bf16 v[128:143], a[248:251], a[92:95], v[128:143]
    ds_read_b128 a[240:243], v47 offset:16896
    buffer_load_dwordx4 v2, s[32:35], s5 offen offset:1024 sc1 lds
    v_mfma_f32_32x32x16_bf16 v[144:159], a[252:255], a[92:95], v[144:159]
    ds_read_b128 a[244:247], v47 offset:17920
    buffer_load_dwordx4 v2, s[32:35], s5 offen offset:2048 sc1 lds
    v_fma_f32 v229, v229, v37, v37
    v_rcp_f32 v228, v228
    s_waitcnt lgkmcnt(2)
    v_mfma_f32_32x32x16_bf16 v[112:127], a[224:227], a[96:99], v[112:127]
    ds_read_b128 a[248:251], v47 offset:18944
    v_rcp_f32 v229, v229
    v_cvt_pk_bf16_f32 v217, v58, v59
    v_mul_f32 v60, v60, v228
    v_mul_f32 v61, v61, v229
    v_mfma_f32_32x32x16_bf16 v[128:143], a[228:231], a[96:99], v[128:143]
    ds_read_b128 a[252:255], v47 offset:19968
    v_mul_f32 v230, v39, v62
    v_mul_f32 v231, v39, v63
    v_exp_f32 v230, v230
    v_mul_f32 v62, v62, v78
    v_mfma_f32_32x32x16_bf16 v[144:159], a[232:235], a[96:99], v[144:159]
    ds_read_b128 a[224:227], v47 offset:20992
    v_exp_f32 v231, v231
    v_mul_f32 v63, v63, v79
    v_fma_f32 v230, v230, v37, v37
    v_fma_f32 v231, v231, v37, v37
    v_mfma_f32_32x32x16_bf16 v[112:127], a[236:239], a[100:103], v[112:127]
    ds_read_b128 a[228:231], v47 offset:22016
    s_mul_i32 s5, s71, 12288
    s_add_u32 m0, s37, 12800
    s_add_u32 s5, s5, s39
    buffer_load_dwordx4 v2, s[32:35], s5 offen offset:0 sc1 lds
    s_waitcnt lgkmcnt(2)
    v_mfma_f32_32x32x16_bf16 v[128:143], a[240:243], a[100:103], v[128:143]
    ds_read_b128 a[232:235], v47 offset:23040
    buffer_load_dwordx4 v2, s[32:35], s5 offen offset:1024 sc1 lds
    v_rcp_f32 v230, v230
    v_mfma_f32_32x32x16_bf16 v[144:159], a[244:247], a[100:103], v[144:159]
    ds_read_b128 a[236:239], v47 offset:24064
    buffer_load_dwordx4 v2, s[32:35], s5 offen offset:2048 sc1 lds
    v_rcp_f32 v231, v231
    v_cvt_pk_bf16_f32 v218, v60, v61
    v_mul_f32 v62, v62, v230
    v_mfma_f32_32x32x16_bf16 v[112:127], a[248:251], a[104:107], v[112:127]
    ds_read_b128 a[240:243], v2 offset:29184
    v_mul_f32 v63, v63, v231
    v_cvt_pk_bf16_f32 v219, v62, v63
    buffer_store_dwordx4 v[212:215], v20, s[32:35], s49 offen offset:0 sc1
    v_mfma_f32_32x32x16_bf16 v[128:143], a[252:255], a[104:107], v[128:143]
    ds_read_b128 a[244:247], v2 offset:30208
    v_mul_f32 v228, v39, v80
    v_mul_f32 v229, v39, v81
    v_exp_f32 v228, v228
    v_mul_f32 v80, v80, v96
    s_waitcnt lgkmcnt(2)
    v_mfma_f32_32x32x16_bf16 v[144:159], a[224:227], a[104:107], v[144:159]
    ds_read_b128 a[248:251], v2 offset:31232
    v_exp_f32 v229, v229
    v_mul_f32 v81, v81, v97
    v_fma_f32 v228, v228, v37, v37
    v_fma_f32 v229, v229, v37, v37
    v_mfma_f32_32x32x16_bf16 v[112:127], a[228:231], a[108:111], v[112:127]
    ds_read_b128 a[252:255], v2 offset:32256
    v_rcp_f32 v228, v228
    v_rcp_f32 v229, v229
    v_mul_f32 v80, v80, v228
    v_mul_f32 v81, v81, v229
    v_mfma_f32_32x32x16_bf16 v[128:143], a[232:235], a[108:111], v[128:143]
    ds_read_b128 a[224:227], v2 offset:33280
    v_mul_f32 v230, v39, v82
    v_mul_f32 v231, v39, v83
    buffer_load_dwordx4 a[196:199], v11, s[32:35], s7 offen offset:0 sc1
    v_mfma_f32_32x32x16_bf16 v[144:159], a[236:239], a[108:111], v[144:159]
    ds_read_b128 a[228:231], v2 offset:34304
    v_exp_f32 v230, v230
    v_mul_f32 v82, v82, v98
    v_exp_f32 v231, v231
    s_waitcnt lgkmcnt(2)
    v_mfma_f32_32x32x16_bf16 v[112:127], a[240:243], a[112:115], v[112:127]
    ds_read_b128 a[232:235], v2 offset:35328
    v_mul_f32 v83, v83, v99
    s_bfe_u32 s12, 8978, s55
    s_lshl_b32 s12, s12, 13
    s_add_u32 s7, s12, s95
    buffer_load_dwordx4 a[200:203], v2, s[32:35], s7 offen offset:0 sc1
    v_mfma_f32_32x32x16_bf16 v[128:143], a[244:247], a[112:115], v[128:143]
    ds_read_b128 a[236:239], v2 offset:36352
    v_fma_f32 v230, v230, v37, v37
    v_fma_f32 v231, v231, v37, v37
    v_rcp_f32 v230, v230
    v_mfma_f32_32x32x16_bf16 v[144:159], a[248:251], a[112:115], v[144:159]
    ds_read_b128 a[240:243], v2 offset:37376
    buffer_load_dwordx4 a[204:207], v2, s[32:35], s7 offen offset:1024 sc1
    v_rcp_f32 v231, v231
    v_cvt_pk_bf16_f32 v220, v80, v81
    v_mfma_f32_32x32x16_bf16 v[112:127], a[252:255], a[116:119], v[112:127]
    ds_read_b128 a[244:247], v2 offset:38400
    v_mul_f32 v82, v82, v230
    v_mul_f32 v83, v83, v231
    v_mul_f32 v228, v39, v84
    v_mul_f32 v229, v39, v85
    v_exp_f32 v228, v228
    s_waitcnt lgkmcnt(2)
    v_mfma_f32_32x32x16_bf16 v[128:143], a[224:227], a[116:119], v[128:143]
    ds_read_b128 a[248:251], v2 offset:39424
    buffer_load_dwordx4 a[208:211], v2, s[32:35], s7 offen offset:2048 sc1
    v_mul_f32 v84, v84, v100
    v_mfma_f32_32x32x16_bf16 v[144:159], a[228:231], a[116:119], v[144:159]
    ds_read_b128 a[252:255], v2 offset:40448
    v_exp_f32 v229, v229
    v_mul_f32 v85, v85, v101
    v_fma_f32 v228, v228, v37, v37
    v_fma_f32 v229, v229, v37, v37
    buffer_store_dwordx4 v[216:219], v20, s[32:35], s49 offen offset:256 sc1
    v_mfma_f32_32x32x16_bf16 v[112:127], a[232:235], a[120:123], v[112:127]
    v_rcp_f32 v228, v228
    v_rcp_f32 v229, v229
    v_mfma_f32_32x32x16_bf16 v[128:143], a[236:239], a[120:123], v[128:143]
    s_waitcnt vmcnt(21)
    s_waitcnt lgkmcnt(0)
    s_barrier
    ds_read_b128 a[224:227], v2 offset:61952
    ds_read_b128 a[228:231], v2 offset:62976
    v_cvt_pk_bf16_f32 v221, v82, v83
    v_mfma_f32_32x32x16_bf16 v[144:159], a[240:243], a[120:123], v[144:159]
    ds_read_b128 a[232:235], v2 offset:64000
    v_mul_f32 v84, v84, v228
    v_mul_f32 v85, v85, v229
    v_mul_f32 v230, v39, v86
    v_mul_f32 v231, v39, v87
    v_mfma_f32_32x32x16_bf16 v[112:127], a[244:247], a[124:127], v[112:127]
    ds_read_b128 a[236:239], v2 offset:65024
    v_exp_f32 v230, v230
    v_mul_f32 v86, v86, v102
    v_exp_f32 v231, v231
    v_mul_f32 v87, v87, v103
    v_mfma_f32_32x32x16_bf16 v[128:143], a[248:251], a[124:127], v[128:143]
    ds_read_b128 a[240:243], v3 offset:512
    v_fma_f32 v230, v230, v37, v37
    v_fma_f32 v231, v231, v37, v37
    v_rcp_f32 v230, v230
    v_mfma_f32_32x32x16_bf16 v[144:159], a[252:255], a[124:127], v[144:159]
    ds_read_b128 a[244:247], v3 offset:1536
    s_mul_i32 s5, s72, 12288
    s_add_u32 m0, s37, 143872
    s_add_u32 s5, s5, s39
    buffer_load_dwordx4 v2, s[32:35], s5 offen offset:0 sc1 lds
    v_rcp_f32 v231, v231
    s_waitcnt lgkmcnt(2)
    v_mfma_f32_32x32x16_bf16 v[112:127], a[224:227], a[128:131], v[112:127]
    ds_read_b128 a[248:251], v3 offset:2560
    buffer_load_dwordx4 v2, s[32:35], s5 offen offset:1024 sc1 lds
    v_cvt_pk_bf16_f32 v222, v84, v85
    v_mul_f32 v86, v86, v230
    v_mfma_f32_32x32x16_bf16 v[128:143], a[228:231], a[128:131], v[128:143]
    ds_read_b128 a[252:255], v3 offset:3584
    buffer_load_dwordx4 v2, s[32:35], s5 offen offset:2048 sc1 lds
    v_mul_f32 v87, v87, v231
    v_mul_f32 v228, v39, v88
    v_mul_f32 v229, v39, v89
    v_mfma_f32_32x32x16_bf16 v[144:159], a[232:235], a[128:131], v[144:159]
    ds_read_b128 a[224:227], v3 offset:4608
    v_exp_f32 v228, v228
    v_mul_f32 v88, v88, v104
    v_exp_f32 v229, v229
    v_mfma_f32_32x32x16_bf16 v[112:127], a[236:239], a[132:135], v[112:127]
    ds_read_b128 a[228:231], v3 offset:5632
    v_mul_f32 v89, v89, v105
    v_fma_f32 v228, v228, v37, v37
    v_fma_f32 v229, v229, v37, v37
    v_rcp_f32 v228, v228
    s_waitcnt lgkmcnt(2)
    v_mfma_f32_32x32x16_bf16 v[128:143], a[240:243], a[132:135], v[128:143]
    ds_read_b128 a[232:235], v3 offset:6656
    v_rcp_f32 v229, v229
    s_mul_i32 s5, s73, 12288
    s_add_u32 m0, s37, 29184
    s_add_u32 s5, s5, s39
    buffer_load_dwordx4 v2, s[32:35], s5 offen offset:0 sc1 lds
    v_mfma_f32_32x32x16_bf16 v[144:159], a[244:247], a[132:135], v[144:159]
    ds_read_b128 a[236:239], v3 offset:7680
    buffer_load_dwordx4 v2, s[32:35], s5 offen offset:1024 sc1 lds
    v_cvt_pk_bf16_f32 v223, v86, v87
    v_mfma_f32_32x32x16_bf16 v[112:127], a[248:251], a[136:139], v[112:127]
    ds_read_b128 a[240:243], v2 offset:45568
    buffer_load_dwordx4 v2, s[32:35], s5 offen offset:2048 sc1 lds
    v_mul_f32 v88, v88, v228
    v_mul_f32 v89, v89, v229
    v_mfma_f32_32x32x16_bf16 v[128:143], a[252:255], a[136:139], v[128:143]
    ds_read_b128 a[244:247], v2 offset:46592
    v_mul_f32 v230, v39, v90
    v_mul_f32 v231, v39, v91
    v_exp_f32 v230, v230
    v_mul_f32 v90, v90, v106
    s_waitcnt lgkmcnt(2)
    v_mfma_f32_32x32x16_bf16 v[144:159], a[224:227], a[136:139], v[144:159]
    ds_read_b128 a[248:251], v2 offset:47616
    v_exp_f32 v231, v231
    buffer_load_dwordx4 a[212:215], v2, s[32:35], s7 offen offset:3072 sc1
    v_mul_f32 v91, v91, v107
    v_mfma_f32_32x32x16_bf16 v[112:127], a[228:231], a[140:143], v[112:127]
    ds_read_b128 a[252:255], v2 offset:48640
    v_fma_f32 v230, v230, v37, v37
    v_fma_f32 v231, v231, v37, v37
    v_rcp_f32 v230, v230
    v_mfma_f32_32x32x16_bf16 v[128:143], a[232:235], a[140:143], v[128:143]
    ds_read_b128 a[224:227], v2 offset:49664
    v_rcp_f32 v231, v231
    buffer_load_dwordx4 a[216:219], v11, s[32:35], s7 offen offset:0 sc1
    v_cvt_pk_bf16_f32 v224, v88, v89
    v_mfma_f32_32x32x16_bf16 v[144:159], a[236:239], a[140:143], v[144:159]
    ds_read_b128 a[228:231], v2 offset:50688
    v_mul_f32 v90, v90, v230
    v_mul_f32 v91, v91, v231
    v_mul_f32 v228, v39, v92
    v_mul_f32 v229, v39, v93
    v_exp_f32 v228, v228
    s_waitcnt lgkmcnt(2)
    v_mfma_f32_32x32x16_bf16 v[112:127], a[240:243], a[144:147], v[112:127]
    ds_read_b128 a[232:235], v2 offset:51712
    s_bfe_u32 s12, 16947, s55
    s_lshl_b32 s12, s12, 13
    s_add_u32 s7, s12, s95
    buffer_load_dwordx4 a[220:223], v2, s[32:35], s7 offen offset:0 sc1
    v_mfma_f32_32x32x16_bf16 v[128:143], a[244:247], a[144:147], v[128:143]
    ds_read_b128 a[236:239], v2 offset:52736
    v_mul_f32 v92, v92, v108
    v_exp_f32 v229, v229
    v_mul_f32 v93, v93, v109
    v_fma_f32 v228, v228, v37, v37
    v_fma_f32 v229, v229, v37, v37
    v_mfma_f32_32x32x16_bf16 v[144:159], a[248:251], a[144:147], v[144:159]
    ds_read_b128 a[240:243], v2 offset:53760
    v_rcp_f32 v228, v228
    v_rcp_f32 v229, v229
    v_cvt_pk_bf16_f32 v225, v90, v91
    v_mfma_f32_32x32x16_bf16 v[112:127], a[252:255], a[148:151], v[112:127]
    ds_read_b128 a[244:247], v2 offset:54784
    v_mul_f32 v92, v92, v228
    v_mul_f32 v93, v93, v229
    v_mul_f32 v230, v39, v94
    v_mul_f32 v231, v39, v95
    s_waitcnt lgkmcnt(2)
    v_mfma_f32_32x32x16_bf16 v[128:143], a[224:227], a[148:151], v[128:143]
    ds_read_b128 a[248:251], v2 offset:55808
    v_exp_f32 v230, v230
    v_mul_f32 v94, v94, v110
    v_exp_f32 v231, v231
    v_mul_f32 v95, v95, v111
    v_mfma_f32_32x32x16_bf16 v[144:159], a[228:231], a[148:151], v[144:159]
    ds_read_b128 a[252:255], v2 offset:56832
    v_fma_f32 v230, v230, v37, v37
    v_fma_f32 v231, v231, v37, v37
    v_rcp_f32 v230, v230
    v_rcp_f32 v231, v231
    v_mfma_f32_32x32x16_bf16 v[112:127], a[232:235], a[152:155], v[112:127]
    v_cvt_pk_bf16_f32 v226, v92, v93
    v_mul_f32 v94, v94, v230
    v_mul_f32 v95, v95, v231
    v_cvt_pk_bf16_f32 v227, v94, v95
    buffer_store_dwordx4 v[220:223], v20, s[32:35], s38 offen offset:0 sc1
    v_mfma_f32_32x32x16_bf16 v[128:143], a[236:239], a[152:155], v[128:143]
    s_waitcnt vmcnt(16)
    s_waitcnt lgkmcnt(0)
    s_barrier
    ds_read_b128 a[224:227], v3 offset:61952
    ds_read_b128 a[228:231], v3 offset:62976
    v_mfma_f32_32x32x16_bf16 v[144:159], a[240:243], a[152:155], v[144:159]
    ds_read_b128 a[232:235], v3 offset:64000
    v_mfma_f32_32x32x16_bf16 v[112:127], a[244:247], a[156:159], v[112:127]
    ds_read_b128 a[236:239], v3 offset:65024
    s_mul_i32 s5, s74, 12288
    s_add_u32 m0, s37, 61952
    s_add_u32 s5, s5, s39
    buffer_load_dwordx4 v2, s[32:35], s5 offen offset:0 sc1 lds
    v_mfma_f32_32x32x16_bf16 v[128:143], a[248:251], a[156:159], v[128:143]
    ds_read_b128 a[240:243], v47 offset:512
    buffer_load_dwordx4 v2, s[32:35], s5 offen offset:1024 sc1 lds
    v_mfma_f32_32x32x16_bf16 v[144:159], a[252:255], a[156:159], v[144:159]
    ds_read_b128 a[244:247], v47 offset:1536
    buffer_load_dwordx4 v2, s[32:35], s5 offen offset:2048 sc1 lds
    s_waitcnt lgkmcnt(2)
    v_mfma_f32_32x32x16_bf16 v[160:175], a[224:227], a[0:3], 0
    ds_read_b128 a[248:251], v47 offset:2560
    v_mfma_f32_32x32x16_bf16 v[48:63], a[228:231], a[0:3], 0
    ds_read_b128 a[252:255], v47 offset:3584
    v_mfma_f32_32x32x16_bf16 v[64:79], a[232:235], a[0:3], 0
    ds_read_b128 a[224:227], v47 offset:4608
    buffer_store_dwordx4 v[224:227], v20, s[32:35], s38 offen offset:256 sc1
    ds_read_b32 v44, v30 offset:3456
    ds_read_b32 v42, v30 offset:3584
    s_waitcnt lgkmcnt(1)
    v_mfma_f32_32x32x16_bf16 v[160:175], v[44:47], v[32:35], v[160:175]
    ds_read_b32 v44, v30 offset:3712
    s_waitcnt lgkmcnt(0)
    v_mfma_f32_32x32x16_bf16 v[48:63], v[42:45], v[32:35], v[48:63]
    v_mfma_f32_32x32x16_bf16 v[64:79], v[44:47], v[32:35], v[64:79]
    s_bfe_u32 s56, s55, 0x20002
    s_cmp_eq_u32 s56, 3
    s_cselect_b32 s56, 0, s56
    s_add_u32 s57, s56, 0
    s_cmp_ge_u32 s57, 3
    s_cselect_b32 s58, 3, 0
    s_sub_u32 s57, s57, s58
    s_add_u32 s58, s57, s64
    s_add_u32 s58, s58, 1
    s_and_b32 s58, s58, 3
    s_mul_i32 s59, s58, 69632
    s_mul_i32 s58, s58, 3
    s_add_u32 s57, s57, s58
    s_mul_i32 s5, s75, 12288
    s_add_u32 m0, s37, 45568
    s_add_u32 s5, s5, s39
    buffer_load_dwordx4 v2, s[32:35], s5 offen offset:0 sc1 lds
    v_mfma_f32_32x32x16_bf16 v[160:175], a[236:239], a[4:7], v[160:175]
    ds_read_b128 a[228:231], v47 offset:5632
    s_mul_i32 s88, s57, 5120
    v_add_u32 v12, s59, v2
    s_add_u32 s57, s56, 1
    s_cmp_ge_u32 s57, 3
    s_cselect_b32 s58, 3, 0
    s_sub_u32 s57, s57, s58
    s_add_u32 s58, s57, s64
    s_add_u32 s58, s58, 1
    buffer_load_dwordx4 v2, s[32:35], s5 offen offset:1024 sc1 lds
    v_mfma_f32_32x32x16_bf16 v[48:63], a[240:243], a[4:7], v[48:63]
    ds_read_b128 a[232:235], v47 offset:6656
    s_and_b32 s58, s58, 3
    s_mul_i32 s59, s58, 69632
    s_mul_i32 s58, s58, 3
    s_add_u32 s57, s57, s58
    s_mul_i32 s89, s57, 5120
    v_add_u32 v13, s59, v2
    s_add_u32 s57, s56, 2
    s_cmp_ge_u32 s57, 3
    s_cselect_b32 s58, 3, 0
    s_sub_u32 s57, s57, s58
    s_add_u32 s58, s57, s64
    buffer_load_dwordx4 v2, s[32:35], s5 offen offset:2048 sc1 lds
    v_mfma_f32_32x32x16_bf16 v[64:79], a[244:247], a[4:7], v[64:79]
    ds_read_b128 a[236:239], v47 offset:7680
    buffer_load_dwordx4 a[0:3], v2, s[32:35], s7 offen offset:1024 sc1
    s_add_u32 s58, s58, 1
    s_and_b32 s58, s58, 3
    s_mul_i32 s59, s58, 69632
    s_mul_i32 s58, s58, 3
    s_add_u32 s57, s57, s58
    v_mfma_f32_32x32x16_bf16 v[160:175], a[248:251], a[8:11], v[160:175]
    ds_read_b128 a[240:243], v2 offset:12800
    s_mul_i32 s90, s57, 5120
    v_add_u32 v14, s59, v2
    s_mul_i32 s59, s64, 69632
    v_add_u32 v30, s59, v2
    v_cvt_pk_bf16_f32 v208, v112, v113
    v_cvt_pk_bf16_f32 v209, v114, v115
    v_cvt_pk_bf16_f32 v210, v116, v117
    v_cvt_pk_bf16_f32 v211, v118, v119
    v_cvt_pk_bf16_f32 v212, v120, v121
    v_mfma_f32_32x32x16_bf16 v[48:63], a[252:255], a[8:11], v[48:63]
    ds_read_b128 a[244:247], v2 offset:13824
    buffer_load_dwordx4 a[4:7], v2, s[32:35], s7 offen offset:2048 sc1
    v_cvt_pk_bf16_f32 v213, v122, v123
    v_cvt_pk_bf16_f32 v214, v124, v125
    v_cvt_pk_bf16_f32 v215, v126, v127
    v_cvt_pk_bf16_f32 v216, v128, v129
    v_cvt_pk_bf16_f32 v217, v130, v131
    s_waitcnt lgkmcnt(2)
    v_mfma_f32_32x32x16_bf16 v[64:79], a[224:227], a[8:11], v[64:79]
    ds_read_b128 a[248:251], v2 offset:14848
    v_mov_b32 v218, 0
    v_mov_b32 v219, 0
    ds_read_b64_tr_b16 v[236:237], v16 offset:0
    ds_read_b64_tr_b16 v[238:239], v16 offset:160
    ds_read_b64_tr_b16 v[248:249], v17 offset:0
    ds_read_b64_tr_b16 v[250:251], v17 offset:160
    ds_read_b64_tr_b16 v[240:241], v16 offset:320
    ds_read_b64_tr_b16 v[242:243], v16 offset:480
    v_mfma_f32_32x32x16_bf16 v[160:175], a[228:231], a[12:15], v[160:175]
    ds_read_b128 a[252:255], v2 offset:15872
    ds_read_b64_tr_b16 v[252:253], v17 offset:320
    ds_read_b64_tr_b16 v[254:255], v17 offset:480
    ds_read_b64_tr_b16 v[244:245], v16 offset:640
    ds_read_b64_tr_b16 v[220:221], v17 offset:640
    v_mov_b32 v246, 0
    v_mov_b32 v247, 0
    v_mov_b32 v222, 0
    v_mov_b32 v223, 0
    s_waitcnt lgkmcnt(9)
    v_mfma_f32_32x32x16_bf16 v[176:191], v[236:239], v[208:211], 0
    s_waitcnt lgkmcnt(7)
    v_mfma_f32_32x32x16_bf16 v[192:207], v[248:251], v[208:211], 0
    s_waitcnt lgkmcnt(5)
    v_mfma_f32_32x32x16_bf16 v[176:191], v[240:243], v[212:215], v[176:191]
    s_waitcnt lgkmcnt(2)
    v_mfma_f32_32x32x16_bf16 v[192:207], v[252:255], v[212:215], v[192:207]
    s_waitcnt lgkmcnt(1)
    v_mfma_f32_32x32x16_bf16 v[176:191], v[244:247], v[216:219], v[176:191]
    s_waitcnt lgkmcnt(0)
    v_mfma_f32_32x32x16_bf16 v[192:207], v[220:223], v[216:219], v[192:207]
    v_mul_f32 v132, v132, v36
    v_mul_f32 v133, v133, v36
    v_cvt_pk_bf16_f32 v112, v132, v133
    v_mul_f32 v134, v134, v36
    v_mul_f32 v135, v135, v36
    v_cvt_pk_bf16_f32 v113, v134, v135
    v_mul_f32 v136, v136, v36
    v_mul_f32 v137, v137, v36
    v_cvt_pk_bf16_f32 v114, v136, v137
    v_mul_f32 v138, v138, v36
    v_mfma_f32_32x32x16_bf16 v[48:63], a[232:235], a[12:15], v[48:63]
    ds_read_b128 a[224:227], v2 offset:16896
    buffer_load_dwordx4 a[8:11], v2, s[32:35], s7 offen offset:3072 sc1
    v_mul_f32 v139, v139, v36
    v_cvt_pk_bf16_f32 v115, v138, v139
    v_mul_f32 v140, v140, v36
    v_mul_f32 v141, v141, v36
    v_cvt_pk_bf16_f32 v116, v140, v141
    v_mfma_f32_32x32x16_bf16 v[64:79], a[236:239], a[12:15], v[64:79]
    ds_read_b128 a[228:231], v2 offset:17920
    v_mul_f32 v142, v142, v36
    v_mul_f32 v143, v143, v36
    v_cvt_pk_bf16_f32 v117, v142, v143
    v_mul_f32 v144, v144, v36
    v_mul_f32 v145, v145, v36
    v_cvt_pk_bf16_f32 v118, v144, v145
    v_mul_f32 v146, v146, v36
    v_mul_f32 v147, v147, v36
    v_mfma_f32_32x32x16_bf16 v[160:175], a[240:243], a[16:19], v[160:175]
    ds_read_b128 a[232:235], v2 offset:18944
    v_cvt_pk_bf16_f32 v119, v146, v147
    v_mul_f32 v148, v148, v36
    v_mul_f32 v149, v149, v36
    v_cvt_pk_bf16_f32 v120, v148, v149
    v_mul_f32 v150, v150, v36
    v_mul_f32 v151, v151, v36
    v_cvt_pk_bf16_f32 v121, v150, v151
    v_mov_b32 v122, 0x3f80
    v_mfma_f32_32x32x16_bf16 v[48:63], a[244:247], a[16:19], v[48:63]
    ds_read_b128 a[236:239], v2 offset:19968
    buffer_load_dwordx4 a[12:15], v11, s[32:35], s7 offen offset:0 sc1
    v_mov_b32 v123, 0
    v_xor_b32 v234, 144, v21
    ds_write_b128 v234, v[112:115]
    v_xor_b32 v235, 160, v21
    ds_write_b128 v235, v[116:119]
    v_xor_b32 v234, 176, v21
    v_mfma_f32_32x32x16_bf16 v[64:79], a[248:251], a[16:19], v[64:79]
    ds_read_b128 a[240:243], v2 offset:20992
    ds_write_b128 v234, v[120:123]
    v_max3_f32 v228, v176, v177, v178
    v_min3_f32 v229, v176, v177, v178
    v_max3_f32 v228, v228, v179, v180
    v_min3_f32 v229, v229, v179, v180
    v_max3_f32 v228, v228, v181, v182
    v_min3_f32 v229, v229, v181, v182
    v_max3_f32 v228, v228, v183, v184
    v_mfma_f32_32x32x16_bf16 v[160:175], a[252:255], a[20:23], v[160:175]
    ds_read_b128 a[244:247], v2 offset:22016
    v_min3_f32 v229, v229, v183, v184
    v_max3_f32 v228, v228, v185, v186
    v_min3_f32 v229, v229, v185, v186
    v_max3_f32 v228, v228, v187, v188
    v_min3_f32 v229, v229, v187, v188
    v_max3_f32 v228, v228, v189, v190
    v_min3_f32 v229, v229, v189, v190
    v_max3_f32 v228, v228, v191, v192
    s_waitcnt lgkmcnt(5)
    v_mfma_f32_32x32x16_bf16 v[48:63], a[224:227], a[20:23], v[48:63]
    ds_read_b128 a[248:251], v2 offset:23040
    s_bfe_u32 s12, 13381, s55
    s_lshl_b32 s12, s12, 13
    s_add_u32 s7, s12, s95
    buffer_load_dwordx4 a[16:19], v2, s[32:35], s7 offen offset:0 sc1
    v_min3_f32 v229, v229, v191, v192
    v_max3_f32 v228, v228, v193, v194
    v_min3_f32 v229, v229, v193, v194
    v_max_f32 v228, v228, v195
    v_mfma_f32_32x32x16_bf16 v[64:79], a[228:231], a[20:23], v[64:79]
    ds_read_b128 a[252:255], v2 offset:24064
    v_min_f32 v229, v229, v195
    v_mul_f32 v230, v39, v228
    v_mul_f32 v231, v38, v229
    v_fma_f32 v208, v176, v38, v230
    v_fma_f32 v176, v176, v39, v231
    v_exp_f32 v208, v208
    v_fma_f32 v209, v177, v38, v230
    v_mfma_f32_32x32x16_bf16 v[160:175], a[232:235], a[24:27], v[160:175]
    v_exp_f32 v176, v176
    v_fma_f32 v177, v177, v39, v231
    v_exp_f32 v209, v209
    v_fma_f32 v210, v178, v38, v230
    v_exp_f32 v177, v177
    v_fma_f32 v178, v178, v39, v231
    v_mfma_f32_32x32x16_bf16 v[48:63], a[236:239], a[24:27], v[48:63]
    s_waitcnt vmcnt(8)
    s_waitcnt lgkmcnt(0)
    s_barrier
    s_cmp_eq_u32 s64, 0
    s_cbranch_scc0 SK_57
    s_mov_b32 s14, s43
    buffer_store_dword v1, v29, s[32:35], s14 offen sc1
SK_57:
    ds_read_b128 a[224:227], v47 offset:12800
    ds_read_b128 a[228:231], v47 offset:13824
    s_mul_i32 s5, s76, 12288
    s_add_u32 m0, s37, 127488
    s_add_u32 s5, s5, s39
    buffer_load_dwordx4 v2, s[32:35], s5 offen offset:0 sc1 lds
    v_mfma_f32_32x32x16_bf16 v[64:79], a[240:243], a[24:27], v[64:79]
    ds_read_b128 a[232:235], v47 offset:14848
    v_exp_f32 v210, v210
    v_fma_f32 v211, v179, v38, v230
    v_exp_f32 v178, v178
    buffer_load_dwordx4 v2, s[32:35], s5 offen offset:1024 sc1 lds
    v_mfma_f32_32x32x16_bf16 v[160:175], a[244:247], a[28:31], v[160:175]
    ds_read_b128 a[236:239], v47 offset:15872
    v_fma_f32 v179, v179, v39, v231
    v_add_f32 v232, v208, v209
    v_add_f32 v233, v176, v177
    v_exp_f32 v211, v211
    v_mfma_f32_32x32x16_bf16 v[48:63], a[248:251], a[28:31], v[48:63]
    ds_read_b128 a[240:243], v47 offset:16896
    v_fma_f32 v212, v180, v38, v230
    v_exp_f32 v179, v179
    buffer_load_dwordx4 v2, s[32:35], s5 offen offset:2048 sc1 lds
    v_fma_f32 v180, v180, v39, v231
    v_add_f32 v232, v232, v210
    v_mfma_f32_32x32x16_bf16 v[64:79], a[252:255], a[28:31], v[64:79]
    ds_read_b128 a[244:247], v47 offset:17920
    v_add_f32 v233, v233, v178
    v_exp_f32 v212, v212
    v_fma_f32 v213, v181, v38, v230
    v_exp_f32 v180, v180
    v_fma_f32 v181, v181, v39, v231
    s_mul_i32 s5, s77, 12288
    s_add_u32 m0, s37, 12800
    s_add_u32 s5, s5, s39
    buffer_load_dwordx4 v2, s[32:35], s5 offen offset:0 sc1 lds
    s_waitcnt lgkmcnt(2)
    v_mfma_f32_32x32x16_bf16 v[160:175], a[224:227], a[32:35], v[160:175]
    ds_read_b128 a[248:251], v47 offset:18944
    v_add_f32 v232, v232, v211
    v_add_f32 v233, v233, v179
    v_exp_f32 v213, v213
    v_fma_f32 v214, v182, v38, v230
    v_mfma_f32_32x32x16_bf16 v[48:63], a[228:231], a[32:35], v[48:63]
    ds_read_b128 a[252:255], v47 offset:19968
    buffer_load_dwordx4 v2, s[32:35], s5 offen offset:1024 sc1 lds
    v_exp_f32 v181, v181
    v_fma_f32 v182, v182, v39, v231
    v_add_f32 v232, v232, v212
    v_add_f32 v233, v233, v180
    v_mfma_f32_32x32x16_bf16 v[64:79], a[232:235], a[32:35], v[64:79]
    ds_read_b128 a[224:227], v47 offset:20992
    v_exp_f32 v214, v214
    v_fma_f32 v215, v183, v38, v230
    v_exp_f32 v182, v182
    buffer_load_dwordx4 v2, s[32:35], s5 offen offset:2048 sc1 lds
    v_fma_f32 v183, v183, v39, v231
    v_mfma_f32_32x32x16_bf16 v[160:175], a[236:239], a[36:39], v[160:175]
    ds_read_b128 a[228:231], v47 offset:22016
    buffer_load_dwordx4 a[20:23], v2, s[32:35], s7 offen offset:1024 sc1
    v_add_f32 v232, v232, v213
    v_add_f32 v233, v233, v181
    v_exp_f32 v215, v215
    v_fma_f32 v216, v184, v38, v230
    s_waitcnt lgkmcnt(2)
    v_mfma_f32_32x32x16_bf16 v[48:63], a[240:243], a[36:39], v[48:63]
    ds_read_b128 a[232:235], v47 offset:23040
    buffer_load_dwordx4 a[24:27], v2, s[32:35], s7 offen offset:2048 sc1
    v_exp_f32 v183, v183
    v_fma_f32 v184, v184, v39, v231
    v_add_f32 v232, v232, v214
    v_add_f32 v233, v233, v182
    v_mfma_f32_32x32x16_bf16 v[64:79], a[244:247], a[36:39], v[64:79]
    ds_read_b128 a[236:239], v47 offset:24064
    v_exp_f32 v216, v216
    v_fma_f32 v217, v185, v38, v230
    v_exp_f32 v184, v184
    buffer_load_dwordx4 a[28:31], v2, s[32:35], s7 offen offset:3072 sc1
    v_fma_f32 v185, v185, v39, v231
    v_mfma_f32_32x32x16_bf16 v[160:175], a[248:251], a[40:43], v[160:175]
    ds_read_b128 a[240:243], v2 offset:29184
    v_add_f32 v232, v232, v215
    v_add_f32 v233, v233, v183
    v_exp_f32 v217, v217
    v_fma_f32 v218, v186, v38, v230
    v_exp_f32 v185, v185
    v_fma_f32 v186, v186, v39, v231
    v_mfma_f32_32x32x16_bf16 v[48:63], a[252:255], a[40:43], v[48:63]
    ds_read_b128 a[244:247], v2 offset:30208
    buffer_load_dwordx4 a[32:35], v11, s[32:35], s7 offen offset:0 sc1
    v_add_f32 v232, v232, v216
    v_add_f32 v233, v233, v184
    v_exp_f32 v218, v218
    v_fma_f32 v219, v187, v38, v230
    s_waitcnt lgkmcnt(2)
    v_mfma_f32_32x32x16_bf16 v[64:79], a[224:227], a[40:43], v[64:79]
    ds_read_b128 a[248:251], v2 offset:31232
    v_exp_f32 v186, v186
    s_bfe_u32 s12, 21860, s55
    s_lshl_b32 s12, s12, 13
    s_add_u32 s7, s12, s95
    buffer_load_dwordx4 a[36:39], v2, s[32:35], s7 offen offset:0 sc1
    v_fma_f32 v187, v187, v39, v231
    v_add_f32 v232, v232, v217
    v_mfma_f32_32x32x16_bf16 v[160:175], a[228:231], a[44:47], v[160:175]
    ds_read_b128 a[252:255], v2 offset:32256
    v_add_f32 v233, v233, v185
    v_exp_f32 v219, v219
    v_fma_f32 v220, v188, v38, v230
    v_exp_f32 v187, v187
    v_fma_f32 v188, v188, v39, v231
    v_add_f32 v232, v232, v218
    v_mfma_f32_32x32x16_bf16 v[48:63], a[232:235], a[44:47], v[48:63]
    ds_read_b128 a[224:227], v2 offset:33280
    buffer_load_dwordx4 a[40:43], v2, s[32:35], s7 offen offset:1024 sc1
    v_add_f32 v233, v233, v186
    v_exp_f32 v220, v220
    v_fma_f32 v221, v189, v38, v230
    v_mfma_f32_32x32x16_bf16 v[64:79], a[236:239], a[44:47], v[64:79]
    ds_read_b128 a[228:231], v2 offset:34304
    v_exp_f32 v188, v188
    v_fma_f32 v189, v189, v39, v231
    v_add_f32 v232, v232, v219
    v_add_f32 v233, v233, v187
    v_exp_f32 v221, v221
    v_fma_f32 v222, v190, v38, v230
    v_exp_f32 v189, v189
    s_waitcnt lgkmcnt(2)
    v_mfma_f32_32x32x16_bf16 v[160:175], a[240:243], a[48:51], v[160:175]
    ds_read_b128 a[232:235], v2 offset:35328
    v_fma_f32 v190, v190, v39, v231
    v_add_f32 v232, v232, v220
    v_add_f32 v233, v233, v188
    v_exp_f32 v222, v222
    v_fma_f32 v223, v191, v38, v230
    v_exp_f32 v190, v190
    v_mfma_f32_32x32x16_bf16 v[48:63], a[244:247], a[48:51], v[48:63]
    ds_read_b128 a[236:239], v2 offset:36352
    buffer_load_dwordx4 a[44:47], v2, s[32:35], s7 offen offset:2048 sc1
    v_fma_f32 v191, v191, v39, v231
    v_add_f32 v232, v232, v221
    v_add_f32 v233, v233, v189
    v_exp_f32 v223, v223
    v_mfma_f32_32x32x16_bf16 v[64:79], a[248:251], a[48:51], v[64:79]
    ds_read_b128 a[240:243], v2 offset:37376
    v_fma_f32 v224, v192, v38, v230
    v_exp_f32 v191, v191
    v_fma_f32 v192, v192, v39, v231
    v_add_f32 v232, v232, v222
    v_add_f32 v233, v233, v190
    v_exp_f32 v224, v224
    v_mfma_f32_32x32x16_bf16 v[160:175], a[252:255], a[52:55], v[160:175]
    ds_read_b128 a[244:247], v2 offset:38400
    v_fma_f32 v225, v193, v38, v230
    v_exp_f32 v192, v192
    v_fma_f32 v193, v193, v39, v231
    v_add_f32 v232, v232, v223
    v_add_f32 v233, v233, v191
    v_exp_f32 v225, v225
    v_fma_f32 v226, v194, v38, v230
    s_waitcnt lgkmcnt(2)
    v_mfma_f32_32x32x16_bf16 v[48:63], a[224:227], a[52:55], v[48:63]
    ds_read_b128 a[248:251], v2 offset:39424
    buffer_load_dwordx4 a[48:51], v2, s[32:35], s7 offen offset:3072 sc1
    v_exp_f32 v193, v193
    v_fma_f32 v194, v194, v39, v231
    v_add_f32 v232, v232, v224
    v_add_f32 v233, v233, v192
    v_mfma_f32_32x32x16_bf16 v[64:79], a[228:231], a[52:55], v[64:79]
    ds_read_b128 a[252:255], v2 offset:40448
    v_exp_f32 v226, v226
    v_fma_f32 v227, v195, v38, v230
    v_exp_f32 v194, v194
    v_fma_f32 v195, v195, v39, v231
    v_add_f32 v232, v232, v225
    v_add_f32 v233, v233, v193
    v_mfma_f32_32x32x16_bf16 v[160:175], a[232:235], a[56:59], v[160:175]
    v_exp_f32 v227, v227
    v_exp_f32 v195, v195
    v_add_f32 v232, v232, v226
    v_add_f32 v233, v233, v194
    v_add_f32 v232, v232, v227
    v_add_f32 v233, v233, v195
    v_mfma_f32_32x32x16_bf16 v[48:63], a[236:239], a[56:59], v[48:63]
    s_waitcnt vmcnt(19)
    s_waitcnt lgkmcnt(0)
    s_barrier
    ds_read_b128 a[224:227], v2 offset:61952
    ds_read_b128 a[228:231], v2 offset:62976
    s_mul_i32 s5, s78, 12288
    s_add_u32 m0, s37, 143872
    s_add_u32 s5, s5, s39
    buffer_load_dwordx4 v2, s[32:35], s5 offen offset:0 sc1 lds
    v_mfma_f32_32x32x16_bf16 v[64:79], a[240:243], a[56:59], v[64:79]
    ds_read_b128 a[232:235], v2 offset:64000
    buffer_load_dwordx4 v2, s[32:35], s5 offen offset:1024 sc1 lds
    v_rcp_f32 v232, v232
    v_rcp_f32 v233, v233
    v_mul_f32 v208, v208, v232
    v_mfma_f32_32x32x16_bf16 v[160:175], a[244:247], a[60:63], v[160:175]
    ds_read_b128 a[236:239], v2 offset:65024
    v_mul_f32 v209, v209, v232
    v_mul_f32 v176, v176, v233
    buffer_load_dwordx4 v2, s[32:35], s5 offen offset:2048 sc1 lds
    v_mul_f32 v177, v177, v233
    v_cvt_pk_bf16_f32 v124, v208, v209
    v_cvt_pk_bf16_f32 v134, v176, v177
    v_mul_f32 v210, v210, v232
    v_mfma_f32_32x32x16_bf16 v[48:63], a[248:251], a[60:63], v[48:63]
    ds_read_b128 a[240:243], v3 offset:512
    v_mul_f32 v211, v211, v232
    v_mul_f32 v178, v178, v233
    v_mul_f32 v179, v179, v233
    v_cvt_pk_bf16_f32 v125, v210, v211
    v_cvt_pk_bf16_f32 v135, v178, v179
    v_mul_f32 v212, v212, v232
    s_mul_i32 s5, s79, 12288
    s_add_u32 m0, s37, 29184
    s_add_u32 s5, s5, s39
    buffer_load_dwordx4 v2, s[32:35], s5 offen offset:0 sc1 lds
    v_mfma_f32_32x32x16_bf16 v[64:79], a[252:255], a[60:63], v[64:79]
    ds_read_b128 a[244:247], v3 offset:1536
    v_mov_b32 v31, 0
    s_cmp_eq_u32 s64, 0
    s_cbranch_scc0 SK_58
    s_mov_b32 s15, s44
    buffer_load_dword v31, v28, s[32:35], s15 offen sc1
SK_58:
    s_waitcnt lgkmcnt(2)
    v_mfma_f32_32x32x16_bf16 v[160:175], a[224:227], a[64:67], v[160:175]
    ds_read_b128 a[248:251], v3 offset:2560
    v_mul_f32 v213, v213, v232
    v_mul_f32 v180, v180, v233
    v_mul_f32 v181, v181, v233
    v_cvt_pk_bf16_f32 v126, v212, v213
    v_cvt_pk_bf16_f32 v136, v180, v181
    v_mul_f32 v214, v214, v232
    v_mul_f32 v215, v215, v232
    v_mul_f32 v182, v182, v233
    s_add_u32 m0, s37, 29184
    s_nop 0
    buffer_load_dwordx4 v2, s[32:35], s5 offen offset:1024 sc1 lds
    v_mfma_f32_32x32x16_bf16 v[48:63], a[228:231], a[64:67], v[48:63]
    ds_read_b128 a[252:255], v3 offset:3584
    v_mul_f32 v183, v183, v233
    v_cvt_pk_bf16_f32 v127, v214, v215
    v_cvt_pk_bf16_f32 v137, v182, v183
    v_mul_f32 v216, v216, v232
    v_mul_f32 v217, v217, v232
    v_mfma_f32_32x32x16_bf16 v[64:79], a[232:235], a[64:67], v[64:79]
    ds_read_b128 a[224:227], v3 offset:4608
    buffer_load_dwordx4 v2, s[32:35], s5 offen offset:2048 sc1 lds
    v_mul_f32 v184, v184, v233
    v_mul_f32 v185, v185, v233
    v_cvt_pk_bf16_f32 v128, v216, v217
    v_cvt_pk_bf16_f32 v138, v184, v185
    v_mul_f32 v218, v218, v232
    v_mfma_f32_32x32x16_bf16 v[160:175], a[236:239], a[68:71], v[160:175]
    ds_read_b128 a[228:231], v3 offset:5632
    buffer_load_dwordx4 a[52:55], v11, s[32:35], s7 offen offset:0 sc1
    v_mul_f32 v219, v219, v232
    v_mul_f32 v186, v186, v233
    v_mul_f32 v187, v187, v233
    v_cvt_pk_bf16_f32 v129, v218, v219
    v_cvt_pk_bf16_f32 v139, v186, v187
    s_waitcnt lgkmcnt(2)
    v_mfma_f32_32x32x16_bf16 v[48:63], a[240:243], a[68:71], v[48:63]
    ds_read_b128 a[232:235], v3 offset:6656
    s_bfe_u32 s12, 26454, s55
    s_lshl_b32 s12, s12, 13
    s_add_u32 s7, s12, s95
    buffer_load_dwordx4 a[56:59], v2, s[32:35], s7 offen offset:0 sc1
    v_mul_f32 v220, v220, v232
    v_mul_f32 v221, v221, v232
    v_mul_f32 v188, v188, v233
    v_mul_f32 v189, v189, v233
    v_mfma_f32_32x32x16_bf16 v[64:79], a[244:247], a[68:71], v[64:79]
    ds_read_b128 a[236:239], v3 offset:7680
    buffer_load_dwordx4 a[60:63], v2, s[32:35], s7 offen offset:1024 sc1
    v_cvt_pk_bf16_f32 v130, v220, v221
    v_cvt_pk_bf16_f32 v140, v188, v189
    v_mul_f32 v222, v222, v232
    v_mul_f32 v223, v223, v232
    v_mul_f32 v190, v190, v233
    v_mfma_f32_32x32x16_bf16 v[160:175], a[248:251], a[72:75], v[160:175]
    ds_read_b128 a[240:243], v2 offset:45568
    v_mul_f32 v191, v191, v233
    v_cvt_pk_bf16_f32 v131, v222, v223
    v_cvt_pk_bf16_f32 v141, v190, v191
    v_mul_f32 v224, v224, v232
    buffer_load_dwordx4 a[64:67], v2, s[32:35], s7 offen offset:2048 sc1
    v_mul_f32 v225, v225, v232
    v_mul_f32 v192, v192, v233
    v_mfma_f32_32x32x16_bf16 v[48:63], a[252:255], a[72:75], v[48:63]
    ds_read_b128 a[244:247], v2 offset:46592
    v_mul_f32 v193, v193, v233
    v_cvt_pk_bf16_f32 v132, v224, v225
    v_cvt_pk_bf16_f32 v142, v192, v193
    v_mul_f32 v226, v226, v232
    v_mul_f32 v227, v227, v232
    v_mul_f32 v194, v194, v233
    v_mul_f32 v195, v195, v233
    v_cvt_pk_bf16_f32 v133, v226, v227
    buffer_load_dwordx4 a[68:71], v2, s[32:35], s7 offen offset:3072 sc1
    s_waitcnt lgkmcnt(2)
    v_mfma_f32_32x32x16_bf16 v[64:79], a[224:227], a[72:75], v[64:79]
    ds_read_b128 a[248:251], v2 offset:47616
    v_cvt_pk_bf16_f32 v143, v194, v195
    v_xor_b32 v234, 0, v21
    ds_write_b128 v234, v[124:127]
    v_xor_b32 v235, 16, v21
    ds_write_b128 v235, v[128:131]
    v_mfma_f32_32x32x16_bf16 v[160:175], a[228:231], a[76:79], v[160:175]
    ds_read_b128 a[252:255], v2 offset:48640
    v_xor_b32 v234, 32, v21
    ds_write_b128 v234, v[132:135]
    v_xor_b32 v235, 48, v21
    ds_write_b128 v235, v[136:139]
    v_xor_b32 v234, 128, v21
    ds_write_b128 v234, v[140:143]
    v_mfma_f32_32x32x16_bf16 v[48:63], a[232:235], a[76:79], v[48:63]
    ds_read_b128 a[224:227], v2 offset:49664
    buffer_load_dwordx4 a[72:75], v11, s[32:35], s7 offen offset:0 sc1
    v_mfma_f32_32x32x16_bf16 v[64:79], a[236:239], a[76:79], v[64:79]
    ds_read_b128 a[228:231], v2 offset:50688
    s_waitcnt lgkmcnt(5)
    v_mfma_f32_32x32x16_bf16 v[160:175], a[240:243], a[80:83], v[160:175]
    ds_read_b128 a[232:235], v2 offset:51712
    s_waitcnt lgkmcnt(3)
    s_barrier
    ds_read_b64_tr_b16 v[176:177], v24 offset:0
    ds_read_b64_tr_b16 v[178:179], v25 offset:0
    ds_read_b64_tr_b16 v[180:181], v26 offset:0
    ds_read_b64_tr_b16 v[182:183], v27 offset:0
    ds_read_b64_tr_b16 v[184:185], v24 offset:4096
    ds_read_b64_tr_b16 v[186:187], v25 offset:4096
    ds_read_b64_tr_b16 v[188:189], v26 offset:4096
    ds_read_b64_tr_b16 v[190:191], v27 offset:4096
    v_mfma_f32_32x32x16_bf16 v[48:63], a[244:247], a[80:83], v[48:63]
    ds_read_b128 a[236:239], v2 offset:52736
    s_bfe_u32 s12, 30327, s55
    s_lshl_b32 s12, s12, 13
    s_add_u32 s7, s12, s95
    buffer_load_dwordx4 a[76:79], v2, s[32:35], s7 offen offset:0 sc1
    v_mfma_f32_32x32x16_bf16 v[64:79], a[248:251], a[80:83], v[64:79]
    ds_read_b128 a[240:243], v2 offset:53760
    ds_read_b64_tr_b16 v[192:193], v24 offset:8192
    ds_read_b64_tr_b16 v[194:195], v25 offset:8192
    s_waitcnt lgkmcnt(13)
    ds_read_b64_tr_b16 v[196:197], v26 offset:8192
    ds_read_b64_tr_b16 v[198:199], v27 offset:8192
    s_waitcnt lgkmcnt(10)
    v_mfma_f32_32x32x16_bf16 v[112:127], v[176:179], v[180:183], 0
    v_mfma_f32_32x32x16_bf16 v[160:175], a[252:255], a[84:87], v[160:175]
    ds_read_b128 a[244:247], v2 offset:54784
    ds_read_b64_tr_b16 v[200:201], v24 offset:12288
    ds_read_b64_tr_b16 v[202:203], v25 offset:12288
    ds_read_b64_tr_b16 v[204:205], v26 offset:12288
    ds_read_b64_tr_b16 v[206:207], v27 offset:12288
    s_waitcnt lgkmcnt(11)
    v_mfma_f32_32x32x16_bf16 v[112:127], v[184:187], v[188:191], v[112:127]
    s_waitcnt lgkmcnt(10)
    v_mfma_f32_32x32x16_bf16 v[48:63], a[224:227], a[84:87], v[48:63]
    ds_read_b128 a[248:251], v2 offset:55808
    buffer_load_dwordx4 a[80:83], v2, s[32:35], s7 offen offset:1024 sc1
    ds_read_b64_tr_b16 v[176:177], v24 offset:16384
    ds_read_b64_tr_b16 v[178:179], v25 offset:16384
    ds_read_b64_tr_b16 v[180:181], v26 offset:16384
    ds_read_b64_tr_b16 v[182:183], v27 offset:16384
    s_waitcnt lgkmcnt(10)
    v_mfma_f32_32x32x16_bf16 v[112:127], v[192:195], v[196:199], v[112:127]
    v_mfma_f32_32x32x16_bf16 v[64:79], a[228:231], a[84:87], v[64:79]
    ds_read_b128 a[252:255], v2 offset:56832
    ds_read_b64_tr_b16 v[184:185], v24 offset:20480
    ds_read_b64_tr_b16 v[186:187], v25 offset:20480
    ds_read_b64_tr_b16 v[188:189], v26 offset:20480
    ds_read_b64_tr_b16 v[190:191], v27 offset:20480
    s_waitcnt lgkmcnt(10)
    v_mfma_f32_32x32x16_bf16 v[112:127], v[200:203], v[204:207], v[112:127]
    v_mfma_f32_32x32x16_bf16 v[160:175], a[232:235], a[88:91], v[160:175]
    ds_read_b64_tr_b16 v[192:193], v24 offset:24576
    ds_read_b64_tr_b16 v[194:195], v25 offset:24576
    ds_read_b64_tr_b16 v[196:197], v26 offset:24576
    ds_read_b64_tr_b16 v[198:199], v27 offset:24576
    s_waitcnt lgkmcnt(9)
    v_mfma_f32_32x32x16_bf16 v[112:127], v[176:179], v[180:183], v[112:127]
    v_mfma_f32_32x32x16_bf16 v[48:63], a[236:239], a[88:91], v[48:63]
    s_waitcnt vmcnt(22)
    s_waitcnt lgkmcnt(8)
    s_waitcnt vmcnt(10)
    v_cmp_ne_u32 s[100:101], s23, v31
    s_nop 0
    s_cmp_lg_u64 s[100:101], 0
    s_cbranch_scc1 M_slow_h1
M_back_h1:
    s_barrier
    ds_read_b128 a[224:227], v3 offset:61952
    ds_read_b128 a[228:231], v3 offset:62976
    s_bfe_u32 s12, 1, s55
    s_lshl_b32 s12, s12, 10
    s_add_u32 s6, s12, s92
    buffer_load_dwordx4 a[84:87], v12, s[32:35], s6 offen sc1
    v_mfma_f32_32x32x16_bf16 v[64:79], a[240:243], a[88:91], v[64:79]
    ds_read_b128 a[232:235], v3 offset:64000
    ds_read_b64_tr_b16 v[200:201], v24 offset:28672
    ds_read_b64_tr_b16 v[202:203], v25 offset:28672
    ds_read_b64_tr_b16 v[204:205], v26 offset:28672
    ds_read_b64_tr_b16 v[206:207], v27 offset:28672
    s_waitcnt lgkmcnt(11)
    v_mfma_f32_32x32x16_bf16 v[112:127], v[184:187], v[188:191], v[112:127]
    v_mfma_f32_32x32x16_bf16 v[160:175], a[244:247], a[92:95], v[160:175]
    ds_read_b128 a[236:239], v3 offset:65024
    s_waitcnt lgkmcnt(8)
    v_mfma_f32_32x32x16_bf16 v[112:127], v[192:195], v[196:199], v[112:127]
    v_mfma_f32_32x32x16_bf16 v[48:63], a[248:251], a[92:95], v[48:63]
    ds_read_b128 a[240:243], v47 offset:512
    buffer_load_dwordx4 a[88:91], v13, s[32:35], s6 offen sc1
    s_waitcnt lgkmcnt(2)
    v_mfma_f32_32x32x16_bf16 v[112:127], v[200:203], v[204:207], v[112:127]
    v_mfma_f32_32x32x16_bf16 v[64:79], a[252:255], a[92:95], v[64:79]
    ds_read_b128 a[244:247], v47 offset:1536
    s_waitcnt lgkmcnt(2)
    v_mfma_f32_32x32x16_bf16 v[160:175], a[224:227], a[96:99], v[160:175]
    ds_read_b128 a[248:251], v47 offset:2560
    v_mfma_f32_32x32x16_bf16 v[48:63], a[228:231], a[96:99], v[48:63]
    ds_read_b128 a[252:255], v47 offset:3584
    buffer_load_dwordx4 a[92:95], v14, s[32:35], s6 offen sc1
    v_mfma_f32_32x32x16_bf16 v[64:79], a[232:235], a[96:99], v[64:79]
    ds_read_b128 a[224:227], v47 offset:4608
    v_mfma_f32_32x32x16_bf16 v[160:175], a[236:239], a[100:103], v[160:175]
    ds_read_b128 a[228:231], v47 offset:5632
    v_cvt_pk_bf16_f32 v128, v112, v113
    v_cvt_pk_bf16_f32 v129, v114, v115
    v_cvt_pk_bf16_f32 v130, v116, v117
    v_cvt_pk_bf16_f32 v131, v118, v119
    v_cvt_pk_bf16_f32 v132, v120, v121
    v_cvt_pk_bf16_f32 v133, v122, v123
    v_cvt_pk_bf16_f32 v134, v124, v125
    v_cvt_pk_bf16_f32 v135, v126, v127
    s_waitcnt lgkmcnt(2)
    v_mfma_f32_32x32x16_bf16 v[48:63], a[240:243], a[100:103], v[48:63]
    ds_read_b128 a[232:235], v47 offset:6656
    buffer_load_dwordx4 a[96:99], v30, s[32:35], s6 offen sc1
    buffer_store_dwordx4 v[128:131], v22, s[32:35], s51 offen sc1
    s_bitcmp0_b32 s64, 0
    s_cbranch_scc0 SK_59
    buffer_store_dwordx4 v[132:135], v23, s[32:35], s51 offen offset:672 sc1
SK_59:
    v_mfma_f32_32x32x16_bf16 v[64:79], a[244:247], a[100:103], v[64:79]
    ds_read_b128 a[236:239], v47 offset:7680
    v_and_b32 v32, 0xf0, v2
    v_and_b32 v33, 16, v2
    v_mov_b32 v34, 0x3f80
    v_lshlrev_b32 v33, v33, v34
    v_lshrrev_b32 v32, 5, v32
    v_mfma_f32_32x32x16_bf16 v[160:175], a[248:251], a[104:107], v[160:175]
    ds_read_b128 a[240:243], v2 offset:12800
    v_cmp_eq_u32 vcc, 0, v32
    v_mfma_f32_32x32x16_bf16 v[48:63], a[252:255], a[104:107], v[48:63]
    ds_read_b128 a[244:247], v2 offset:13824
    v_cndmask_b32 v24, 0, v33, vcc
    v_cmp_eq_u32 vcc, 1, v32
    s_waitcnt lgkmcnt(2)
    v_mfma_f32_32x32x16_bf16 v[64:79], a[224:227], a[104:107], v[64:79]
    ds_read_b128 a[248:251], v2 offset:14848
    v_cndmask_b32 v25, 0, v33, vcc
    v_cmp_eq_u32 vcc, 2, v32
    v_mfma_f32_32x32x16_bf16 v[160:175], a[228:231], a[108:111], v[160:175]
    ds_read_b128 a[252:255], v2 offset:15872
    v_cndmask_b32 v26, 0, v33, vcc
    v_cmp_eq_u32 vcc, 3, v32
    v_mfma_f32_32x32x16_bf16 v[48:63], a[232:235], a[108:111], v[48:63]
    ds_read_b128 a[224:227], v2 offset:16896
    s_bfe_u32 s12, 4384, s55
    s_lshl_b32 s12, s12, 10
    s_add_u32 s6, s12, s92
    buffer_load_dwordx4 a[100:103], v12, s[32:35], s6 offen sc1
    v_cndmask_b32 v27, 0, v33, vcc
    s_cmp_eq_u32 s60, 15
    s_cselect_b32 s56, s64, 0
    s_cmp_eq_u32 s56, 3
    s_cselect_b32 s56, 1073741824, 0
    v_mfma_f32_32x32x16_bf16 v[64:79], a[236:239], a[108:111], v[64:79]
    ds_read_b128 a[228:231], v2 offset:17920
    v_add_u32 v19, s56, v19
    buffer_load_dwordx4 a[104:107], v13, s[32:35], s6 offen sc1
    s_waitcnt lgkmcnt(2)
    v_mfma_f32_32x32x16_bf16 v[160:175], a[240:243], a[112:115], v[160:175]
    ds_read_b128 a[232:235], v2 offset:18944
    v_mfma_f32_32x32x16_bf16 v[48:63], a[244:247], a[112:115], v[48:63]
    ds_read_b128 a[236:239], v2 offset:19968
    v_mfma_f32_32x32x16_bf16 v[64:79], a[248:251], a[112:115], v[64:79]
    ds_read_b128 a[240:243], v2 offset:20992
    buffer_load_dwordx4 a[108:111], v14, s[32:35], s6 offen sc1
    v_mfma_f32_32x32x16_bf16 v[160:175], a[252:255], a[116:119], v[160:175]
    ds_read_b128 a[244:247], v2 offset:22016
    s_waitcnt lgkmcnt(2)
    v_mfma_f32_32x32x16_bf16 v[48:63], a[224:227], a[116:119], v[48:63]
    ds_read_b128 a[248:251], v2 offset:23040
    buffer_load_dwordx4 a[112:115], v30, s[32:35], s6 offen sc1
    v_mfma_f32_32x32x16_bf16 v[64:79], a[228:231], a[116:119], v[64:79]
    ds_read_b128 a[252:255], v2 offset:24064
    v_mfma_f32_32x32x16_bf16 v[160:175], a[232:235], a[120:123], v[160:175]
    v_mfma_f32_32x32x16_bf16 v[48:63], a[236:239], a[120:123], v[48:63]
    s_waitcnt vmcnt(17)
    s_waitcnt lgkmcnt(0)
    s_barrier
    ds_read_b128 a[224:227], v47 offset:12800
    ds_read_b128 a[228:231], v47 offset:13824
    s_bfe_u32 s12, 8978, s55
    s_lshl_b32 s12, s12, 10
    s_add_u32 s6, s12, s92
    buffer_load_dwordx4 a[116:119], v12, s[32:35], s6 offen sc1
    v_mfma_f32_32x32x16_bf16 v[64:79], a[240:243], a[120:123], v[64:79]
    ds_read_b128 a[232:235], v47 offset:14848
    v_mfma_f32_32x32x16_bf16 v[160:175], a[244:247], a[124:127], v[160:175]
    ds_read_b128 a[236:239], v47 offset:15872
    v_mfma_f32_32x32x16_bf16 v[48:63], a[248:251], a[124:127], v[48:63]
    ds_read_b128 a[240:243], v47 offset:16896
    buffer_load_dwordx4 a[120:123], v13, s[32:35], s6 offen sc1
    v_mfma_f32_32x32x16_bf16 v[64:79], a[252:255], a[124:127], v[64:79]
    ds_read_b128 a[244:247], v47 offset:17920
    s_waitcnt lgkmcnt(2)
    v_mfma_f32_32x32x16_bf16 v[160:175], a[224:227], a[128:131], v[160:175]
    ds_read_b128 a[248:251], v47 offset:18944
    v_mfma_f32_32x32x16_bf16 v[48:63], a[228:231], a[128:131], v[48:63]
    ds_read_b128 a[252:255], v47 offset:19968
    buffer_load_dwordx4 a[124:127], v14, s[32:35], s6 offen sc1
    v_mfma_f32_32x32x16_bf16 v[64:79], a[232:235], a[128:131], v[64:79]
    ds_read_b128 a[224:227], v47 offset:20992
    v_mfma_f32_32x32x16_bf16 v[160:175], a[236:239], a[132:135], v[160:175]
    ds_read_b128 a[228:231], v47 offset:22016
    s_waitcnt lgkmcnt(2)
    v_mfma_f32_32x32x16_bf16 v[48:63], a[240:243], a[132:135], v[48:63]
    ds_read_b128 a[232:235], v47 offset:23040
    buffer_load_dwordx4 a[128:131], v30, s[32:35], s6 offen sc1
    v_mfma_f32_32x32x16_bf16 v[64:79], a[244:247], a[132:135], v[64:79]
    ds_read_b128 a[236:239], v47 offset:24064
    v_mfma_f32_32x32x16_bf16 v[160:175], a[248:251], a[136:139], v[160:175]
    ds_read_b128 a[240:243], v2 offset:29184
    v_mfma_f32_32x32x16_bf16 v[48:63], a[252:255], a[136:139], v[48:63]
    ds_read_b128 a[244:247], v2 offset:30208
    s_bfe_u32 s12, 16947, s55
    s_lshl_b32 s12, s12, 10
    s_add_u32 s6, s12, s92
    buffer_load_dwordx4 a[132:135], v12, s[32:35], s6 offen sc1
    s_waitcnt lgkmcnt(2)
    v_mfma_f32_32x32x16_bf16 v[64:79], a[224:227], a[136:139], v[64:79]
    ds_read_b128 a[248:251], v2 offset:31232
    v_mfma_f32_32x32x16_bf16 v[160:175], a[228:231], a[140:143], v[160:175]
    ds_read_b128 a[252:255], v2 offset:32256
    v_mfma_f32_32x32x16_bf16 v[48:63], a[232:235], a[140:143], v[48:63]
    ds_read_b128 a[224:227], v2 offset:33280
    buffer_load_dwordx4 a[136:139], v13, s[32:35], s6 offen sc1
    v_mfma_f32_32x32x16_bf16 v[64:79], a[236:239], a[140:143], v[64:79]
    ds_read_b128 a[228:231], v2 offset:34304
    s_waitcnt lgkmcnt(2)
    v_mfma_f32_32x32x16_bf16 v[160:175], a[240:243], a[144:147], v[160:175]
    ds_read_b128 a[232:235], v2 offset:35328
    v_mfma_f32_32x32x16_bf16 v[48:63], a[244:247], a[144:147], v[48:63]
    ds_read_b128 a[236:239], v2 offset:36352
    buffer_load_dwordx4 a[140:143], v14, s[32:35], s6 offen sc1
    v_mfma_f32_32x32x16_bf16 v[64:79], a[248:251], a[144:147], v[64:79]
    ds_read_b128 a[240:243], v2 offset:37376
    v_mfma_f32_32x32x16_bf16 v[160:175], a[252:255], a[148:151], v[160:175]
    ds_read_b128 a[244:247], v2 offset:38400
    s_waitcnt lgkmcnt(2)
    v_mfma_f32_32x32x16_bf16 v[48:63], a[224:227], a[148:151], v[48:63]
    ds_read_b128 a[248:251], v2 offset:39424
    buffer_load_dwordx4 a[144:147], v30, s[32:35], s6 offen sc1
    v_mfma_f32_32x32x16_bf16 v[64:79], a[228:231], a[148:151], v[64:79]
    ds_read_b128 a[252:255], v2 offset:40448
    v_mfma_f32_32x32x16_bf16 v[160:175], a[232:235], a[152:155], v[160:175]
    v_mfma_f32_32x32x16_bf16 v[48:63], a[236:239], a[152:155], v[48:63]
    s_bfe_u32 s12, 13381, s55
    s_lshl_b32 s12, s12, 10
    s_add_u32 s6, s12, s92
    buffer_load_dwordx4 a[148:151], v12, s[32:35], s6 offen sc1
    s_waitcnt lgkmcnt(0)
    v_mfma_f32_32x32x16_bf16 v[64:79], a[240:243], a[152:155], v[64:79]
    v_mfma_f32_32x32x16_bf16 v[160:175], a[244:247], a[156:159], v[160:175]
    buffer_load_dwordx4 v[42:45], v19, s[32:35], s50 offen sc1
    v_mfma_f32_32x32x16_bf16 v[48:63], a[248:251], a[156:159], v[48:63]
    buffer_load_dwordx4 a[152:155], v13, s[32:35], s6 offen sc1
    v_mfma_f32_32x32x16_bf16 v[64:79], a[252:255], a[156:159], v[64:79]
    buffer_load_dwordx4 a[156:159], v14, s[32:35], s6 offen sc1
    buffer_load_dwordx4 a[224:227], v30, s[32:35], s6 offen sc1
    s_bfe_u32 s12, 21860, s55
    s_lshl_b32 s12, s12, 10
    s_add_u32 s6, s12, s92
    buffer_load_dwordx4 a[228:231], v12, s[32:35], s6 offen sc1
    v_cvt_pk_bf16_f32 v208, v152, v153
    v_cvt_pk_bf16_f32 v209, v154, v155
    v_cvt_pk_bf16_f32 v210, v156, v157
    v_cvt_pk_bf16_f32 v211, v158, v159
    v_cvt_pk_bf16_f32 v212, v160, v161
    v_cvt_pk_bf16_f32 v213, v162, v163
    v_cvt_pk_bf16_f32 v214, v164, v165
    v_cvt_pk_bf16_f32 v215, v166, v167
    v_cvt_pk_bf16_f32 v216, v168, v169
    buffer_load_dwordx4 a[232:235], v13, s[32:35], s6 offen sc1
    v_cvt_pk_bf16_f32 v217, v170, v171
    v_mov_b32 v218, 0
    v_mov_b32 v219, 0
    s_waitcnt vmcnt(22)
    v_mfma_f32_16x16x32_bf16 v[80:83], a[160:163], a[84:87], 0
    v_pk_mul_f32 v[160:161], v[48:49], v[38:39] op_sel:[0,1] op_sel_hi:[1,1]
    v_pk_mul_f32 v[48:49], v[48:49], v[64:65] op_sel:[0,0] op_sel_hi:[1,1]
    v_pk_mul_f32 v[162:163], v[50:51], v[38:39] op_sel:[0,1] op_sel_hi:[1,1]
    v_pk_mul_f32 v[50:51], v[50:51], v[66:67] op_sel:[0,0] op_sel_hi:[1,1]
    v_pk_mul_f32 v[164:165], v[52:53], v[38:39] op_sel:[0,1] op_sel_hi:[1,1]
    v_pk_mul_f32 v[52:53], v[52:53], v[68:69] op_sel:[0,0] op_sel_hi:[1,1]
    v_pk_mul_f32 v[166:167], v[54:55], v[38:39] op_sel:[0,1] op_sel_hi:[1,1]
    buffer_load_dwordx4 a[236:239], v14, s[32:35], s6 offen sc1
    v_pk_mul_f32 v[54:55], v[54:55], v[70:71] op_sel:[0,0] op_sel_hi:[1,1]
    v_pk_mul_f32 v[168:169], v[56:57], v[38:39] op_sel:[0,1] op_sel_hi:[1,1]
    v_pk_mul_f32 v[56:57], v[56:57], v[72:73] op_sel:[0,0] op_sel_hi:[1,1]
    v_mfma_f32_16x16x32_bf16 v[84:87], a[164:167], a[84:87], 0
    v_pk_mul_f32 v[170:171], v[58:59], v[38:39] op_sel:[0,1] op_sel_hi:[1,1]
    v_pk_mul_f32 v[58:59], v[58:59], v[74:75] op_sel:[0,0] op_sel_hi:[1,1]
    v_pk_mul_f32 v[172:173], v[60:61], v[38:39] op_sel:[0,1] op_sel_hi:[1,1]
    v_pk_mul_f32 v[60:61], v[60:61], v[76:77] op_sel:[0,0] op_sel_hi:[1,1]
    v_pk_mul_f32 v[174:175], v[62:63], v[38:39] op_sel:[0,1] op_sel_hi:[1,1]
    v_pk_mul_f32 v[62:63], v[62:63], v[78:79] op_sel:[0,0] op_sel_hi:[1,1]
    v_exp_f32 v160, v160
    buffer_load_dwordx4 a[240:243], v30, s[32:35], s6 offen sc1
    v_mfma_f32_16x16x32_bf16 v[88:91], a[168:171], a[84:87], 0
    v_exp_f32 v161, v161
    v_exp_f32 v162, v162
    v_exp_f32 v163, v163
    v_mfma_f32_16x16x32_bf16 v[92:95], a[172:175], a[84:87], 0
    v_exp_f32 v164, v164
    v_exp_f32 v165, v165
    v_exp_f32 v166, v166
    v_mfma_f32_16x16x32_bf16 v[96:99], a[176:179], a[84:87], 0
    s_bfe_u32 s12, 26454, s55
    s_lshl_b32 s12, s12, 10
    s_add_u32 s6, s12, s92
    buffer_load_dwordx4 a[244:247], v12, s[32:35], s6 offen sc1
    v_exp_f32 v167, v167
    v_exp_f32 v168, v168
    v_exp_f32 v169, v169
    v_exp_f32 v170, v170
    buffer_load_dwordx4 a[248:251], v13, s[32:35], s6 offen sc1
    v_exp_f32 v171, v171
    v_exp_f32 v172, v172
    v_exp_f32 v173, v173
    v_exp_f32 v174, v174
    v_exp_f32 v175, v175
    v_pk_fma_f32 v[160:161], v[160:161], v[36:37], v[36:37] op_sel:[0,1,1] op_sel_hi:[1,1,1]
    v_mfma_f32_16x16x32_bf16 v[100:103], a[160:163], a[88:91], 0
    buffer_load_dwordx4 a[252:255], v14, s[32:35], s6 offen sc1
    v_pk_fma_f32 v[162:163], v[162:163], v[36:37], v[36:37] op_sel:[0,1,1] op_sel_hi:[1,1,1]
    v_pk_fma_f32 v[164:165], v[164:165], v[36:37], v[36:37] op_sel:[0,1,1] op_sel_hi:[1,1,1]
    v_pk_fma_f32 v[166:167], v[166:167], v[36:37], v[36:37] op_sel:[0,1,1] op_sel_hi:[1,1,1]
    v_pk_fma_f32 v[168:169], v[168:169], v[36:37], v[36:37] op_sel:[0,1,1] op_sel_hi:[1,1,1]
    v_pk_fma_f32 v[170:171], v[170:171], v[36:37], v[36:37] op_sel:[0,1,1] op_sel_hi:[1,1,1]
    v_pk_fma_f32 v[172:173], v[172:173], v[36:37], v[36:37] op_sel:[0,1,1] op_sel_hi:[1,1,1]
    v_pk_fma_f32 v[174:175], v[174:175], v[36:37], v[36:37] op_sel:[0,1,1] op_sel_hi:[1,1,1]
    v_rcp_f32 v160, v160
    v_rcp_f32 v161, v161
    v_rcp_f32 v162, v162
    buffer_load_dwordx4 a[84:87], v30, s[32:35], s6 offen sc1
    v_mfma_f32_16x16x32_bf16 v[104:107], a[164:167], a[88:91], 0
    v_rcp_f32 v163, v163
    v_rcp_f32 v164, v164
    v_rcp_f32 v165, v165
    v_mfma_f32_16x16x32_bf16 v[108:111], a[168:171], a[88:91], 0
    v_rcp_f32 v166, v166
    v_rcp_f32 v167, v167
    v_rcp_f32 v168, v168
    v_mfma_f32_16x16x32_bf16 v[112:115], a[172:175], a[88:91], 0
    v_rcp_f32 v169, v169
    v_rcp_f32 v170, v170
    v_rcp_f32 v171, v171
    v_mfma_f32_16x16x32_bf16 v[116:119], a[176:179], a[88:91], 0
    buffer_load_dwordx4 a[88:91], v2, s[32:35], s7 offen offset:2048 sc1
    v_rcp_f32 v172, v172
    v_rcp_f32 v173, v173
    v_rcp_f32 v174, v174
    s_waitcnt vmcnt(27)
    v_mfma_f32_16x16x32_bf16 v[120:123], a[160:163], a[92:95], 0
    v_rcp_f32 v175, v175
    v_pk_mul_f32 v[48:49], v[48:49], v[160:161] op_sel:[0,0] op_sel_hi:[1,1]
    v_pk_mul_f32 v[50:51], v[50:51], v[162:163] op_sel:[0,0] op_sel_hi:[1,1]
    v_mfma_f32_16x16x32_bf16 v[124:127], a[164:167], a[92:95], 0
    v_pk_mul_f32 v[52:53], v[52:53], v[164:165] op_sel:[0,0] op_sel_hi:[1,1]
    v_pk_mul_f32 v[54:55], v[54:55], v[166:167] op_sel:[0,0] op_sel_hi:[1,1]
    v_pk_mul_f32 v[56:57], v[56:57], v[168:169] op_sel:[0,0] op_sel_hi:[1,1]
    v_mfma_f32_16x16x32_bf16 v[128:131], a[168:171], a[92:95], 0
    v_pk_mul_f32 v[58:59], v[58:59], v[170:171] op_sel:[0,0] op_sel_hi:[1,1]
    v_pk_mul_f32 v[60:61], v[60:61], v[172:173] op_sel:[0,0] op_sel_hi:[1,1]
    v_pk_mul_f32 v[62:63], v[62:63], v[174:175] op_sel:[0,0] op_sel_hi:[1,1]
    v_mfma_f32_16x16x32_bf16 v[132:135], a[172:175], a[92:95], 0
    v_cvt_pk_bf16_f32 v160, v48, v49
    v_cvt_pk_bf16_f32 v161, v50, v51
    v_cvt_pk_bf16_f32 v162, v52, v53
    v_mfma_f32_16x16x32_bf16 v[136:139], a[176:179], a[92:95], 0
    buffer_load_dwordx4 a[92:95], v2, s[32:35], s7 offen offset:3072 sc1
    v_cvt_pk_bf16_f32 v163, v54, v55
    v_cvt_pk_bf16_f32 v164, v56, v57
    v_cvt_pk_bf16_f32 v165, v58, v59
    v_mfma_f32_16x16x32_bf16 v[140:143], a[160:163], a[96:99], 0
    buffer_load_dwordx4 a[160:163], v11, s[32:35], s7 offen offset:0 sc1
    v_cvt_pk_bf16_f32 v166, v60, v61
    v_cvt_pk_bf16_f32 v167, v62, v63
    buffer_store_dwordx4 v[160:163], v20, s[32:35], s53 offen offset:0 sc1
    v_mfma_f32_16x16x32_bf16 v[144:147], a[164:167], a[96:99], 0
    v_mfma_f32_16x16x32_bf16 v[148:151], a[168:171], a[96:99], 0
    s_waitcnt vmcnt(15)
    v_mfma_f32_16x16x32_bf16 v[32:35], v[24:27], v[42:45], 0
    s_nop 7
    v_cmp_u_f32 s[100:101], v32, v32
    s_nop 0
    s_cmp_lg_u64 s[100:101], 0
    s_cbranch_scc1 M_slow_kva
M_back_kva:
    v_add_f32_dpp v32, v32, v32 row_ror:4 row_mask:0xf bank_mask:0xf
    v_mfma_f32_16x16x32_bf16 v[152:155], a[172:175], a[96:99], 0
    v_add_f32_dpp v33, v33, v33 row_ror:4 row_mask:0xf bank_mask:0xf
    v_add_f32_dpp v34, v34, v34 row_ror:4 row_mask:0xf bank_mask:0xf
    v_add_f32_dpp v35, v35, v35 row_ror:4 row_mask:0xf bank_mask:0xf
    v_mfma_f32_16x16x32_bf16 v[156:159], a[176:179], a[96:99], 0
    s_bfe_u32 s12, 30327, s55
    s_lshl_b32 s12, s12, 10
    s_add_u32 s6, s12, s92
    buffer_load_dwordx4 a[164:167], v12, s[32:35], s6 offen sc1
    v_add_f32_dpp v32, v32, v32 row_ror:8 row_mask:0xf bank_mask:0xf
    v_add_f32_dpp v33, v33, v33 row_ror:8 row_mask:0xf bank_mask:0xf
    v_add_f32_dpp v34, v34, v34 row_ror:8 row_mask:0xf bank_mask:0xf
    v_add_f32_dpp v35, v35, v35 row_ror:8 row_mask:0xf bank_mask:0xf
    v_cvt_pk_bf16_f32 v42, v32, v33
    v_cvt_pk_bf16_f32 v43, v34, v35
    buffer_store_dwordx2 v[42:43], v0, s[32:35], s40 offen sc1
    ds_read_b64_tr_b16 v[236:237], v16 offset:0
    v_mfma_f32_16x16x32_bf16 v[80:83], a[180:183], a[100:103], v[80:83]
    ds_read_b64_tr_b16 v[238:239], v16 offset:160
    ds_read_b64_tr_b16 v[248:249], v17 offset:0
    ds_read_b64_tr_b16 v[250:251], v17 offset:160
    ds_read_b64_tr_b16 v[240:241], v16 offset:320
    ds_read_b64_tr_b16 v[242:243], v16 offset:480
    ds_read_b64_tr_b16 v[252:253], v17 offset:320
    ds_read_b64_tr_b16 v[254:255], v17 offset:480
    ds_read_b64_tr_b16 v[244:245], v16 offset:640
    ds_read_b64_tr_b16 v[220:221], v17 offset:640
    v_mov_b32 v246, 0
    v_mfma_f32_16x16x32_bf16 v[84:87], a[184:187], a[100:103], v[84:87]
    v_mov_b32 v247, 0
    v_mov_b32 v222, 0
    v_mov_b32 v223, 0
    s_waitcnt lgkmcnt(8)
    v_mfma_f32_32x32x16_bf16 v[176:191], v[236:239], v[208:211], 0
    buffer_load_dwordx4 a[168:171], v13, s[32:35], s6 offen sc1
    s_waitcnt lgkmcnt(6)
    v_mfma_f32_32x32x16_bf16 v[192:207], v[248:251], v[208:211], 0
    s_waitcnt lgkmcnt(4)
    v_mfma_f32_32x32x16_bf16 v[176:191], v[240:243], v[212:215], v[176:191]
    buffer_load_dwordx4 a[172:175], v14, s[32:35], s6 offen sc1
    s_waitcnt lgkmcnt(2)
    v_mfma_f32_32x32x16_bf16 v[192:207], v[252:255], v[212:215], v[192:207]
    s_waitcnt lgkmcnt(1)
    v_mfma_f32_32x32x16_bf16 v[176:191], v[244:247], v[216:219], v[176:191]
    buffer_load_dwordx4 a[96:99], v30, s[32:35], s6 offen sc1
    s_waitcnt lgkmcnt(0)
    v_mfma_f32_32x32x16_bf16 v[192:207], v[220:223], v[216:219], v[192:207]
    buffer_store_dwordx4 v[164:167], v20, s[32:35], s53 offen offset:256 sc1
    v_mfma_f32_16x16x32_bf16 v[88:91], a[188:191], a[100:103], v[88:91]
    v_mfma_f32_16x16x32_bf16 v[92:95], a[192:195], a[100:103], v[92:95]
    v_mfma_f32_16x16x32_bf16 v[96:99], a[196:199], a[100:103], v[96:99]
    v_mfma_f32_16x16x32_bf16 v[100:103], a[180:183], a[104:107], v[100:103]
    v_mfma_f32_16x16x32_bf16 v[104:107], a[184:187], a[104:107], v[104:107]
    v_mfma_f32_16x16x32_bf16 v[108:111], a[188:191], a[104:107], v[108:111]
    v_mfma_f32_16x16x32_bf16 v[112:115], a[192:195], a[104:107], v[112:115]
    v_mfma_f32_16x16x32_bf16 v[116:119], a[196:199], a[104:107], v[116:119]
    v_max3_f32 v228, v176, v177, v178
    v_min3_f32 v229, v176, v177, v178
    v_max3_f32 v228, v228, v179, v180
    v_min3_f32 v229, v229, v179, v180
    v_max3_f32 v228, v228, v181, v182
    s_bfe_u32 s12, 1, s55
    s_lshl_b32 s12, s12, 13
    s_add_u32 s7, s12, s96
    buffer_load_dwordx4 a[176:179], v2, s[32:35], s7 offen offset:0 sc1
    v_min3_f32 v229, v229, v181, v182
    v_max3_f32 v228, v228, v183, v184
    v_min3_f32 v229, v229, v183, v184
    v_max3_f32 v228, v228, v185, v186
    v_min3_f32 v229, v229, v185, v186
    v_mfma_f32_16x16x32_bf16 v[120:123], a[180:183], a[108:111], v[120:123]
    v_max3_f32 v228, v228, v187, v188
    v_min3_f32 v229, v229, v187, v188
    v_max3_f32 v228, v228, v189, v190
    buffer_load_dwordx4 a[100:103], v2, s[32:35], s7 offen offset:1024 sc1
    v_min3_f32 v229, v229, v189, v190
    v_max3_f32 v228, v228, v191, v192
    v_min3_f32 v229, v229, v191, v192
    v_max3_f32 v228, v228, v193, v194
    v_min3_f32 v229, v229, v193, v194
    v_max_f32 v228, v228, v195
    v_min_f32 v229, v229, v195
    v_mfma_f32_16x16x32_bf16 v[124:127], a[184:187], a[108:111], v[124:127]
    v_mul_f32 v230, v39, v228
    v_mul_f32 v231, v38, v229
    v_pk_fma_f32 v[208:209], v[176:177], v[38:39], v[230:231] op_sel:[0,0,0] op_sel_hi:[1,0,0]
    v_pk_fma_f32 v[176:177], v[176:177], v[38:39], v[230:231] op_sel:[0,1,1] op_sel_hi:[1,1,1]
    buffer_load_dwordx4 a[104:107], v2, s[32:35], s7 offen offset:2048 sc1
    v_mfma_f32_16x16x32_bf16 v[128:131], a[188:191], a[108:111], v[128:131]
    v_pk_fma_f32 v[210:211], v[178:179], v[38:39], v[230:231] op_sel:[0,0,0] op_sel_hi:[1,0,0]
    v_pk_fma_f32 v[178:179], v[178:179], v[38:39], v[230:231] op_sel:[0,1,1] op_sel_hi:[1,1,1]
    v_pk_fma_f32 v[212:213], v[180:181], v[38:39], v[230:231] op_sel:[0,0,0] op_sel_hi:[1,0,0]
    v_mfma_f32_16x16x32_bf16 v[132:135], a[192:195], a[108:111], v[132:135]
    v_pk_fma_f32 v[180:181], v[180:181], v[38:39], v[230:231] op_sel:[0,1,1] op_sel_hi:[1,1,1]
    v_pk_fma_f32 v[214:215], v[182:183], v[38:39], v[230:231] op_sel:[0,0,0] op_sel_hi:[1,0,0]
    v_pk_fma_f32 v[182:183], v[182:183], v[38:39], v[230:231] op_sel:[0,1,1] op_sel_hi:[1,1,1]
    v_mfma_f32_16x16x32_bf16 v[136:139], a[196:199], a[108:111], v[136:139]
    v_pk_fma_f32 v[216:217], v[184:185], v[38:39], v[230:231] op_sel:[0,0,0] op_sel_hi:[1,0,0]
    v_pk_fma_f32 v[184:185], v[184:185], v[38:39], v[230:231] op_sel:[0,1,1] op_sel_hi:[1,1,1]
    buffer_load_dwordx4 a[108:111], v2, s[32:35], s7 offen offset:3072 sc1
    v_pk_fma_f32 v[218:219], v[186:187], v[38:39], v[230:231] op_sel:[0,0,0] op_sel_hi:[1,0,0]
    v_mfma_f32_16x16x32_bf16 v[140:143], a[180:183], a[112:115], v[140:143]
    v_pk_fma_f32 v[186:187], v[186:187], v[38:39], v[230:231] op_sel:[0,1,1] op_sel_hi:[1,1,1]
    v_pk_fma_f32 v[220:221], v[188:189], v[38:39], v[230:231] op_sel:[0,0,0] op_sel_hi:[1,0,0]
    v_pk_fma_f32 v[188:189], v[188:189], v[38:39], v[230:231] op_sel:[0,1,1] op_sel_hi:[1,1,1]
    v_pk_fma_f32 v[222:223], v[190:191], v[38:39], v[230:231] op_sel:[0,0,0] op_sel_hi:[1,0,0]
    v_pk_fma_f32 v[190:191], v[190:191], v[38:39], v[230:231] op_sel:[0,1,1] op_sel_hi:[1,1,1]
    v_pk_fma_f32 v[224:225], v[192:193], v[38:39], v[230:231] op_sel:[0,0,0] op_sel_hi:[1,0,0]
    v_pk_fma_f32 v[192:193], v[192:193], v[38:39], v[230:231] op_sel:[0,1,1] op_sel_hi:[1,1,1]
    v_pk_fma_f32 v[226:227], v[194:195], v[38:39], v[230:231] op_sel:[0,0,0] op_sel_hi:[1,0,0]
    v_pk_fma_f32 v[194:195], v[194:195], v[38:39], v[230:231] op_sel:[0,1,1] op_sel_hi:[1,1,1]
    v_exp_f32 v208, v208
    buffer_load_dwordx4 a[180:183], v11, s[32:35], s7 offen offset:0 sc1
    v_mfma_f32_16x16x32_bf16 v[144:147], a[184:187], a[112:115], v[144:147]
    v_exp_f32 v176, v176
    v_exp_f32 v209, v209
    v_exp_f32 v177, v177
    v_exp_f32 v210, v210
    v_exp_f32 v178, v178
    s_bfe_u32 s12, 4384, s55
    s_lshl_b32 s12, s12, 13
    s_add_u32 s7, s12, s96
    buffer_load_dwordx4 a[184:187], v2, s[32:35], s7 offen offset:0 sc1
    v_mfma_f32_16x16x32_bf16 v[148:151], a[188:191], a[112:115], v[148:151]
    v_exp_f32 v211, v211
    v_exp_f32 v179, v179
    v_exp_f32 v212, v212
    v_exp_f32 v180, v180
    v_exp_f32 v213, v213
    buffer_load_dwordx4 a[188:191], v2, s[32:35], s7 offen offset:1024 sc1
    v_mfma_f32_16x16x32_bf16 v[152:155], a[192:195], a[112:115], v[152:155]
    v_exp_f32 v181, v181
    v_exp_f32 v214, v214
    v_exp_f32 v182, v182
    v_exp_f32 v215, v215
    v_exp_f32 v183, v183
    buffer_load_dwordx4 a[192:195], v2, s[32:35], s7 offen offset:2048 sc1
    v_mfma_f32_16x16x32_bf16 v[156:159], a[196:199], a[112:115], v[156:159]
    v_exp_f32 v216, v216
    v_exp_f32 v184, v184
    v_mfma_f32_16x16x32_bf16 v[80:83], a[200:203], a[116:119], v[80:83]
    v_mfma_f32_16x16x32_bf16 v[84:87], a[204:207], a[116:119], v[84:87]
    v_mfma_f32_16x16x32_bf16 v[88:91], a[208:211], a[116:119], v[88:91]
    buffer_load_dwordx4 a[112:115], v2, s[32:35], s7 offen offset:3072 sc1
    v_mfma_f32_16x16x32_bf16 v[92:95], a[212:215], a[116:119], v[92:95]
    v_mfma_f32_16x16x32_bf16 v[96:99], a[216:219], a[116:119], v[96:99]
    v_mfma_f32_16x16x32_bf16 v[100:103], a[200:203], a[120:123], v[100:103]
    v_mfma_f32_16x16x32_bf16 v[104:107], a[204:207], a[120:123], v[104:107]
    buffer_load_dwordx4 a[196:199], v11, s[32:35], s7 offen offset:0 sc1
    v_mfma_f32_16x16x32_bf16 v[108:111], a[208:211], a[120:123], v[108:111]
    v_mfma_f32_16x16x32_bf16 v[112:115], a[212:215], a[120:123], v[112:115]
    v_mfma_f32_16x16x32_bf16 v[116:119], a[216:219], a[120:123], v[116:119]
    v_mfma_f32_16x16x32_bf16 v[120:123], a[200:203], a[124:127], v[120:123]
    s_bfe_u32 s12, 8978, s55
    s_lshl_b32 s12, s12, 13
    s_add_u32 s7, s12, s96
    buffer_load_dwordx4 a[116:119], v2, s[32:35], s7 offen offset:0 sc1
    buffer_load_dwordx4 v[32:35], v5, s[32:35], s52 offen sc1
    v_exp_f32 v217, v217
    v_exp_f32 v185, v185
    v_exp_f32 v218, v218
    v_exp_f32 v186, v186
    v_exp_f32 v219, v219
    v_exp_f32 v187, v187
    v_exp_f32 v220, v220
    v_exp_f32 v188, v188
    v_mfma_f32_16x16x32_bf16 v[124:127], a[204:207], a[124:127], v[124:127]
    v_exp_f32 v221, v221
    v_exp_f32 v189, v189
    v_exp_f32 v222, v222
    buffer_load_dwordx4 a[120:123], v2, s[32:35], s7 offen offset:1024 sc1
    v_mfma_f32_16x16x32_bf16 v[128:131], a[208:211], a[124:127], v[128:131]
    v_exp_f32 v190, v190
    v_exp_f32 v223, v223
    v_exp_f32 v191, v191
    v_mfma_f32_16x16x32_bf16 v[132:135], a[212:215], a[124:127], v[132:135]
    v_exp_f32 v224, v224
    v_exp_f32 v192, v192
    v_exp_f32 v225, v225
    v_mfma_f32_16x16x32_bf16 v[136:139], a[216:219], a[124:127], v[136:139]
    buffer_load_dwordx4 a[124:127], v2, s[32:35], s7 offen offset:2048 sc1
    v_exp_f32 v193, v193
    v_exp_f32 v226, v226
    v_exp_f32 v194, v194
    v_mfma_f32_16x16x32_bf16 v[140:143], a[200:203], a[128:131], v[140:143]
    buffer_load_dwordx4 a[200:203], v2, s[32:35], s7 offen offset:3072 sc1
    v_exp_f32 v227, v227
    v_exp_f32 v195, v195
    v_pk_add_f32 v[232:233], v[208:209], v[210:211] op_sel:[0,0] op_sel_hi:[1,1]
    v_mfma_f32_16x16x32_bf16 v[144:147], a[204:207], a[128:131], v[144:147]
    v_pk_add_f32 v[234:235], v[176:177], v[178:179] op_sel:[0,0] op_sel_hi:[1,1]
    v_pk_add_f32 v[232:233], v[232:233], v[212:213] op_sel:[0,0] op_sel_hi:[1,1]
    v_pk_add_f32 v[234:235], v[234:235], v[180:181] op_sel:[0,0] op_sel_hi:[1,1]
    v_pk_add_f32 v[232:233], v[232:233], v[214:215] op_sel:[0,0] op_sel_hi:[1,1]
    v_pk_add_f32 v[234:235], v[234:235], v[182:183] op_sel:[0,0] op_sel_hi:[1,1]
    v_pk_add_f32 v[232:233], v[232:233], v[216:217] op_sel:[0,0] op_sel_hi:[1,1]
    buffer_load_dwordx4 a[204:207], v11, s[32:35], s7 offen offset:0 sc1
    v_mfma_f32_16x16x32_bf16 v[148:151], a[208:211], a[128:131], v[148:151]
    v_pk_add_f32 v[234:235], v[234:235], v[184:185] op_sel:[0,0] op_sel_hi:[1,1]
    v_pk_add_f32 v[232:233], v[232:233], v[218:219] op_sel:[0,0] op_sel_hi:[1,1]
    v_pk_add_f32 v[234:235], v[234:235], v[186:187] op_sel:[0,0] op_sel_hi:[1,1]
    v_pk_add_f32 v[232:233], v[232:233], v[220:221] op_sel:[0,0] op_sel_hi:[1,1]
    v_pk_add_f32 v[234:235], v[234:235], v[188:189] op_sel:[0,0] op_sel_hi:[1,1]
    v_pk_add_f32 v[232:233], v[232:233], v[222:223] op_sel:[0,0] op_sel_hi:[1,1]
    v_pk_add_f32 v[234:235], v[234:235], v[190:191] op_sel:[0,0] op_sel_hi:[1,1]
    v_pk_add_f32 v[232:233], v[232:233], v[224:225] op_sel:[0,0] op_sel_hi:[1,1]
    v_pk_add_f32 v[234:235], v[234:235], v[192:193] op_sel:[0,0] op_sel_hi:[1,1]
    v_pk_add_f32 v[232:233], v[232:233], v[226:227] op_sel:[0,0] op_sel_hi:[1,1]
    v_mfma_f32_16x16x32_bf16 v[152:155], a[212:215], a[128:131], v[152:155]
    s_bfe_u32 s12, 12851, s55
    s_lshl_b32 s12, s12, 13
    s_add_u32 s7, s12, s96
    buffer_load_dwordx4 a[208:211], v2, s[32:35], s7 offen offset:0 sc1
    v_pk_add_f32 v[234:235], v[234:235], v[194:195] op_sel:[0,0] op_sel_hi:[1,1]
    v_add_f32 v234, v234, v235
    v_add_f32 v232, v232, v233
    v_rcp_f32 v234, v234
    v_mul_f32 v40, 0x358637bd, v232
    v_mul_f32 v234, v234, v232
    v_cvt_pk_bf16_f32 v236, v208, v209
    v_pk_mul_f32 v[176:177], v[176:177], v[234:235] op_sel:[0,0] op_sel_hi:[1,0]
    v_cvt_pk_bf16_f32 v237, v210, v211
    buffer_load_dwordx4 a[212:215], v2, s[32:35], s7 offen offset:1024 sc1
    v_mfma_f32_16x16x32_bf16 v[156:159], a[216:219], a[128:131], v[156:159]
    v_pk_mul_f32 v[178:179], v[178:179], v[234:235] op_sel:[0,0] op_sel_hi:[1,0]
    v_cvt_pk_bf16_f32 v238, v212, v213
    v_pk_mul_f32 v[180:181], v[180:181], v[234:235] op_sel:[0,0] op_sel_hi:[1,0]
    v_cvt_pk_bf16_f32 v239, v214, v215
    v_pk_mul_f32 v[182:183], v[182:183], v[234:235] op_sel:[0,0] op_sel_hi:[1,0]
    v_cvt_pk_bf16_f32 v240, v216, v217
    v_pk_mul_f32 v[184:185], v[184:185], v[234:235] op_sel:[0,0] op_sel_hi:[1,0]
    v_cvt_pk_bf16_f32 v241, v218, v219
    v_pk_mul_f32 v[186:187], v[186:187], v[234:235] op_sel:[0,0] op_sel_hi:[1,0]
    v_cvt_pk_bf16_f32 v242, v220, v221
    v_mfma_f32_16x16x32_bf16 v[80:83], a[220:223], a[132:135], v[80:83]
    s_bfe_u32 s12, 1, s55
    s_lshl_b32 s12, s12, 10
    s_add_u32 s6, s12, s93
    buffer_load_dwordx4 v[48:51], v12, s[32:35], s6 offen sc1
    v_pk_mul_f32 v[188:189], v[188:189], v[234:235] op_sel:[0,0] op_sel_hi:[1,0]
    v_cvt_pk_bf16_f32 v243, v222, v223
    v_pk_mul_f32 v[190:191], v[190:191], v[234:235] op_sel:[0,0] op_sel_hi:[1,0]
    v_cvt_pk_bf16_f32 v244, v224, v225
    v_pk_mul_f32 v[192:193], v[192:193], v[234:235] op_sel:[0,0] op_sel_hi:[1,0]
    v_cvt_pk_bf16_f32 v245, v226, v227
    v_pk_mul_f32 v[194:195], v[194:195], v[234:235] op_sel:[0,0] op_sel_hi:[1,0]
    v_cvt_pk_bf16_f32 v246, v176, v177
    v_cvt_pk_bf16_f32 v247, v178, v179
    buffer_load_dwordx4 v[52:55], v13, s[32:35], s6 offen sc1
    v_cvt_pk_bf16_f32 v248, v180, v181
    v_mfma_f32_16x16x32_bf16 v[84:87], a[0:3], a[132:135], v[84:87]
    v_cvt_pk_bf16_f32 v249, v182, v183
    v_cvt_pk_bf16_f32 v250, v184, v185
    v_cvt_pk_bf16_f32 v251, v186, v187
    v_cvt_pk_bf16_f32 v252, v188, v189
    v_cvt_pk_bf16_f32 v253, v190, v191
    v_cvt_pk_bf16_f32 v254, v192, v193
    v_cvt_pk_bf16_f32 v255, v194, v195
    v_mfma_f32_16x16x32_bf16 v[88:91], a[4:7], a[132:135], v[88:91]
    v_mfma_f32_16x16x32_bf16 v[92:95], a[8:11], a[132:135], v[92:95]
    buffer_load_dwordx4 v[56:59], v14, s[32:35], s6 offen sc1
    v_mfma_f32_16x16x32_bf16 v[96:99], a[12:15], a[132:135], v[96:99]
    v_mfma_f32_16x16x32_bf16 v[100:103], a[220:223], a[136:139], v[100:103]
    v_mfma_f32_16x16x32_bf16 v[104:107], a[0:3], a[136:139], v[104:107]
    v_mfma_f32_16x16x32_bf16 v[108:111], a[4:7], a[136:139], v[108:111]
    buffer_load_dwordx4 v[60:63], v30, s[32:35], s6 offen sc1
    v_mfma_f32_16x16x32_bf16 v[112:115], a[8:11], a[136:139], v[112:115]
    v_mfma_f32_16x16x32_bf16 v[116:119], a[12:15], a[136:139], v[116:119]
    v_mfma_f32_16x16x32_bf16 v[120:123], a[220:223], a[140:143], v[120:123]
    v_mfma_f32_16x16x32_bf16 v[124:127], a[0:3], a[140:143], v[124:127]
    s_bfe_u32 s12, 4384, s55
    s_lshl_b32 s12, s12, 10
    s_add_u32 s6, s12, s93
    buffer_load_dwordx4 v[64:67], v12, s[32:35], s6 offen sc1
    v_mfma_f32_16x16x32_bf16 v[128:131], a[4:7], a[140:143], v[128:131]
    v_mfma_f32_16x16x32_bf16 v[132:135], a[8:11], a[140:143], v[132:135]
    s_waitcnt vmcnt(11)
    v_max_u32 v15, v32, v34
    v_cmp_eq_u32 s[100:101], -1, v15
    s_nop 0
    s_cmp_lg_u64 s[100:101], 0
    s_cbranch_scc1 M_slow_kvb
M_back_kvb:
    buffer_load_dwordx4 v[68:71], v13, s[32:35], s6 offen sc1
    ds_write_b128 v4, v[32:35]
    v_mfma_f32_16x16x32_bf16 v[136:139], a[12:15], a[140:143], v[136:139]
    v_mfma_f32_16x16x32_bf16 v[140:143], a[220:223], a[144:147], v[140:143]
    v_mfma_f32_16x16x32_bf16 v[144:147], a[0:3], a[144:147], v[144:147]
    buffer_load_dwordx4 v[72:75], v14, s[32:35], s6 offen sc1
    v_mfma_f32_16x16x32_bf16 v[148:151], a[4:7], a[144:147], v[148:151]
    v_mfma_f32_16x16x32_bf16 v[152:155], a[8:11], a[144:147], v[152:155]
    s_waitcnt lgkmcnt(0)
    s_barrier
    ds_read_b128 v[212:215], v7 offset:0
    ds_read_b128 v[208:211], v6 offset:0
    buffer_load_dwordx4 v[76:79], v30, s[32:35], s6 offen sc1
    ds_read_b128 v[220:223], v7 offset:16
    ds_read_b128 v[216:219], v6 offset:16
    ds_read_b128 v[160:163], v7 offset:32
    ds_read_b128 v[224:227], v6 offset:32
    ds_read_b128 v[168:171], v7 offset:48
    ds_read_b128 v[164:167], v6 offset:48
    v_mfma_f32_16x16x32_bf16 v[156:159], a[12:15], a[144:147], v[156:159]
    ds_read_b64 v[42:43], v7 offset:64
    ds_read_b64 v[44:45], v7 offset:80
    ds_read_b64 v[172:173], v6 offset:64
    ds_read_b64 v[174:175], v6 offset:80
    s_waitcnt lgkmcnt(11)
    v_mfma_f32_32x32x16_bf16 v[192:207], v[212:215], v[236:239], 0
    buffer_load_dwordx4 a[128:131], v2, s[32:35], s7 offen offset:2048 sc1
    s_waitcnt lgkmcnt(10)
    v_mfma_f32_32x32x16_bf16 v[176:191], v[208:211], v[236:239], 0
    s_waitcnt lgkmcnt(9)
    v_mfma_f32_32x32x16_bf16 v[192:207], v[220:223], v[240:243], v[192:207]
    buffer_load_dwordx4 a[216:219], v2, s[32:35], s7 offen offset:3072 sc1
    s_waitcnt lgkmcnt(8)
    v_mfma_f32_32x32x16_bf16 v[176:191], v[216:219], v[240:243], v[176:191]
    s_waitcnt lgkmcnt(7)
    v_mfma_f32_32x32x16_bf16 v[192:207], v[160:163], v[244:247], v[192:207]
    buffer_load_dwordx4 a[132:135], v11, s[32:35], s7 offen offset:0 sc1
    s_waitcnt lgkmcnt(6)
    v_mfma_f32_32x32x16_bf16 v[176:191], v[224:227], v[244:247], v[176:191]
    v_mfma_f32_16x16x32_bf16 v[80:83], a[16:19], a[148:151], v[80:83]
    s_add_u32 s7, s97, 0
    buffer_load_dwordx4 a[136:139], v2, s[32:35], s7 offen offset:0 sc1
    s_waitcnt lgkmcnt(5)
    v_mfma_f32_32x32x16_bf16 v[192:207], v[168:171], v[248:251], v[192:207]
    s_waitcnt lgkmcnt(4)
    v_mfma_f32_32x32x16_bf16 v[176:191], v[164:167], v[248:251], v[176:191]
    s_waitcnt lgkmcnt(2)
    v_mfma_f32_32x32x16_bf16 v[192:207], v[42:45], v[252:255], v[192:207]
    buffer_load_dwordx4 a[140:143], v2, s[32:35], s7 offen offset:1024 sc1
    s_waitcnt lgkmcnt(0)
    v_mfma_f32_32x32x16_bf16 v[176:191], v[172:175], v[252:255], v[176:191]
    v_mfma_f32_16x16x32_bf16 v[84:87], a[20:23], a[148:151], v[84:87]
    s_bfe_u32 s12, 8978, s55
    s_lshl_b32 s12, s12, 10
    s_add_u32 s6, s12, s93
    buffer_load_dwordx4 v[160:163], v12, s[32:35], s6 offen sc1
    v_mfma_f32_16x16x32_bf16 v[88:91], a[24:27], a[148:151], v[88:91]
    v_mfma_f32_16x16x32_bf16 v[92:95], a[28:31], a[148:151], v[92:95]
    buffer_load_dwordx4 v[164:167], v13, s[32:35], s6 offen sc1
    v_mfma_f32_16x16x32_bf16 v[96:99], a[32:35], a[148:151], v[96:99]
    v_add_f32 v228, v196, v40
    v_rcp_f32 v228, v228
    v_mfma_f32_16x16x32_bf16 v[100:103], a[16:19], a[152:155], v[100:103]
    v_pk_mul_f32 v[176:177], v[176:177], v[228:229] op_sel:[0,0] op_sel_hi:[1,0]
    v_pk_mul_f32 v[178:179], v[178:179], v[228:229] op_sel:[0,0] op_sel_hi:[1,0]
    v_pk_mul_f32 v[180:181], v[180:181], v[228:229] op_sel:[0,0] op_sel_hi:[1,0]
    v_pk_mul_f32 v[182:183], v[182:183], v[228:229] op_sel:[0,0] op_sel_hi:[1,0]
    v_pk_mul_f32 v[184:185], v[184:185], v[228:229] op_sel:[0,0] op_sel_hi:[1,0]
    v_pk_mul_f32 v[186:187], v[186:187], v[228:229] op_sel:[0,0] op_sel_hi:[1,0]
    buffer_load_dwordx4 v[168:171], v14, s[32:35], s6 offen sc1
    v_pk_mul_f32 v[188:189], v[188:189], v[228:229] op_sel:[0,0] op_sel_hi:[1,0]
    v_pk_mul_f32 v[190:191], v[190:191], v[228:229] op_sel:[0,0] op_sel_hi:[1,0]
    v_pk_mul_f32 v[192:193], v[192:193], v[228:229] op_sel:[0,0] op_sel_hi:[1,0]
    v_pk_mul_f32 v[194:195], v[194:195], v[228:229] op_sel:[0,0] op_sel_hi:[1,0]
    v_mfma_f32_16x16x32_bf16 v[104:107], a[20:23], a[152:155], v[104:107]
    v_cvt_pk_bf16_f32 v236, v176, v177
    v_cvt_pk_bf16_f32 v237, v178, v179
    v_cvt_pk_bf16_f32 v238, v180, v181
    v_cvt_pk_bf16_f32 v239, v182, v183
    v_cvt_pk_bf16_f32 v240, v184, v185
    v_cvt_pk_bf16_f32 v241, v186, v187
    v_cvt_pk_bf16_f32 v242, v188, v189
    buffer_load_dwordx4 v[172:175], v30, s[32:35], s6 offen sc1
    v_cvt_pk_bf16_f32 v243, v190, v191
    v_cvt_pk_bf16_f32 v244, v192, v193
    v_cvt_pk_bf16_f32 v245, v194, v195
    v_mfma_f32_16x16x32_bf16 v[108:111], a[24:27], a[152:155], v[108:111]
    buffer_store_dwordx4 v[236:239], v8, s[32:35], s54 offen sc1
    v_mfma_f32_16x16x32_bf16 v[112:115], a[28:31], a[152:155], v[112:115]
    s_mov_b32 s28, s18
    s_and_b32 s29, s19, 0xffff
    v_mfma_f32_16x16x32_bf16 v[116:119], a[32:35], a[152:155], v[116:119]
    s_mov_b32 s30, 2048*1280
    s_lshl2_add_u32 s46, s62, s64
    v_mfma_f32_16x16x32_bf16 v[120:123], a[16:19], a[156:159], v[120:123]
    s_mul_i32 s46, s46, 16*1280
    s_lshl_b32 s56, s63, 5
    v_mfma_f32_16x16x32_bf16 v[124:127], a[20:23], a[156:159], v[124:127]
    s_add_u32 s47, s46, s56
    s_lshl2_add_u32 s46, s56, s46
    v_mfma_f32_16x16x32_bf16 v[128:131], a[24:27], a[156:159], v[128:131]
    v_lshrrev_b32 v218, 8, v2
    v_mul_u32_u24 v218, 24, v218
    v_mfma_f32_16x16x32_bf16 v[132:135], a[28:31], a[156:159], v[132:135]
    v_sub_u32 v218, v10, v218
    buffer_load_dwordx4 v[208:211], v10, s[24:27], s46 offen
    v_mfma_f32_16x16x32_bf16 v[136:139], a[32:35], a[156:159], v[136:139]
    buffer_load_dwordx4 v[212:215], v10, s[24:27], s46 offen offset:16
    buffer_load_dwordx2 v[216:217], v218, s[24:27], s47 offen offset:1024
    v_mfma_f32_16x16x32_bf16 v[140:143], a[16:19], a[224:227], v[140:143]
    v_mfma_f32_16x16x32_bf16 v[144:147], a[20:23], a[224:227], v[144:147]
    buffer_store_dwordx4 v[240:243], v8, s[32:35], s54 offen offset:256 sc1
    v_mfma_f32_16x16x32_bf16 v[148:151], a[24:27], a[224:227], v[148:151]
    v_mfma_f32_16x16x32_bf16 v[152:155], a[28:31], a[224:227], v[152:155]
    v_mfma_f32_16x16x32_bf16 v[156:159], a[32:35], a[224:227], v[156:159]
    v_mfma_f32_16x16x32_bf16 v[80:83], a[36:39], a[228:231], v[80:83]
    v_mfma_f32_16x16x32_bf16 v[84:87], a[40:43], a[228:231], v[84:87]
    v_mfma_f32_16x16x32_bf16 v[88:91], a[44:47], a[228:231], v[88:91]
    v_mfma_f32_16x16x32_bf16 v[92:95], a[48:51], a[228:231], v[92:95]
    v_mfma_f32_16x16x32_bf16 v[96:99], a[52:55], a[228:231], v[96:99]
    v_mfma_f32_16x16x32_bf16 v[100:103], a[36:39], a[232:235], v[100:103]
    v_mfma_f32_16x16x32_bf16 v[104:107], a[40:43], a[232:235], v[104:107]
    v_mfma_f32_16x16x32_bf16 v[108:111], a[44:47], a[232:235], v[108:111]
    v_mfma_f32_16x16x32_bf16 v[112:115], a[48:51], a[232:235], v[112:115]
    v_mfma_f32_16x16x32_bf16 v[116:119], a[52:55], a[232:235], v[116:119]
    v_mfma_f32_16x16x32_bf16 v[120:123], a[36:39], a[236:239], v[120:123]
    v_mfma_f32_16x16x32_bf16 v[124:127], a[40:43], a[236:239], v[124:127]
    v_mfma_f32_16x16x32_bf16 v[128:131], a[44:47], a[236:239], v[128:131]
    v_mfma_f32_16x16x32_bf16 v[132:135], a[48:51], a[236:239], v[132:135]
    s_bfe_u32 s12, 12851, s55
    s_lshl_b32 s12, s12, 10
    s_add_u32 s6, s12, s93
    buffer_load_dwordx4 v[176:179], v12, s[32:35], s6 offen sc1
    v_mfma_f32_16x16x32_bf16 v[136:139], a[52:55], a[236:239], v[136:139]
    v_mfma_f32_16x16x32_bf16 v[140:143], a[36:39], a[240:243], v[140:143]
    v_mfma_f32_16x16x32_bf16 v[144:147], a[40:43], a[240:243], v[144:147]
    buffer_load_dwordx4 v[180:183], v13, s[32:35], s6 offen sc1
    v_mfma_f32_16x16x32_bf16 v[148:151], a[44:47], a[240:243], v[148:151]
    v_mfma_f32_16x16x32_bf16 v[152:155], a[48:51], a[240:243], v[152:155]
    v_mfma_f32_16x16x32_bf16 v[156:159], a[52:55], a[240:243], v[156:159]
    v_mfma_f32_16x16x32_bf16 v[80:83], a[56:59], a[244:247], v[80:83]
    buffer_store_dwordx2 v[244:245], v9, s[32:35], s54 offen offset:512 sc1
    s_waitcnt vmcnt(6)
    v_lshlrev_b32 v236, 16, v208
    v_mfma_f32_16x16x32_bf16 v[84:87], a[60:63], a[244:247], v[84:87]
    v_and_b32 v237, 0xffff0000, v208
    v_lshlrev_b32 v238, 16, v209
    v_mfma_f32_16x16x32_bf16 v[88:91], a[64:67], a[244:247], v[88:91]
    v_and_b32 v239, 0xffff0000, v209
    v_lshlrev_b32 v240, 16, v210
    v_mfma_f32_16x16x32_bf16 v[92:95], a[68:71], a[244:247], v[92:95]
    v_and_b32 v241, 0xffff0000, v210
    v_lshlrev_b32 v242, 16, v211
    v_mfma_f32_16x16x32_bf16 v[96:99], a[72:75], a[244:247], v[96:99]
    v_and_b32 v243, 0xffff0000, v211
    buffer_load_dwordx4 v[184:187], v14, s[32:35], s6 offen sc1
    s_waitcnt vmcnt(6)
    v_lshlrev_b32 v244, 16, v212
    v_mfma_f32_16x16x32_bf16 v[100:103], a[56:59], a[248:251], v[100:103]
    v_and_b32 v245, 0xffff0000, v212
    v_lshlrev_b32 v246, 16, v213
    v_mfma_f32_16x16x32_bf16 v[104:107], a[60:63], a[248:251], v[104:107]
    v_and_b32 v247, 0xffff0000, v213
    v_lshlrev_b32 v248, 16, v214
    v_mfma_f32_16x16x32_bf16 v[108:111], a[64:67], a[248:251], v[108:111]
    v_and_b32 v249, 0xffff0000, v214
    v_lshlrev_b32 v250, 16, v215
    buffer_load_dwordx4 v[188:191], v30, s[32:35], s6 offen sc1
    v_mfma_f32_16x16x32_bf16 v[112:115], a[68:71], a[248:251], v[112:115]
    v_and_b32 v251, 0xffff0000, v215
    s_waitcnt vmcnt(6)
    v_lshlrev_b32 v252, 16, v216
    v_mfma_f32_16x16x32_bf16 v[116:119], a[72:75], a[248:251], v[116:119]
    v_and_b32 v253, 0xffff0000, v216
    v_lshlrev_b32 v254, 16, v217
    v_mfma_f32_16x16x32_bf16 v[120:123], a[56:59], a[252:255], v[120:123]
    v_and_b32 v255, 0xffff0000, v217
    s_mul_i32 s56, s64, 2560
    v_mfma_f32_16x16x32_bf16 v[124:127], a[60:63], a[252:255], v[124:127]
    buffer_load_dwordx4 a[220:223], v2, s[32:35], s7 offen offset:2048 sc1
    s_add_u32 s56, s56, 74240
    v_and_b32 v225, 0xf0, v2
    v_mfma_f32_16x16x32_bf16 v[128:131], a[64:67], a[252:255], v[128:131]
    v_lshrrev_b32 v226, 8, v2
    v_lshlrev_b32 v220, 3, v225
    v_mfma_f32_16x16x32_bf16 v[132:135], a[68:71], a[252:255], v[132:135]
    v_lshl_add_u32 v220, v226, 5, v220
    v_and_b32 v221, 0x70, v225
    v_mfma_f32_16x16x32_bf16 v[136:139], a[72:75], a[252:255], v[136:139]
    buffer_load_dwordx4 a[0:3], v2, s[32:35], s7 offen offset:3072 sc1
    v_xor_b32 v220, v220, v221
    v_add_u32 v220, s56, v220
    v_mfma_f32_16x16x32_bf16 v[140:143], a[56:59], a[84:87], v[140:143]
    v_xor_b32 v218, 16, v220
    v_lshlrev_b32 v221, 1, v225
    v_mfma_f32_16x16x32_bf16 v[144:147], a[60:63], a[84:87], v[144:147]
    v_lshl_add_u32 v221, v226, 3, v221
    v_add_u32 v221, s56, v221
    v_mfma_f32_16x16x32_bf16 v[148:151], a[64:67], a[84:87], v[148:151]
    v_add_u32 v222, s56, v2
    v_lshrrev_b32 v225, 7, v2
    buffer_load_dwordx4 a[4:7], v11, s[32:35], s7 offen offset:0 sc1
    v_mfma_f32_16x16x32_bf16 v[152:155], a[68:71], a[84:87], v[152:155]
    v_lshlrev_b32 v226, 4, v225
    v_mul_u32_u24 v225, 1280, v225
    v_mfma_f32_16x16x32_bf16 v[156:159], a[72:75], a[84:87], v[156:159]
    v_xor_b32 v226, v226, v2
    v_and_b32 v226, 0x70, v226
    v_mfma_f32_16x16x32_bf16 v[80:83], a[76:79], a[164:167], v[80:83]
    v_add_u32 v223, v225, v226
    v_add_u32 v227, 10240, v223
    v_mfma_f32_16x16x32_bf16 v[84:87], a[80:83], a[164:167], v[84:87]
    s_add_u32 s7, s97, 8192
    buffer_load_dwordx4 a[8:11], v2, s[32:35], s7 offen offset:0 sc1
    v_lshrrev_b32 v225, 5, v2
    v_mul_u32_u24 v225, 1280, v225
    v_mfma_f32_16x16x32_bf16 v[88:91], a[88:91], a[164:167], v[88:91]
    v_and_b32 v226, 16, v2
    v_add_u32 v225, v225, v226
    v_mfma_f32_16x16x32_bf16 v[92:95], a[92:95], a[164:167], v[92:95]
    v_mov_b32 v226, 1073741824
    v_cmp_gt_u32 vcc, 512, v2
    v_mfma_f32_16x16x32_bf16 v[96:99], a[160:163], a[164:167], v[96:99]
    buffer_load_dwordx4 a[144:147], v2, s[32:35], s7 offen offset:1024 sc1
    v_cndmask_b32 v224, v226, v225, vcc
    s_mul_i32 s56, s64, 15360
    v_mfma_f32_16x16x32_bf16 v[100:103], a[76:79], a[168:171], v[100:103]
    v_add_u32 v233, s56, v2
    v_add_u32 v229, s88, v2
    v_mfma_f32_16x16x32_bf16 v[104:107], a[80:83], a[168:171], v[104:107]
    v_add_u32 v230, s89, v2
    v_add_u32 v231, s90, v2
    v_mfma_f32_16x16x32_bf16 v[108:111], a[88:91], a[168:171], v[108:111]
    v_mfma_f32_16x16x32_bf16 v[112:115], a[92:95], a[168:171], v[112:115]
    buffer_load_dwordx4 a[12:15], v2, s[32:35], s7 offen offset:2048 sc1
    v_mfma_f32_16x16x32_bf16 v[116:119], a[160:163], a[168:171], v[116:119]
    v_mfma_f32_16x16x32_bf16 v[120:123], a[76:79], a[172:175], v[120:123]
    v_mfma_f32_16x16x32_bf16 v[124:127], a[80:83], a[172:175], v[124:127]
    v_mfma_f32_16x16x32_bf16 v[128:131], a[88:91], a[172:175], v[128:131]
    buffer_load_dwordx4 a[148:151], v2, s[32:35], s7 offen offset:3072 sc1
    v_mfma_f32_16x16x32_bf16 v[132:135], a[92:95], a[172:175], v[132:135]
    v_mfma_f32_16x16x32_bf16 v[136:139], a[160:163], a[172:175], v[136:139]
    v_mfma_f32_16x16x32_bf16 v[140:143], a[76:79], a[96:99], v[140:143]
    v_mfma_f32_16x16x32_bf16 v[144:147], a[80:83], a[96:99], v[144:147]
    buffer_load_dwordx4 a[152:155], v11, s[32:35], s7 offen offset:0 sc1
    v_mfma_f32_16x16x32_bf16 v[148:151], a[88:91], a[96:99], v[148:151]
    v_mfma_f32_16x16x32_bf16 v[152:155], a[92:95], a[96:99], v[152:155]
    v_mfma_f32_16x16x32_bf16 v[156:159], a[160:163], a[96:99], v[156:159]
    v_max_u32 v15, v48, v52
    v_max3_u32 v15, v15, v56, v60
    v_cmp_eq_u32 s[100:101], -1, v15
    s_nop 0
    s_cmp_lg_u64 s[100:101], 0
    s_cbranch_scc1 M_slow_a8_0
M_back_a8_0:
    v_mfma_f32_16x16x32_bf16 v[80:83], a[176:179], v[48:51], v[80:83]
    s_add_u32 s7, s97, 16384
    buffer_load_dwordx4 a[156:159], v2, s[32:35], s7 offen offset:0 sc1
    v_mfma_f32_16x16x32_bf16 v[84:87], a[100:103], v[48:51], v[84:87]
    v_mfma_f32_16x16x32_bf16 v[88:91], a[104:107], v[48:51], v[88:91]
    buffer_load_dwordx4 a[16:19], v2, s[32:35], s7 offen offset:1024 sc1
    v_mfma_f32_16x16x32_bf16 v[92:95], a[108:111], v[48:51], v[92:95]
    v_mfma_f32_16x16x32_bf16 v[96:99], a[180:183], v[48:51], v[96:99]
    v_mfma_f32_16x16x32_bf16 v[100:103], a[176:179], v[52:55], v[100:103]
    v_mfma_f32_16x16x32_bf16 v[104:107], a[100:103], v[52:55], v[104:107]
    buffer_load_dwordx4 a[20:23], v2, s[32:35], s7 offen offset:2048 sc1
    v_mfma_f32_16x16x32_bf16 v[108:111], a[104:107], v[52:55], v[108:111]
    v_mfma_f32_16x16x32_bf16 v[112:115], a[108:111], v[52:55], v[112:115]
    v_mfma_f32_16x16x32_bf16 v[116:119], a[180:183], v[52:55], v[116:119]
    v_mfma_f32_16x16x32_bf16 v[120:123], a[176:179], v[56:59], v[120:123]
    buffer_load_dwordx4 a[24:27], v2, s[32:35], s7 offen offset:3072 sc1
    v_mfma_f32_16x16x32_bf16 v[124:127], a[100:103], v[56:59], v[124:127]
    v_mfma_f32_16x16x32_bf16 v[128:131], a[104:107], v[56:59], v[128:131]
    v_mfma_f32_16x16x32_bf16 v[132:135], a[108:111], v[56:59], v[132:135]
    v_mfma_f32_16x16x32_bf16 v[136:139], a[180:183], v[56:59], v[136:139]
    buffer_load_dwordx4 a[28:31], v11, s[32:35], s7 offen offset:0 sc1
    v_mfma_f32_16x16x32_bf16 v[140:143], a[176:179], v[60:63], v[140:143]
    v_mfma_f32_16x16x32_bf16 v[144:147], a[100:103], v[60:63], v[144:147]
    v_mfma_f32_16x16x32_bf16 v[148:151], a[104:107], v[60:63], v[148:151]
    v_mfma_f32_16x16x32_bf16 v[152:155], a[108:111], v[60:63], v[152:155]
    s_add_u32 s7, s97, 24576
    buffer_load_dwordx4 a[224:227], v2, s[32:35], s7 offen offset:0 sc1
    v_mfma_f32_16x16x32_bf16 v[156:159], a[180:183], v[60:63], v[156:159]
    v_max_u32 v15, v64, v68
    v_max3_u32 v15, v15, v72, v76
    v_cmp_eq_u32 s[100:101], -1, v15
    s_nop 0
    s_cmp_lg_u64 s[100:101], 0
    s_cbranch_scc1 M_slow_a9_0
M_back_a9_0:
    v_mfma_f32_16x16x32_bf16 v[80:83], a[184:187], v[64:67], v[80:83]
    v_mfma_f32_16x16x32_bf16 v[84:87], a[188:191], v[64:67], v[84:87]
    buffer_load_dwordx4 a[32:35], v2, s[32:35], s7 offen offset:1024 sc1
    v_mfma_f32_16x16x32_bf16 v[88:91], a[192:195], v[64:67], v[88:91]
    v_mfma_f32_16x16x32_bf16 v[92:95], a[112:115], v[64:67], v[92:95]
    v_mfma_f32_16x16x32_bf16 v[96:99], a[196:199], v[64:67], v[96:99]
    v_mfma_f32_16x16x32_bf16 v[100:103], a[184:187], v[68:71], v[100:103]
    buffer_load_dwordx4 a[228:231], v2, s[32:35], s7 offen offset:2048 sc1
    v_mfma_f32_16x16x32_bf16 v[104:107], a[188:191], v[68:71], v[104:107]
    v_mfma_f32_16x16x32_bf16 v[108:111], a[192:195], v[68:71], v[108:111]
    v_mfma_f32_16x16x32_bf16 v[112:115], a[112:115], v[68:71], v[112:115]
    v_mfma_f32_16x16x32_bf16 v[116:119], a[196:199], v[68:71], v[116:119]
    buffer_load_dwordx4 a[232:235], v2, s[32:35], s7 offen offset:3072 sc1
    v_mfma_f32_16x16x32_bf16 v[120:123], a[184:187], v[72:75], v[120:123]
    v_mfma_f32_16x16x32_bf16 v[124:127], a[188:191], v[72:75], v[124:127]
    v_mfma_f32_16x16x32_bf16 v[128:131], a[192:195], v[72:75], v[128:131]
    v_mfma_f32_16x16x32_bf16 v[132:135], a[112:115], v[72:75], v[132:135]
    buffer_load_dwordx4 v[192:195], v12, s[32:35], s94 offen offset:0 sc1
    v_mfma_f32_16x16x32_bf16 v[136:139], a[196:199], v[72:75], v[136:139]
    v_mfma_f32_16x16x32_bf16 v[140:143], a[184:187], v[76:79], v[140:143]
    v_mfma_f32_16x16x32_bf16 v[144:147], a[188:191], v[76:79], v[144:147]
    v_mfma_f32_16x16x32_bf16 v[148:151], a[192:195], v[76:79], v[148:151]
    buffer_load_dwordx4 v[196:199], v13, s[32:35], s94 offen offset:0 sc1
    v_mfma_f32_16x16x32_bf16 v[152:155], a[112:115], v[76:79], v[152:155]
    v_mfma_f32_16x16x32_bf16 v[156:159], a[196:199], v[76:79], v[156:159]
    v_max_u32 v15, v160, v164
    v_max3_u32 v15, v15, v168, v172
    v_cmp_eq_u32 s[100:101], -1, v15
    s_nop 0
    s_cmp_lg_u64 s[100:101], 0
    s_cbranch_scc1 M_slow_a10_0
M_back_a10_0:
    v_mfma_f32_16x16x32_bf16 v[80:83], a[116:119], v[160:163], v[80:83]
    buffer_load_dwordx4 v[200:203], v14, s[32:35], s94 offen offset:0 sc1
    v_mfma_f32_16x16x32_bf16 v[84:87], a[120:123], v[160:163], v[84:87]
    v_mfma_f32_16x16x32_bf16 v[88:91], a[124:127], v[160:163], v[88:91]
    v_mfma_f32_16x16x32_bf16 v[92:95], a[200:203], v[160:163], v[92:95]
    v_mfma_f32_16x16x32_bf16 v[96:99], a[204:207], v[160:163], v[96:99]
    buffer_load_dwordx4 v[204:207], v30, s[32:35], s94 offen offset:0 sc1
    v_mfma_f32_16x16x32_bf16 v[100:103], a[116:119], v[164:167], v[100:103]
    v_mfma_f32_16x16x32_bf16 v[104:107], a[120:123], v[164:167], v[104:107]
    v_mfma_f32_16x16x32_bf16 v[108:111], a[124:127], v[164:167], v[108:111]
    v_mfma_f32_16x16x32_bf16 v[112:115], a[200:203], v[164:167], v[112:115]
    buffer_load_dwordx4 a[236:239], v11, s[32:35], s7 offen offset:0 sc1
    v_mfma_f32_16x16x32_bf16 v[116:119], a[204:207], v[164:167], v[116:119]
    v_mfma_f32_16x16x32_bf16 v[120:123], a[116:119], v[168:171], v[120:123]
    v_mfma_f32_16x16x32_bf16 v[124:127], a[120:123], v[168:171], v[124:127]
    v_mfma_f32_16x16x32_bf16 v[128:131], a[124:127], v[168:171], v[128:131]
    s_add_u32 s7, s97, 32768
    buffer_load_dwordx4 a[36:39], v2, s[32:35], s7 offen offset:0 sc1
    v_mfma_f32_16x16x32_bf16 v[132:135], a[200:203], v[168:171], v[132:135]
    v_mfma_f32_16x16x32_bf16 v[136:139], a[204:207], v[168:171], v[136:139]
    v_mfma_f32_16x16x32_bf16 v[140:143], a[116:119], v[172:175], v[140:143]
    buffer_load_dwordx4 a[40:43], v2, s[32:35], s7 offen offset:1024 sc1
    v_mfma_f32_16x16x32_bf16 v[144:147], a[120:123], v[172:175], v[144:147]
    v_mfma_f32_16x16x32_bf16 v[148:151], a[124:127], v[172:175], v[148:151]
    v_mfma_f32_16x16x32_bf16 v[152:155], a[200:203], v[172:175], v[152:155]
    v_mfma_f32_16x16x32_bf16 v[156:159], a[204:207], v[172:175], v[156:159]
    buffer_load_dwordx4 a[44:47], v2, s[32:35], s7 offen offset:2048 sc1
    s_waitcnt vmcnt(28)
    v_max_u32 v15, v176, v180
    s_waitcnt vmcnt(25)
    v_max3_u32 v15, v15, v184, v188
    v_cmp_eq_u32 s[100:101], -1, v15
    s_nop 0
    s_cmp_lg_u64 s[100:101], 0
    s_cbranch_scc1 M_slow_a11_0
M_back_a11_0:
    v_mfma_f32_16x16x32_bf16 v[80:83], a[208:211], v[176:179], v[80:83]
    v_mfma_f32_16x16x32_bf16 v[84:87], a[212:215], v[176:179], v[84:87]
    buffer_load_dwordx4 a[48:51], v2, s[32:35], s7 offen offset:3072 sc1
    v_mfma_f32_16x16x32_bf16 v[88:91], a[128:131], v[176:179], v[88:91]
    v_mfma_f32_16x16x32_bf16 v[92:95], a[216:219], v[176:179], v[92:95]
    v_mfma_f32_16x16x32_bf16 v[96:99], a[132:135], v[176:179], v[96:99]
    v_mfma_f32_16x16x32_bf16 v[100:103], a[208:211], v[180:183], v[100:103]
    buffer_load_dwordx4 a[240:243], v11, s[32:35], s7 offen offset:0 sc1
    v_mfma_f32_16x16x32_bf16 v[104:107], a[212:215], v[180:183], v[104:107]
    v_mfma_f32_16x16x32_bf16 v[108:111], a[128:131], v[180:183], v[108:111]
    v_mfma_f32_16x16x32_bf16 v[112:115], a[216:219], v[180:183], v[112:115]
    v_mfma_f32_16x16x32_bf16 v[116:119], a[132:135], v[180:183], v[116:119]
    buffer_load_dwordx4 v[48:51], v12, s[32:35], s94 offen offset:1024 sc1
    v_mfma_f32_16x16x32_bf16 v[120:123], a[208:211], v[184:187], v[120:123]
    v_mfma_f32_16x16x32_bf16 v[124:127], a[212:215], v[184:187], v[124:127]
    v_mfma_f32_16x16x32_bf16 v[128:131], a[128:131], v[184:187], v[128:131]
    v_mfma_f32_16x16x32_bf16 v[132:135], a[216:219], v[184:187], v[132:135]
    buffer_load_dwordx4 v[52:55], v12, s[32:35], s94 offen offset:2048 sc1
    v_mfma_f32_16x16x32_bf16 v[136:139], a[132:135], v[184:187], v[136:139]
    v_mfma_f32_16x16x32_bf16 v[140:143], a[208:211], v[188:191], v[140:143]
    v_mfma_f32_16x16x32_bf16 v[144:147], a[212:215], v[188:191], v[144:147]
    v_mfma_f32_16x16x32_bf16 v[148:151], a[128:131], v[188:191], v[148:151]
    buffer_load_dwordx4 v[56:59], v12, s[32:35], s94 offen offset:3072 sc1
    v_mfma_f32_16x16x32_bf16 v[152:155], a[216:219], v[188:191], v[152:155]
    v_mfma_f32_16x16x32_bf16 v[156:159], a[132:135], v[188:191], v[156:159]
    buffer_load_dwordx4 v[60:63], v12, s[32:35], s91 offen offset:0 sc1
    s_waitcnt vmcnt(13)
    v_max_u32 v15, v192, v194
    s_waitcnt vmcnt(12)
    v_max3_u32 v15, v15, v196, v198
    s_waitcnt vmcnt(11)
    v_max3_u32 v15, v15, v200, v202
    s_waitcnt vmcnt(10)
    v_max3_u32 v15, v15, v204, v206
    v_cmp_eq_u32 s[100:101], -1, v15
    s_nop 0
    s_cmp_lg_u64 s[100:101], 0
    s_cbranch_scc1 M_slow_a12_0
M_back_a12_0:
    v_mfma_f32_16x16x32_bf16 v[80:83], a[136:139], v[192:195], v[80:83]
    buffer_load_dwordx4 v[64:67], v13, s[32:35], s94 offen offset:1024 sc1
    v_mfma_f32_16x16x32_bf16 v[84:87], a[140:143], v[192:195], v[84:87]
    v_mfma_f32_16x16x32_bf16 v[88:91], a[220:223], v[192:195], v[88:91]
    v_mfma_f32_16x16x32_bf16 v[92:95], a[0:3], v[192:195], v[92:95]
    v_mfma_f32_16x16x32_bf16 v[96:99], a[4:7], v[192:195], v[96:99]
    buffer_load_dwordx4 v[68:71], v13, s[32:35], s94 offen offset:2048 sc1
    v_mfma_f32_16x16x32_bf16 v[100:103], a[136:139], v[196:199], v[100:103]
    v_mfma_f32_16x16x32_bf16 v[104:107], a[140:143], v[196:199], v[104:107]
    v_mfma_f32_16x16x32_bf16 v[108:111], a[220:223], v[196:199], v[108:111]
    v_mfma_f32_16x16x32_bf16 v[112:115], a[0:3], v[196:199], v[112:115]
    buffer_load_dwordx4 v[72:75], v13, s[32:35], s94 offen offset:3072 sc1
    v_mfma_f32_16x16x32_bf16 v[116:119], a[4:7], v[196:199], v[116:119]
    v_mfma_f32_16x16x32_bf16 v[120:123], a[136:139], v[200:203], v[120:123]
    v_mfma_f32_16x16x32_bf16 v[124:127], a[140:143], v[200:203], v[124:127]
    v_mfma_f32_16x16x32_bf16 v[128:131], a[220:223], v[200:203], v[128:131]
    buffer_load_dwordx4 v[76:79], v13, s[32:35], s91 offen offset:0 sc1
    v_mfma_f32_16x16x32_bf16 v[132:135], a[0:3], v[200:203], v[132:135]
    v_mfma_f32_16x16x32_bf16 v[136:139], a[4:7], v[200:203], v[136:139]
    v_mfma_f32_16x16x32_bf16 v[140:143], a[136:139], v[204:207], v[140:143]
    v_mfma_f32_16x16x32_bf16 v[144:147], a[140:143], v[204:207], v[144:147]
    buffer_load_dwordx4 v[160:163], v14, s[32:35], s94 offen offset:1024 sc1
    v_mfma_f32_16x16x32_bf16 v[148:151], a[220:223], v[204:207], v[148:151]
    v_mfma_f32_16x16x32_bf16 v[152:155], a[0:3], v[204:207], v[152:155]
    v_mfma_f32_16x16x32_bf16 v[156:159], a[4:7], v[204:207], v[156:159]
    buffer_load_dwordx4 v[164:167], v14, s[32:35], s94 offen offset:2048 sc1
    buffer_load_dwordx4 v[168:171], v14, s[32:35], s94 offen offset:3072 sc1
    buffer_load_dwordx4 v[172:175], v14, s[32:35], s91 offen offset:0 sc1
    buffer_load_dwordx4 v[176:179], v30, s[32:35], s94 offen offset:1024 sc1
    buffer_load_dwordx4 v[180:183], v30, s[32:35], s94 offen offset:2048 sc1
    s_waitcnt vmcnt(13)
    v_max_u32 v15, v48, v50
    s_waitcnt vmcnt(12)
    v_max3_u32 v15, v15, v52, v54
    s_waitcnt vmcnt(11)
    v_max3_u32 v15, v15, v56, v58
    s_waitcnt vmcnt(10)
    v_max3_u32 v15, v15, v60, v62
    v_cmp_eq_u32 s[100:101], -1, v15
    s_nop 0
    s_cmp_lg_u64 s[100:101], 0
    s_cbranch_scc1 M_slow_a13_0
M_back_a13_0:
    v_mfma_f32_16x16x32_bf16 v[80:83], a[8:11], v[48:51], v[80:83]
    buffer_load_dwordx4 v[184:187], v30, s[32:35], s94 offen offset:3072 sc1
    v_mfma_f32_16x16x32_bf16 v[84:87], a[144:147], v[48:51], v[84:87]
    v_mfma_f32_16x16x32_bf16 v[88:91], a[12:15], v[48:51], v[88:91]
    v_mfma_f32_16x16x32_bf16 v[92:95], a[148:151], v[48:51], v[92:95]
    v_mfma_f32_16x16x32_bf16 v[96:99], a[152:155], v[48:51], v[96:99]
    buffer_load_dwordx4 v[188:191], v30, s[32:35], s91 offen offset:0 sc1
    v_mfma_f32_16x16x32_bf16 v[80:83], a[156:159], v[52:55], v[80:83]
    v_mfma_f32_16x16x32_bf16 v[84:87], a[16:19], v[52:55], v[84:87]
    v_mfma_f32_16x16x32_bf16 v[88:91], a[20:23], v[52:55], v[88:91]
    v_mfma_f32_16x16x32_bf16 v[92:95], a[24:27], v[52:55], v[92:95]
    v_mfma_f32_16x16x32_bf16 v[96:99], a[28:31], v[52:55], v[96:99]
    v_mfma_f32_16x16x32_bf16 v[80:83], a[224:227], v[56:59], v[80:83]
    v_mfma_f32_16x16x32_bf16 v[84:87], a[32:35], v[56:59], v[84:87]
    v_mfma_f32_16x16x32_bf16 v[88:91], a[228:231], v[56:59], v[88:91]
    v_mfma_f32_16x16x32_bf16 v[92:95], a[232:235], v[56:59], v[92:95]
    v_mfma_f32_16x16x32_bf16 v[96:99], a[236:239], v[56:59], v[96:99]
    v_mfma_f32_16x16x32_bf16 v[80:83], a[36:39], v[60:63], v[80:83]
    v_mfma_f32_16x16x32_bf16 v[84:87], a[40:43], v[60:63], v[84:87]
    v_mfma_f32_16x16x32_bf16 v[88:91], a[44:47], v[60:63], v[88:91]
    v_mfma_f32_16x16x32_bf16 v[92:95], a[48:51], v[60:63], v[92:95]
    v_mfma_f32_16x16x32_bf16 v[96:99], a[240:243], v[60:63], v[96:99]
    s_waitcnt vmcnt(11)
    v_max_u32 v15, v64, v66
    s_waitcnt vmcnt(10)
    v_max3_u32 v15, v15, v68, v70
    s_waitcnt vmcnt(9)
    v_max3_u32 v15, v15, v72, v74
    s_waitcnt vmcnt(8)
    v_max3_u32 v15, v15, v76, v78
    v_cmp_eq_u32 s[100:101], -1, v15
    s_nop 0
    s_cmp_lg_u64 s[100:101], 0
    s_cbranch_scc1 M_slow_a13_1
M_back_a13_1:
    v_mfma_f32_16x16x32_bf16 v[100:103], a[8:11], v[64:67], v[100:103]
    ds_write_b128 v229, v[80:83] offset:12800
    v_mfma_f32_16x16x32_bf16 v[104:107], a[144:147], v[64:67], v[104:107]
    ds_write_b128 v229, v[84:87] offset:13824
    v_mfma_f32_16x16x32_bf16 v[108:111], a[12:15], v[64:67], v[108:111]
    ds_write_b128 v229, v[88:91] offset:14848
    v_mfma_f32_16x16x32_bf16 v[112:115], a[148:151], v[64:67], v[112:115]
    ds_write_b128 v229, v[92:95] offset:15872
    v_mfma_f32_16x16x32_bf16 v[116:119], a[152:155], v[64:67], v[116:119]
    ds_write_b128 v229, v[96:99] offset:16896
    v_mfma_f32_16x16x32_bf16 v[100:103], a[156:159], v[68:71], v[100:103]
    v_mfma_f32_16x16x32_bf16 v[104:107], a[16:19], v[68:71], v[104:107]
    v_mfma_f32_16x16x32_bf16 v[108:111], a[20:23], v[68:71], v[108:111]
    v_mfma_f32_16x16x32_bf16 v[112:115], a[24:27], v[68:71], v[112:115]
    v_mfma_f32_16x16x32_bf16 v[116:119], a[28:31], v[68:71], v[116:119]
    v_mfma_f32_16x16x32_bf16 v[100:103], a[224:227], v[72:75], v[100:103]
    v_mfma_f32_16x16x32_bf16 v[104:107], a[32:35], v[72:75], v[104:107]
    v_mfma_f32_16x16x32_bf16 v[108:111], a[228:231], v[72:75], v[108:111]
    v_mfma_f32_16x16x32_bf16 v[112:115], a[232:235], v[72:75], v[112:115]
    v_mfma_f32_16x16x32_bf16 v[116:119], a[236:239], v[72:75], v[116:119]
    v_mfma_f32_16x16x32_bf16 v[100:103], a[36:39], v[76:79], v[100:103]
    v_mfma_f32_16x16x32_bf16 v[104:107], a[40:43], v[76:79], v[104:107]
    v_mfma_f32_16x16x32_bf16 v[108:111], a[44:47], v[76:79], v[108:111]
    v_mfma_f32_16x16x32_bf16 v[112:115], a[48:51], v[76:79], v[112:115]
    v_mfma_f32_16x16x32_bf16 v[116:119], a[240:243], v[76:79], v[116:119]
    s_waitcnt vmcnt(7)
    v_max_u32 v15, v160, v162
    s_waitcnt vmcnt(6)
    v_max3_u32 v15, v15, v164, v166
    s_waitcnt vmcnt(5)
    v_max3_u32 v15, v15, v168, v170
    s_waitcnt vmcnt(4)
    v_max3_u32 v15, v15, v172, v174
    v_cmp_eq_u32 s[100:101], -1, v15
    s_nop 0
    s_cmp_lg_u64 s[100:101], 0
    s_cbranch_scc1 M_slow_a13_2
M_back_a13_2:
    v_mfma_f32_16x16x32_bf16 v[120:123], a[8:11], v[160:163], v[120:123]
    ds_write_b128 v230, v[100:103] offset:12800
    v_mfma_f32_16x16x32_bf16 v[124:127], a[144:147], v[160:163], v[124:127]
    ds_write_b128 v230, v[104:107] offset:13824
    v_mfma_f32_16x16x32_bf16 v[128:131], a[12:15], v[160:163], v[128:131]
    ds_write_b128 v230, v[108:111] offset:14848
    v_mfma_f32_16x16x32_bf16 v[132:135], a[148:151], v[160:163], v[132:135]
    ds_write_b128 v230, v[112:115] offset:15872
    v_mfma_f32_16x16x32_bf16 v[136:139], a[152:155], v[160:163], v[136:139]
    ds_write_b128 v230, v[116:119] offset:16896
    v_mfma_f32_16x16x32_bf16 v[120:123], a[156:159], v[164:167], v[120:123]
    v_mfma_f32_16x16x32_bf16 v[124:127], a[16:19], v[164:167], v[124:127]
    v_mfma_f32_16x16x32_bf16 v[128:131], a[20:23], v[164:167], v[128:131]
    v_mfma_f32_16x16x32_bf16 v[132:135], a[24:27], v[164:167], v[132:135]
    v_mfma_f32_16x16x32_bf16 v[136:139], a[28:31], v[164:167], v[136:139]
    v_mfma_f32_16x16x32_bf16 v[120:123], a[224:227], v[168:171], v[120:123]
    v_mfma_f32_16x16x32_bf16 v[124:127], a[32:35], v[168:171], v[124:127]
    v_mfma_f32_16x16x32_bf16 v[128:131], a[228:231], v[168:171], v[128:131]
    v_mfma_f32_16x16x32_bf16 v[132:135], a[232:235], v[168:171], v[132:135]
    v_mfma_f32_16x16x32_bf16 v[136:139], a[236:239], v[168:171], v[136:139]
    v_mfma_f32_16x16x32_bf16 v[120:123], a[36:39], v[172:175], v[120:123]
    v_mfma_f32_16x16x32_bf16 v[124:127], a[40:43], v[172:175], v[124:127]
    v_mfma_f32_16x16x32_bf16 v[128:131], a[44:47], v[172:175], v[128:131]
    v_mfma_f32_16x16x32_bf16 v[132:135], a[48:51], v[172:175], v[132:135]
    v_mfma_f32_16x16x32_bf16 v[136:139], a[240:243], v[172:175], v[136:139]
    s_waitcnt vmcnt(3)
    v_max_u32 v15, v176, v178
    s_waitcnt vmcnt(2)
    v_max3_u32 v15, v15, v180, v182
    s_waitcnt vmcnt(1)
    v_max3_u32 v15, v15, v184, v186
    s_waitcnt vmcnt(0)
    v_max3_u32 v15, v15, v188, v190
    v_cmp_eq_u32 s[100:101], -1, v15
    s_nop 0
    s_cmp_lg_u64 s[100:101], 0
    s_cbranch_scc1 M_slow_a13_3
M_back_a13_3:
    v_mfma_f32_16x16x32_bf16 v[140:143], a[8:11], v[176:179], v[140:143]
    ds_write_b128 v231, v[120:123] offset:12800
    v_mfma_f32_16x16x32_bf16 v[144:147], a[144:147], v[176:179], v[144:147]
    ds_write_b128 v231, v[124:127] offset:13824
    v_mfma_f32_16x16x32_bf16 v[148:151], a[12:15], v[176:179], v[148:151]
    ds_write_b128 v231, v[128:131] offset:14848
    v_mfma_f32_16x16x32_bf16 v[152:155], a[148:151], v[176:179], v[152:155]
    ds_write_b128 v231, v[132:135] offset:15872
    v_mfma_f32_16x16x32_bf16 v[156:159], a[152:155], v[176:179], v[156:159]
    ds_write_b128 v231, v[136:139] offset:16896
    v_mfma_f32_16x16x32_bf16 v[140:143], a[156:159], v[180:183], v[140:143]
    s_waitcnt lgkmcnt(0)
    s_barrier
    v_mfma_f32_16x16x32_bf16 v[144:147], a[16:19], v[180:183], v[144:147]
    ds_read_b128 v[80:83], v233 offset:12800
    v_mfma_f32_16x16x32_bf16 v[148:151], a[20:23], v[180:183], v[148:151]
    ds_read_b128 v[84:87], v233 offset:13824
    v_mfma_f32_16x16x32_bf16 v[152:155], a[24:27], v[180:183], v[152:155]
    ds_read_b128 v[88:91], v233 offset:14848
    v_mfma_f32_16x16x32_bf16 v[156:159], a[28:31], v[180:183], v[156:159]
    ds_read_b128 v[92:95], v233 offset:15872
    v_mfma_f32_16x16x32_bf16 v[140:143], a[224:227], v[184:187], v[140:143]
    ds_read_b128 v[96:99], v233 offset:16896
    v_mfma_f32_16x16x32_bf16 v[144:147], a[32:35], v[184:187], v[144:147]
    ds_read_b128 v[100:103], v233 offset:17920
    v_mfma_f32_16x16x32_bf16 v[148:151], a[228:231], v[184:187], v[148:151]
    ds_read_b128 v[104:107], v233 offset:18944
    v_mfma_f32_16x16x32_bf16 v[152:155], a[232:235], v[184:187], v[152:155]
    ds_read_b128 v[108:111], v233 offset:19968
    v_mfma_f32_16x16x32_bf16 v[156:159], a[236:239], v[184:187], v[156:159]
    ds_read_b128 v[112:115], v233 offset:20992
    v_mfma_f32_16x16x32_bf16 v[140:143], a[36:39], v[188:191], v[140:143]
    ds_read_b128 v[116:119], v233 offset:22016
    v_mfma_f32_16x16x32_bf16 v[144:147], a[40:43], v[188:191], v[144:147]
    ds_read_b128 v[120:123], v233 offset:23040
    v_mfma_f32_16x16x32_bf16 v[148:151], a[44:47], v[188:191], v[148:151]
    ds_read_b128 v[124:127], v233 offset:24064
    v_mfma_f32_16x16x32_bf16 v[152:155], a[48:51], v[188:191], v[152:155]
    ds_read_b128 v[128:131], v233 offset:25088
    v_mfma_f32_16x16x32_bf16 v[156:159], a[240:243], v[188:191], v[156:159]
    ds_read_b128 v[132:135], v233 offset:26112
    ds_read_b128 v[136:139], v233 offset:27136
    s_waitcnt lgkmcnt(0)
    v_pk_add_f32 v[236:237], v[236:237], v[80:81]
    v_pk_add_f32 v[238:239], v[238:239], v[82:83]
    v_pk_add_f32 v[240:241], v[240:241], v[84:85]
    v_pk_add_f32 v[242:243], v[242:243], v[86:87]
    v_pk_add_f32 v[244:245], v[244:245], v[88:89]
    v_pk_add_f32 v[246:247], v[246:247], v[90:91]
    v_pk_add_f32 v[248:249], v[248:249], v[92:93]
    v_pk_add_f32 v[250:251], v[250:251], v[94:95]
    v_pk_add_f32 v[252:253], v[252:253], v[96:97]
    v_pk_add_f32 v[254:255], v[254:255], v[98:99]
    v_pk_add_f32 v[236:237], v[236:237], v[100:101]
    v_pk_add_f32 v[238:239], v[238:239], v[102:103]
    v_pk_add_f32 v[240:241], v[240:241], v[104:105]
    v_pk_add_f32 v[242:243], v[242:243], v[106:107]
    v_pk_add_f32 v[244:245], v[244:245], v[108:109]
    v_pk_add_f32 v[246:247], v[246:247], v[110:111]
    v_pk_add_f32 v[248:249], v[248:249], v[112:113]
    v_pk_add_f32 v[250:251], v[250:251], v[114:115]
    v_pk_add_f32 v[252:253], v[252:253], v[116:117]
    v_pk_add_f32 v[254:255], v[254:255], v[118:119]
    v_pk_add_f32 v[236:237], v[236:237], v[120:121]
    v_pk_add_f32 v[238:239], v[238:239], v[122:123]
    v_pk_add_f32 v[240:241], v[240:241], v[124:125]
    v_pk_add_f32 v[242:243], v[242:243], v[126:127]
    v_pk_add_f32 v[244:245], v[244:245], v[128:129]
    v_pk_add_f32 v[246:247], v[246:247], v[130:131]
    v_pk_add_f32 v[248:249], v[248:249], v[132:133]
    v_pk_add_f32 v[250:251], v[250:251], v[134:135]
    v_pk_add_f32 v[252:253], v[252:253], v[136:137]
    v_pk_add_f32 v[254:255], v[254:255], v[138:139]
    v_pk_add_f32 v[236:237], v[236:237], v[140:141]
    v_pk_add_f32 v[238:239], v[238:239], v[142:143]
    v_pk_add_f32 v[240:241], v[240:241], v[144:145]
    v_pk_add_f32 v[242:243], v[242:243], v[146:147]
    v_pk_add_f32 v[244:245], v[244:245], v[148:149]
    v_pk_add_f32 v[246:247], v[246:247], v[150:151]
    v_pk_add_f32 v[248:249], v[248:249], v[152:153]
    v_pk_add_f32 v[250:251], v[250:251], v[154:155]
    v_pk_add_f32 v[252:253], v[252:253], v[156:157]
    v_pk_add_f32 v[254:255], v[254:255], v[158:159]
    v_cvt_pk_bf16_f32 v208, v236, v237
    v_cvt_pk_bf16_f32 v209, v238, v239
    v_cvt_pk_bf16_f32 v210, v240, v241
    v_cvt_pk_bf16_f32 v211, v242, v243
    v_cvt_pk_bf16_f32 v212, v244, v245
    v_cvt_pk_bf16_f32 v213, v246, v247
    v_cvt_pk_bf16_f32 v214, v248, v249
    v_cvt_pk_bf16_f32 v215, v250, v251
    v_cvt_pk_bf16_f32 v216, v252, v253
    v_cvt_pk_bf16_f32 v217, v254, v255
    ds_write_b128 v220, v[208:211]
    ds_write_b128 v218, v[212:215]
    ds_write_b64 v221, v[216:217] offset:2048
    s_waitcnt lgkmcnt(0)
    ds_read_b128 v[80:83], v222 offset:0
    ds_read_b128 v[84:87], v222 offset:1024
    ds_read_b128 v[88:91], v222 offset:2048
    s_waitcnt lgkmcnt(2)
    buffer_store_dwordx4 v[80:83], v223, s[28:31], s46 offen sc1
    s_waitcnt lgkmcnt(1)
    buffer_store_dwordx4 v[84:87], v227, s[28:31], s46 offen sc1
    s_waitcnt lgkmcnt(0)
    buffer_store_dwordx4 v[88:91], v224, s[28:31], s47 offen offset:1024 sc1
    s_cmp_lg_u32 s2, 0
    s_cbranch_scc1 M_end
    s_mov_b32 s56, 21037056
    buffer_store_dword v1, v29, s[32:35], s56 offen sc1
M_end:
    s_endpgm
M_slow_s0:
    s_mov_b32 s8, 0
M_spin_s0:
    buffer_load_dword v228, v28, s[32:35], s15 offen sc1
    s_waitcnt vmcnt(0)
    v_cmp_ne_u32 s[100:101], s23, v228
    s_add_u32 s8, s8, 1
    s_cmp_eq_u64 s[100:101], 0
    s_cbranch_scc1 M_back_s0
    s_cmp_lt_u32 s8, 0x4000
    s_cbranch_scc1 M_spin_s0
    s_branch M_back_s0
M_slow_st:
    s_mov_b32 s8, 0
M_spin_st:
    buffer_load_dwordx4 v[32:35], v234, s[32:35], s47 offen sc1
    s_waitcnt vmcnt(0)
    v_cmp_ne_u32 s[100:101], s22, v35
    s_add_u32 s8, s8, 1
    s_cmp_eq_u64 s[100:101], 0
    s_cbranch_scc1 M_back_st
    s_cmp_lt_u32 s8, 0x4000
    s_cbranch_scc1 M_spin_st
    s_branch M_back_st
M_slow_s0b:
    s_mov_b32 s8, 0
M_spin_s0b:
    buffer_load_dword v233, v31, s[32:35], s9 offen sc1
    s_waitcnt vmcnt(0)
    v_cmp_ne_u32 s[100:101], s23, v233
    s_add_u32 s8, s8, 1
    s_cmp_eq_u64 s[100:101], 0
    s_cbranch_scc1 M_back_s0b
    s_cmp_lt_u32 s8, 0x4000
    s_cbranch_scc1 M_spin_s0b
    s_branch M_back_s0b
M_slow_h1:
    s_mov_b32 s8, 0
M_spin_h1:
    buffer_load_dword v31, v28, s[32:35], s15 offen sc1
    s_waitcnt vmcnt(0)
    v_cmp_ne_u32 s[100:101], s23, v31
    s_add_u32 s8, s8, 1
    s_cmp_eq_u64 s[100:101], 0
    s_cbranch_scc1 M_back_h1
    s_cmp_lt_u32 s8, 0x4000
    s_cbranch_scc1 M_spin_h1
    s_branch M_back_h1
M_slow_kva:
    s_mov_b32 s8, 0
M_spin_kva:
    buffer_load_dwordx4 v[42:45], v19, s[32:35], s50 offen sc1
    s_waitcnt vmcnt(0)
    v_mfma_f32_16x16x32_bf16 v[32:35], v[24:27], v[42:45], 0
    s_nop 7
    v_cmp_u_f32 s[100:101], v32, v32
    s_add_u32 s8, s8, 1
    s_cmp_eq_u64 s[100:101], 0
    s_cbranch_scc1 M_back_kva
    s_cmp_lt_u32 s8, 0x4000
    s_cbranch_scc1 M_spin_kva
    s_branch M_back_kva
M_slow_kvb:
    s_mov_b32 s8, 0
M_spin_kvb:
    buffer_load_dwordx4 v[32:35], v5, s[32:35], s52 offen sc1
    s_waitcnt vmcnt(0)
    v_max_u32 v15, v32, v34
    v_cmp_eq_u32 s[100:101], -1, v15
    s_add_u32 s8, s8, 1
    s_cmp_eq_u64 s[100:101], 0
    s_cbranch_scc1 M_back_kvb
    s_cmp_lt_u32 s8, 0x4000
    s_cbranch_scc1 M_spin_kvb
    s_branch M_back_kvb
M_slow_a8_0:
    s_mov_b32 s8, 0
M_spin_a8_0:
    s_bfe_u32 s12, 1, s55
    s_lshl_b32 s12, s12, 10
    s_add_u32 s13, s12, s93
    buffer_load_dwordx4 v[48:51], v12, s[32:35], s13 offen sc1
    buffer_load_dwordx4 v[52:55], v13, s[32:35], s13 offen sc1
    buffer_load_dwordx4 v[56:59], v14, s[32:35], s13 offen sc1
    buffer_load_dwordx4 v[60:63], v30, s[32:35], s13 offen sc1
    s_waitcnt vmcnt(0)
    v_max_u32 v15, v48, v52
    v_max3_u32 v15, v15, v56, v60
    v_cmp_eq_u32 s[100:101], -1, v15
    s_add_u32 s8, s8, 1
    s_cmp_eq_u64 s[100:101], 0
    s_cbranch_scc1 M_back_a8_0
    s_cmp_lt_u32 s8, 0x4000
    s_cbranch_scc1 M_spin_a8_0
    s_branch M_back_a8_0
M_slow_a9_0:
    s_mov_b32 s8, 0
M_spin_a9_0:
    s_bfe_u32 s12, 4384, s55
    s_lshl_b32 s12, s12, 10
    s_add_u32 s13, s12, s93
    buffer_load_dwordx4 v[64:67], v12, s[32:35], s13 offen sc1
    buffer_load_dwordx4 v[68:71], v13, s[32:35], s13 offen sc1
    buffer_load_dwordx4 v[72:75], v14, s[32:35], s13 offen sc1
    buffer_load_dwordx4 v[76:79], v30, s[32:35], s13 offen sc1
    s_waitcnt vmcnt(0)
    v_max_u32 v15, v64, v68
    v_max3_u32 v15, v15, v72, v76
    v_cmp_eq_u32 s[100:101], -1, v15
    s_add_u32 s8, s8, 1
    s_cmp_eq_u64 s[100:101], 0
    s_cbranch_scc1 M_back_a9_0
    s_cmp_lt_u32 s8, 0x4000
    s_cbranch_scc1 M_spin_a9_0
    s_branch M_back_a9_0
M_slow_a10_0:
    s_mov_b32 s8, 0
M_spin_a10_0:
    s_bfe_u32 s12, 8978, s55
    s_lshl_b32 s12, s12, 10
    s_add_u32 s13, s12, s93
    buffer_load_dwordx4 v[160:163], v12, s[32:35], s13 offen sc1
    buffer_load_dwordx4 v[164:167], v13, s[32:35], s13 offen sc1
    buffer_load_dwordx4 v[168:171], v14, s[32:35], s13 offen sc1
    buffer_load_dwordx4 v[172:175], v30, s[32:35], s13 offen sc1
    s_waitcnt vmcnt(0)
    v_max_u32 v15, v160, v164
    v_max3_u32 v15, v15, v168, v172
    v_cmp_eq_u32 s[100:101], -1, v15
    s_add_u32 s8, s8, 1
    s_cmp_eq_u64 s[100:101], 0
    s_cbranch_scc1 M_back_a10_0
    s_cmp_lt_u32 s8, 0x4000
    s_cbranch_scc1 M_spin_a10_0
    s_branch M_back_a10_0
M_slow_a11_0:
    s_mov_b32 s8, 0
M_spin_a11_0:
    s_bfe_u32 s12, 12851, s55
    s_lshl_b32 s12, s12, 10
    s_add_u32 s13, s12, s93
    buffer_load_dwordx4 v[176:179], v12, s[32:35], s13 offen sc1
    buffer_load_dwordx4 v[180:183], v13, s[32:35], s13 offen sc1
    buffer_load_dwordx4 v[184:187], v14, s[32:35], s13 offen sc1
    buffer_load_dwordx4 v[188:191], v30, s[32:35], s13 offen sc1
    s_waitcnt vmcnt(0)
    v_max_u32 v15, v176, v180
    v_max3_u32 v15, v15, v184, v188
    v_cmp_eq_u32 s[100:101], -1, v15
    s_add_u32 s8, s8, 1
    s_cmp_eq_u64 s[100:101], 0
    s_cbranch_scc1 M_back_a11_0
    s_cmp_lt_u32 s8, 0x4000
    s_cbranch_scc1 M_spin_a11_0
    s_branch M_back_a11_0
M_slow_a12_0:
    s_mov_b32 s8, 0
M_spin_a12_0:
    buffer_load_dwordx4 v[192:195], v12, s[32:35], s94 offen offset:0 sc1
    buffer_load_dwordx4 v[196:199], v13, s[32:35], s94 offen offset:0 sc1
    buffer_load_dwordx4 v[200:203], v14, s[32:35], s94 offen offset:0 sc1
    buffer_load_dwordx4 v[204:207], v30, s[32:35], s94 offen offset:0 sc1
    s_waitcnt vmcnt(0)
    v_max_u32 v15, v192, v194
    v_max3_u32 v15, v15, v196, v198
    v_max3_u32 v15, v15, v200, v202
    v_max3_u32 v15, v15, v204, v206
    v_cmp_eq_u32 s[100:101], -1, v15
    s_add_u32 s8, s8, 1
    s_cmp_eq_u64 s[100:101], 0
    s_cbranch_scc1 M_back_a12_0
    s_cmp_lt_u32 s8, 0x4000
    s_cbranch_scc1 M_spin_a12_0
    s_branch M_back_a12_0
M_slow_a13_0:
    s_mov_b32 s8, 0
M_spin_a13_0:
    buffer_load_dwordx4 v[48:51], v12, s[32:35], s94 offen offset:1024 sc1
    buffer_load_dwordx4 v[52:55], v12, s[32:35], s94 offen offset:2048 sc1
    buffer_load_dwordx4 v[56:59], v12, s[32:35], s94 offen offset:3072 sc1
    buffer_load_dwordx4 v[60:63], v12, s[32:35], s91 offen offset:0 sc1
    s_waitcnt vmcnt(0)
    v_max_u32 v15, v48, v50
    v_max3_u32 v15, v15, v52, v54
    v_max3_u32 v15, v15, v56, v58
    v_max3_u32 v15, v15, v60, v62
    v_cmp_eq_u32 s[100:101], -1, v15
    s_add_u32 s8, s8, 1
    s_cmp_eq_u64 s[100:101], 0
    s_cbranch_scc1 M_back_a13_0
    s_cmp_lt_u32 s8, 0x4000
    s_cbranch_scc1 M_spin_a13_0
    s_branch M_back_a13_0
M_slow_a13_1:
    s_mov_b32 s8, 0
M_spin_a13_1:
    buffer_load_dwordx4 v[64:67], v13, s[32:35], s94 offen offset:1024 sc1
    buffer_load_dwordx4 v[68:71], v13, s[32:35], s94 offen offset:2048 sc1
    buffer_load_dwordx4 v[72:75], v13, s[32:35], s94 offen offset:3072 sc1
    buffer_load_dwordx4 v[76:79], v13, s[32:35], s91 offen offset:0 sc1
    s_waitcnt vmcnt(0)
    v_max_u32 v15, v64, v66
    v_max3_u32 v15, v15, v68, v70
    v_max3_u32 v15, v15, v72, v74
    v_max3_u32 v15, v15, v76, v78
    v_cmp_eq_u32 s[100:101], -1, v15
    s_add_u32 s8, s8, 1
    s_cmp_eq_u64 s[100:101], 0
    s_cbranch_scc1 M_back_a13_1
    s_cmp_lt_u32 s8, 0x4000
    s_cbranch_scc1 M_spin_a13_1
    s_branch M_back_a13_1
M_slow_a13_2:
    s_mov_b32 s8, 0
M_spin_a13_2:
    buffer_load_dwordx4 v[160:163], v14, s[32:35], s94 offen offset:1024 sc1
    buffer_load_dwordx4 v[164:167], v14, s[32:35], s94 offen offset:2048 sc1
    buffer_load_dwordx4 v[168:171], v14, s[32:35], s94 offen offset:3072 sc1
    buffer_load_dwordx4 v[172:175], v14, s[32:35], s91 offen offset:0 sc1
    s_waitcnt vmcnt(0)
    v_max_u32 v15, v160, v162
    v_max3_u32 v15, v15, v164, v166
    v_max3_u32 v15, v15, v168, v170
    v_max3_u32 v15, v15, v172, v174
    v_cmp_eq_u32 s[100:101], -1, v15
    s_add_u32 s8, s8, 1
    s_cmp_eq_u64 s[100:101], 0
    s_cbranch_scc1 M_back_a13_2
    s_cmp_lt_u32 s8, 0x4000
    s_cbranch_scc1 M_spin_a13_2
    s_branch M_back_a13_2
M_slow_a13_3:
    s_mov_b32 s8, 0
M_spin_a13_3:
    buffer_load_dwordx4 v[176:179], v30, s[32:35], s94 offen offset:1024 sc1
    buffer_load_dwordx4 v[180:183], v30, s[32:35], s94 offen offset:2048 sc1
    buffer_load_dwordx4 v[184:187], v30, s[32:35], s94 offen offset:3072 sc1
    buffer_load_dwordx4 v[188:191], v30, s[32:35], s91 offen offset:0 sc1
    s_waitcnt vmcnt(0)
    v_max_u32 v15, v176, v178
    v_max3_u32 v15, v15, v180, v182
    v_max3_u32 v15, v15, v184, v186
    v_max3_u32 v15, v15, v188, v190
    v_cmp_eq_u32 s[100:101], -1, v15
    s_add_u32 s8, s8, 1
    s_cmp_eq_u64 s[100:101], 0
    s_cbranch_scc1 M_back_a13_3
    s_cmp_lt_u32 s8, 0x4000
    s_cbranch_scc1 M_spin_a13_3
    s_branch M_back_a13_3
M_b2o:
    s_sub_u32 s56, s56, 48
    s_lshl1_add_u32 s56, s56, s57
    s_lshl_b32 s56, s56, 1
    s_add_u32 s65, s56, 0
    s_mul_i32 s66, s65, 205
    s_lshr_b32 s66, s66, 10
    s_mul_i32 s67, s66, 5
    s_sub_u32 s67, s65, s67
    s_lshl_b32 s68, s67, 3
    s_cmp_gt_u32 s67, 2
    s_cselect_b32 s69, 4, 0
    s_sub_u32 s68, s68, s69
    s_cmp_eq_u32 s67, 2
    s_cselect_b32 s69, 20, 4
    s_mul_i32 s69, s69, 0
    s_add_u32 s68, s68, s69
    s_mul_i32 s66, s66, 40
    s_add_u32 s68, s68, s66
    s_mul_i32 s68, s68, 1280
    s_add_u32 s68, s68, s59
    buffer_load_dwordx4 v239, s[8:11], s68 offen offset:0 nt lds
    s_add_u32 s65, s56, 0
    s_mul_i32 s66, s65, 205
    s_lshr_b32 s66, s66, 10
    s_mul_i32 s67, s66, 5
    s_sub_u32 s67, s65, s67
    s_lshl_b32 s68, s67, 3
    s_cmp_gt_u32 s67, 2
    s_cselect_b32 s69, 4, 0
    s_sub_u32 s68, s68, s69
    s_cmp_eq_u32 s67, 2
    s_cselect_b32 s69, 20, 4
    s_mul_i32 s69, s69, 1
    s_add_u32 s68, s68, s69
    s_mul_i32 s66, s66, 40
    s_add_u32 s68, s68, s66
    s_mul_i32 s68, s68, 1280
    s_add_u32 s68, s68, s59
    s_sub_u32 s68, s68, 1024
    buffer_load_dwordx4 v239, s[8:11], s68 offen offset:1024 nt lds
    s_add_u32 s65, s56, 1
    s_mul_i32 s66, s65, 205
    s_lshr_b32 s66, s66, 10
    s_mul_i32 s67, s66, 5
    s_sub_u32 s67, s65, s67
    s_lshl_b32 s68, s67, 3
    s_cmp_gt_u32 s67, 2
    s_cselect_b32 s69, 4, 0
    s_sub_u32 s68, s68, s69
    s_cmp_eq_u32 s67, 2
    s_cselect_b32 s69, 20, 4
    s_mul_i32 s69, s69, 0
    s_add_u32 s68, s68, s69
    s_mul_i32 s66, s66, 40
    s_add_u32 s68, s68, s66
    s_mul_i32 s68, s68, 1280
    s_add_u32 s68, s68, s59
    s_sub_u32 s68, s68, 2048
    buffer_load_dwordx4 v239, s[8:11], s68 offen offset:2048 nt lds
    s_add_u32 s65, s56, 1
    s_mul_i32 s66, s65, 205
    s_lshr_b32 s66, s66, 10
    s_mul_i32 s67, s66, 5
    s_sub_u32 s67, s65, s67
    s_lshl_b32 s68, s67, 3
    s_cmp_gt_u32 s67, 2
    s_cselect_b32 s69, 4, 0
    s_sub_u32 s68, s68, s69
    s_cmp_eq_u32 s67, 2
    s_cselect_b32 s69, 20, 4
    s_mul_i32 s69, s69, 1
    s_add_u32 s68, s68, s69
    s_mul_i32 s66, s66, 40
    s_add_u32 s68, s68, s66
    s_mul_i32 s68, s68, 1280
    s_add_u32 s68, s68, s59
    s_sub_u32 s68, s68, 3072
    buffer_load_dwordx4 v239, s[8:11], s68 offen offset:3072 nt lds
    s_branch M_b2o_back
M_codeend:
.p2align 8
.type M_tbl,@object
M_tbl:
.long 0x1f200, 0x0, 0x0, 0x0, 0x1f228, 0x10, 0x10, 0x4, 0x1f208, 0x20, 0x20, 0x8, 0x1f230, 0x30, 0x30, 0xc
.long 0x1f300, 0x40, 0x40000000, 0x10, 0x1f328, 0x50, 0x40000000, 0x14, 0x1f308, 0x60, 0x40000000, 0x18, 0x1f330, 0x70, 0x40000000, 0x1c
.long 0x1f400, 0x80, 0x40000000, 0x20, 0x1f428, 0x90, 0x40000000, 0x24, 0x1f408, 0xa0, 0x40000000, 0x28, 0x1f430, 0xb0, 0x40000000, 0x2c
.long 0x1f500, 0xc0, 0x40000000, 0x30, 0x1f528, 0xd0, 0x40000000, 0x34, 0x1f508, 0xe0, 0x40000000, 0x38, 0x1f530, 0xf0, 0x40000000, 0x3c
.long 0x1f210, 0x100, 0x8, 0x40, 0x1f238, 0x110, 0x18, 0x44, 0x1f218, 0x120, 0x28, 0x48, 0x1f240, 0x130, 0x38, 0x4c
.long 0x1f310, 0x140, 0x40000000, 0x50, 0x1f338, 0x150, 0x40000000, 0x54, 0x1f318, 0x160, 0x40000000, 0x58, 0x1f340, 0x170, 0x40000000, 0x5c
.long 0x1f410, 0x180, 0x40000000, 0x60, 0x1f438, 0x190, 0x40000000, 0x64, 0x1f418, 0x1a0, 0x40000000, 0x68, 0x1f440, 0x1b0, 0x40000000, 0x6c
.long 0x1f510, 0x1c0, 0x40000000, 0x70, 0x1f538, 0x1d0, 0x40000000, 0x74, 0x1f518, 0x1e0, 0x40000000, 0x78, 0x1f540, 0x1f0, 0x40000000, 0x7c
.long 0x1f220, 0x400, 0x40000000, 0x80, 0x1f248, 0x410, 0x40000000, 0x84, 0x1f250, 0x420, 0x40000000, 0x88, 0x1f278, 0x430, 0x40000000, 0x8c
.long 0x1f320, 0x440, 0x40000000, 0x90, 0x1f348, 0x450, 0x40000000, 0x94, 0x1f350, 0x460, 0x40000000, 0x98, 0x1f378, 0x470, 0x40000000, 0x9c
.long 0x1f420, 0x480, 0x40000000, 0xa0, 0x1f448, 0x490, 0x40000000, 0xa4, 0x1f450, 0x4a0, 0x40000000, 0xa8, 0x1f478, 0x4b0, 0x40000000, 0xac
.long 0x1f520, 0x4c0, 0x40000000, 0xb0, 0x1f548, 0x4d0, 0x40000000, 0xb4, 0x1f550, 0x4e0, 0x40000000, 0xb8, 0x1f578, 0x4f0, 0x40000000, 0xbc
.long 0x1f258, 0x500, 0x40000000, 0xc0, 0x1f280, 0x510, 0x40000000, 0xc4, 0x1f260, 0x520, 0x40000000, 0xc8, 0x1f288, 0x530, 0x40000000, 0xcc
.long 0x1f358, 0x540, 0x40000000, 0xd0, 0x1f380, 0x550, 0x40000000, 0xd4, 0x1f360, 0x560, 0x40000000, 0xd8, 0x1f388, 0x570, 0x40000000, 0xdc
.long 0x1f458, 0x580, 0x40000000, 0xe0, 0x1f480, 0x590, 0x40000000, 0xe4, 0x1f460, 0x5a0, 0x40000000, 0xe8, 0x1f488, 0x5b0, 0x40000000, 0xec
.long 0x1f558, 0x5c0, 0x40000000, 0xf0, 0x1f580, 0x5d0, 0x40000000, 0xf4, 0x1f560, 0x5e0, 0x40000000, 0xf8, 0x1f588, 0x5f0, 0x40000000, 0xfc
.long 0x1f268, 0x800, 0x40, 0x100, 0x1f290, 0x810, 0x50, 0x104, 0x1f270, 0x820, 0x60, 0x108, 0x1f298, 0x830, 0x70, 0x10c
.long 0x1f368, 0x840, 0x40000000, 0x110, 0x1f390, 0x850, 0x40000000, 0x114, 0x1f370, 0x860, 0x40000000, 0x118, 0x1f398, 0x870, 0x40000000, 0x11c
.long 0x1f468, 0x880, 0x40000000, 0x120, 0x1f490, 0x890, 0x40000000, 0x124, 0x1f470, 0x8a0, 0x40000000, 0x128, 0x1f498, 0x8b0, 0x40000000, 0x12c
.long 0x1f568, 0x8c0, 0x40000000, 0x130, 0x1f590, 0x8d0, 0x40000000, 0x134, 0x1f570, 0x8e0, 0x40000000, 0x138, 0x1f598, 0x8f0, 0x40000000, 0x13c
.long 0x1f2a0, 0x900, 0x48, 0x140, 0x1f2c8, 0x910, 0x58, 0x144, 0x1f2a8, 0x920, 0x68, 0x148, 0x1f2d0, 0x930, 0x78, 0x14c
.long 0x1f3a0, 0x940, 0x40000000, 0x150, 0x1f3c8, 0x950, 0x40000000, 0x154, 0x1f3a8, 0x960, 0x40000000, 0x158, 0x1f3d0, 0x970, 0x40000000, 0x15c
.long 0x1f4a0, 0x980, 0x40000000, 0x160, 0x1f4c8, 0x990, 0x40000000, 0x164, 0x1f4a8, 0x9a0, 0x40000000, 0x168, 0x1f4d0, 0x9b0, 0x40000000, 0x16c
.long 0x1f5a0, 0x9c0, 0x40000000, 0x170, 0x1f5c8, 0x9d0, 0x40000000, 0x174, 0x1f5a8, 0x9e0, 0x40000000, 0x178, 0x1f5d0, 0x9f0, 0x40000000, 0x17c
.long 0x1f2b0, 0x1e000, 0x40000000, 0x180, 0x1f2d8, 0x1e010, 0x40000000, 0x184, 0x1f2b8, 0x1e020, 0x40000000, 0x188, 0x1f2e0, 0x1e030, 0x40000000, 0x18c
.long 0x1f3b0, 0x1e040, 0x40000000, 0x190, 0x1f3d8, 0x1e050, 0x40000000, 0x194, 0x1f3b8, 0x1e060, 0x40000000, 0x198, 0x1f3e0, 0x1e070, 0x40000000, 0x19c
.long 0x1f4b0, 0x1e080, 0x40000000, 0x1a0, 0x1f4d8, 0x1e090, 0x40000000, 0x1a4, 0x1f4b8, 0x1e0a0, 0x40000000, 0x1a8, 0x1f4e0, 0x1e0b0, 0x40000000, 0x1ac
.long 0x1f5b0, 0x1e0c0, 0x40000000, 0x1b0, 0x1f5d8, 0x1e0d0, 0x40000000, 0x1b4, 0x1f5b8, 0x1e0e0, 0x40000000, 0x1b8, 0x1f5e0, 0x1e0f0, 0x40000000, 0x1bc
.long 0x1f2c0, 0x1e100, 0x40000000, 0x1c0, 0x1f2e8, 0x1e110, 0x40000000, 0x1c4, 0x1f2c0, 0x1e120, 0x40000000, 0x1c8, 0x1f2e8, 0x1e130, 0x40000000, 0x1cc
.long 0x1f3c0, 0x1e140, 0x40000000, 0x1d0, 0x1f3e8, 0x1e150, 0x40000000, 0x1d4, 0x1f3c0, 0x1e160, 0x40000000, 0x1d8, 0x1f3e8, 0x1e170, 0x40000000, 0x1dc
.long 0x1f4c0, 0x1e180, 0x40000000, 0x1e0, 0x1f4e8, 0x1e190, 0x40000000, 0x1e4, 0x1f4c0, 0x1e1a0, 0x40000000, 0x1e8, 0x1f4e8, 0x1e1b0, 0x40000000, 0x1ec
.long 0x1f5c0, 0x1e1c0, 0x40000000, 0x1f0, 0x1f5e8, 0x1e1d0, 0x40000000, 0x1f4, 0x1f5c0, 0x1e1e0, 0x40000000, 0x1f8, 0x1f5e8, 0x1e1f0, 0x40000000, 0x1fc
.long 0x21a00, 0x1e400, 0x80, 0x200, 0x21a08, 0x1e410, 0x90, 0x204, 0x21a10, 0x1e420, 0xa0, 0x208, 0x21a18, 0x1e430, 0xb0, 0x20c
.long 0x21a40, 0x1e440, 0x40000000, 0x210, 0x21a48, 0x1e450, 0x40000000, 0x214, 0x21a50, 0x1e460, 0x40000000, 0x218, 0x21a58, 0x1e470, 0x40000000, 0x21c
.long 0x21a80, 0x1e480, 0x40000000, 0x220, 0x21a88, 0x1e490, 0x40000000, 0x224, 0x21a90, 0x1e4a0, 0x40000000, 0x228, 0x21a98, 0x1e4b0, 0x40000000, 0x22c
.long 0x21ac0, 0x1e4c0, 0x40000000, 0x230, 0x21ac8, 0x1e4d0, 0x40000000, 0x234, 0x21ad0, 0x1e4e0, 0x40000000, 0x238, 0x21ad8, 0x1e4f0, 0x40000000, 0x23c
.long 0x21a20, 0x1e500, 0x88, 0x240, 0x21a28, 0x1e510, 0x98, 0x244, 0x21a30, 0x1e520, 0xa8, 0x248, 0x21a38, 0x1e530, 0xb8, 0x24c
.long 0x21a60, 0x1e540, 0x40000000, 0x250, 0x21a68, 0x1e550, 0x40000000, 0x254, 0x21a70, 0x1e560, 0x40000000, 0x258, 0x21a78, 0x1e570, 0x40000000, 0x25c
.long 0x21aa0, 0x1e580, 0x40000000, 0x260, 0x21aa8, 0x1e590, 0x40000000, 0x264, 0x21ab0, 0x1e5a0, 0x40000000, 0x268, 0x21ab8, 0x1e5b0, 0x40000000, 0x26c
.long 0x21ae0, 0x1e5c0, 0x40000000, 0x270, 0x21ae8, 0x1e5d0, 0x40000000, 0x274, 0x21af0, 0x1e5e0, 0x40000000, 0x278, 0x21af8, 0x1e5f0, 0x40000000, 0x27c
.long 0x22600, 0x1e800, 0x40000000, 0x280, 0x22608, 0x1e810, 0x40000000, 0x284, 0x22610, 0x1e820, 0x40000000, 0x288, 0x22618, 0x1e830, 0x40000000, 0x28c
.long 0x22640, 0x1e840, 0x40000000, 0x290, 0x22648, 0x1e850, 0x40000000, 0x294, 0x22650, 0x1e860, 0x40000000, 0x298, 0x22658, 0x1e870, 0x40000000, 0x29c
.long 0x22680, 0x1e880, 0x40000000, 0x2a0, 0x22688, 0x1e890, 0x40000000, 0x2a4, 0x22690, 0x1e8a0, 0x40000000, 0x2a8, 0x22698, 0x1e8b0, 0x40000000, 0x2ac
.long 0x226c0, 0x1e8c0, 0x40000000, 0x2b0, 0x226c8, 0x1e8d0, 0x40000000, 0x2b4, 0x226d0, 0x1e8e0, 0x40000000, 0x2b8, 0x226d8, 0x1e8f0, 0x40000000, 0x2bc
.long 0x22620, 0x1e900, 0x40000000, 0x2c0, 0x22628, 0x1e910, 0x40000000, 0x2c4, 0x22630, 0x1e920, 0x40000000, 0x2c8, 0x22638, 0x1e930, 0x40000000, 0x2cc
.long 0x22660, 0x1e940, 0x40000000, 0x2d0, 0x22668, 0x1e950, 0x40000000, 0x2d4, 0x22670, 0x1e960, 0x40000000, 0x2d8, 0x22678, 0x1e970, 0x40000000, 0x2dc
.long 0x226a0, 0x1e980, 0x40000000, 0x2e0, 0x226a8, 0x1e990, 0x40000000, 0x2e4, 0x226b0, 0x1e9a0, 0x40000000, 0x2e8, 0x226b8, 0x1e9b0, 0x40000000, 0x2ec
.long 0x226e0, 0x1e9c0, 0x40000000, 0x2f0, 0x226e8, 0x1e9d0, 0x40000000, 0x2f4, 0x226f0, 0x1e9e0, 0x40000000, 0x2f8, 0x226f8, 0x1e9f0, 0x40000000, 0x2fc
.long 0x21a00, 0x40000000, 0xc0, 0x300, 0x21a08, 0x40000010, 0xd0, 0x304, 0x21a10, 0x40000020, 0xe0, 0x308, 0x21a18, 0x40000030, 0xf0, 0x30c
.long 0x21a40, 0x40000040, 0x40000000, 0x310, 0x21a48, 0x40000050, 0x40000000, 0x314, 0x21a50, 0x40000060, 0x40000000, 0x318, 0x21a58, 0x40000070, 0x40000000, 0x31c
.long 0x21a80, 0x40000080, 0x40000000, 0x320, 0x21a88, 0x40000090, 0x40000000, 0x324, 0x21a90, 0x400000a0, 0x40000000, 0x328, 0x21a98, 0x400000b0, 0x40000000, 0x32c
.long 0x21ac0, 0x400000c0, 0x40000000, 0x330, 0x21ac8, 0x400000d0, 0x40000000, 0x334, 0x21ad0, 0x400000e0, 0x40000000, 0x338, 0x21ad8, 0x400000f0, 0x40000000, 0x33c
.long 0x21a20, 0x40000100, 0xc8, 0x340, 0x21a28, 0x40000110, 0xd8, 0x344, 0x21a30, 0x40000120, 0xe8, 0x348, 0x21a38, 0x40000130, 0xf8, 0x34c
.long 0x21a60, 0x40000140, 0x40000000, 0x350, 0x21a68, 0x40000150, 0x40000000, 0x354, 0x21a70, 0x40000160, 0x40000000, 0x358, 0x21a78, 0x40000170, 0x40000000, 0x35c
.long 0x21aa0, 0x40000180, 0x40000000, 0x360, 0x21aa8, 0x40000190, 0x40000000, 0x364, 0x21ab0, 0x400001a0, 0x40000000, 0x368, 0x21ab8, 0x400001b0, 0x40000000, 0x36c
.long 0x21ae0, 0x400001c0, 0x40000000, 0x370, 0x21ae8, 0x400001d0, 0x40000000, 0x374, 0x21af0, 0x400001e0, 0x40000000, 0x378, 0x21af8, 0x400001f0, 0x40000000, 0x37c
.long 0x22600, 0x40000000, 0x40000000, 0x380, 0x22608, 0x40000010, 0x40000000, 0x384, 0x22610, 0x40000020, 0x40000000, 0x388, 0x22618, 0x40000030, 0x40000000, 0x38c
.long 0x22640, 0x40000040, 0x40000000, 0x390, 0x22648, 0x40000050, 0x40000000, 0x394, 0x22650, 0x40000060, 0x40000000, 0x398, 0x22658, 0x40000070, 0x40000000, 0x39c
.long 0x22680, 0x40000080, 0x40000000, 0x3a0, 0x22688, 0x40000090, 0x40000000, 0x3a4, 0x22690, 0x400000a0, 0x40000000, 0x3a8, 0x22698, 0x400000b0, 0x40000000, 0x3ac
.long 0x226c0, 0x400000c0, 0x40000000, 0x3b0, 0x226c8, 0x400000d0, 0x40000000, 0x3b4, 0x226d0, 0x400000e0, 0x40000000, 0x3b8, 0x226d8, 0x400000f0, 0x40000000, 0x3bc
.long 0x22620, 0x40000100, 0x40000000, 0x3c0, 0x22628, 0x40000110, 0x40000000, 0x3c4, 0x22630, 0x40000120, 0x40000000, 0x3c8, 0x22638, 0x40000130, 0x40000000, 0x3cc
.long 0x22660, 0x40000140, 0x40000000, 0x3d0, 0x22668, 0x40000150, 0x40000000, 0x3d4, 0x22670, 0x40000160, 0x40000000, 0x3d8, 0x22678, 0x40000170, 0x40000000, 0x3dc
.long 0x226a0, 0x40000180, 0x40000000, 0x3e0, 0x226a8, 0x40000190, 0x40000000, 0x3e4, 0x226b0, 0x400001a0, 0x40000000, 0x3e8, 0x226b8, 0x400001b0, 0x40000000, 0x3ec
.long 0x226e0, 0x400001c0, 0x40000000, 0x3f0, 0x226e8, 0x400001d0, 0x40000000, 0x3f4, 0x226f0, 0x400001e0, 0x40000000, 0x3f8, 0x226f8, 0x400001f0, 0x40000000, 0x3fc
.long 0x0, 0x13200, 0x0, 0x0, 0x10, 0x13340, 0x10, 0x10, 0x20, 0x13480, 0x20, 0x20, 0x30, 0x135c0, 0x30, 0x30
.long 0x40, 0x13610, 0x40, 0x40, 0x50, 0x13750, 0x50, 0x50, 0x60, 0x13890, 0x60, 0x60, 0x70, 0x139d0, 0x70, 0x70
.long 0x80, 0x13a20, 0x80, 0x80, 0x90, 0x13b60, 0x90, 0x90, 0xa0, 0x13ca0, 0xa0, 0xa0, 0xb0, 0x13de0, 0xb0, 0xb0
.long 0xc0, 0x13e30, 0xc0, 0xc0, 0xd0, 0x13f70, 0xd0, 0xd0, 0xe0, 0x140b0, 0xe0, 0xe0, 0xf0, 0x141f0, 0xf0, 0xf0
.long 0x11000, 0x14200, 0x100, 0x100, 0x11010, 0x14340, 0x110, 0x110, 0x11020, 0x14480, 0x120, 0x120, 0x11030, 0x145c0, 0x130, 0x130
.long 0x11040, 0x14610, 0x140, 0x140, 0x11050, 0x14750, 0x40000000, 0x40000000, 0x11060, 0x14890, 0x40000000, 0x40000000, 0x11070, 0x149d0, 0x40000000, 0x40000000
.long 0x11080, 0x14a20, 0x40000000, 0x40000000, 0x11090, 0x14b60, 0x40000000, 0x40000000, 0x110a0, 0x14ca0, 0x40000000, 0x40000000, 0x110b0, 0x14de0, 0x40000000, 0x40000000
.long 0x110c0, 0x14e30, 0x40000000, 0x40000000, 0x110d0, 0x14f70, 0x40000000, 0x40000000, 0x110e0, 0x150b0, 0x40000000, 0x40000000, 0x110f0, 0x151f0, 0x40000000, 0x40000000
.long 0x200, 0x13240, 0x150, 0x150, 0x210, 0x13300, 0x160, 0x160, 0x220, 0x134c0, 0x170, 0x170, 0x230, 0x13580, 0x180, 0x180
.long 0x240, 0x13650, 0x190, 0x190, 0x250, 0x13710, 0x1a0, 0x1a0, 0x260, 0x138d0, 0x1b0, 0x1b0, 0x270, 0x13990, 0x1c0, 0x1c0
.long 0x280, 0x13a60, 0x1d0, 0x1d0, 0x290, 0x13b20, 0x1e0, 0x1e0, 0x2a0, 0x13ce0, 0x1f0, 0x1f0, 0x2b0, 0x13da0, 0x200, 0x200
.long 0x2c0, 0x13e70, 0x210, 0x210, 0x2d0, 0x13f30, 0x220, 0x220, 0x2e0, 0x140f0, 0x230, 0x230, 0x2f0, 0x141b0, 0x240, 0x240
.long 0x11200, 0x14240, 0x250, 0x250, 0x11210, 0x14300, 0x260, 0x260, 0x11220, 0x144c0, 0x270, 0x270, 0x11230, 0x14580, 0x280, 0x280
.long 0x11240, 0x14650, 0x290, 0x290, 0x11250, 0x14710, 0x40000000, 0x40000000, 0x11260, 0x148d0, 0x40000000, 0x40000000, 0x11270, 0x14990, 0x40000000, 0x40000000
.long 0x11280, 0x14a60, 0x40000000, 0x40000000, 0x11290, 0x14b20, 0x40000000, 0x40000000, 0x112a0, 0x14ce0, 0x40000000, 0x40000000, 0x112b0, 0x14da0, 0x40000000, 0x40000000
.long 0x112c0, 0x14e70, 0x40000000, 0x40000000, 0x112d0, 0x14f30, 0x40000000, 0x40000000, 0x112e0, 0x150f0, 0x40000000, 0x40000000, 0x112f0, 0x151b0, 0x40000000, 0x40000000
.long 0x0, 0x15200, 0x540, 0x40000000, 0x10, 0x15340, 0x550, 0x40000000, 0x20, 0x15480, 0x560, 0x40000000, 0x30, 0x155c0, 0x570, 0x40000000
.long 0x40, 0x15610, 0x580, 0x40000000, 0x50, 0x15750, 0x590, 0x40000000, 0x60, 0x15890, 0x5a0, 0x40000000, 0x70, 0x159d0, 0x5b0, 0x40000000
.long 0x80, 0x15a20, 0x5c0, 0x40000000, 0x90, 0x15b60, 0x5d0, 0x40000000, 0xa0, 0x15ca0, 0x5e0, 0x40000000, 0xb0, 0x15de0, 0x5f0, 0x40000000
.long 0xc0, 0x15e30, 0x600, 0x40000000, 0xd0, 0x15f70, 0x610, 0x40000000, 0xe0, 0x160b0, 0x620, 0x40000000, 0xf0, 0x161f0, 0x630, 0x40000000
.long 0x11000, 0x16200, 0x640, 0x40000000, 0x11010, 0x16340, 0x650, 0x40000000, 0x11020, 0x16480, 0x660, 0x40000000, 0x11030, 0x165c0, 0x670, 0x40000000
.long 0x11040, 0x16610, 0x680, 0x40000000, 0x11050, 0x16750, 0x40000000, 0x40000000, 0x11060, 0x16890, 0x40000000, 0x40000000, 0x11070, 0x169d0, 0x40000000, 0x40000000
.long 0x11080, 0x16a20, 0x40000000, 0x40000000, 0x11090, 0x16b60, 0x40000000, 0x40000000, 0x110a0, 0x16ca0, 0x40000000, 0x40000000, 0x110b0, 0x16de0, 0x40000000, 0x40000000
.long 0x110c0, 0x16e30, 0x40000000, 0x40000000, 0x110d0, 0x16f70, 0x40000000, 0x40000000, 0x110e0, 0x170b0, 0x40000000, 0x40000000, 0x110f0, 0x171f0, 0x40000000, 0x40000000
.long 0x200, 0x15240, 0x690, 0x40000000, 0x210, 0x15300, 0x6a0, 0x40000000, 0x220, 0x154c0, 0x6b0, 0x40000000, 0x230, 0x15580, 0x6c0, 0x40000000
.long 0x240, 0x15650, 0x6d0, 0x40000000, 0x250, 0x15710, 0x6e0, 0x40000000, 0x260, 0x158d0, 0x6f0, 0x40000000, 0x270, 0x15990, 0x700, 0x40000000
.long 0x280, 0x15a60, 0x710, 0x40000000, 0x290, 0x15b20, 0x720, 0x40000000, 0x2a0, 0x15ce0, 0x730, 0x40000000, 0x2b0, 0x15da0, 0x740, 0x40000000
.long 0x2c0, 0x15e70, 0x750, 0x40000000, 0x2d0, 0x15f30, 0x760, 0x40000000, 0x2e0, 0x160f0, 0x770, 0x40000000, 0x2f0, 0x161b0, 0x780, 0x40000000
.long 0x11200, 0x16240, 0x790, 0x40000000, 0x11210, 0x16300, 0x7a0, 0x40000000, 0x11220, 0x164c0, 0x7b0, 0x40000000, 0x11230, 0x16580, 0x7c0, 0x40000000
.long 0x11240, 0x16650, 0x7d0, 0x40000000, 0x11250, 0x16710, 0x40000000, 0x40000000, 0x11260, 0x168d0, 0x40000000, 0x40000000, 0x11270, 0x16990, 0x40000000, 0x40000000
.long 0x11280, 0x16a60, 0x40000000, 0x40000000, 0x11290, 0x16b20, 0x40000000, 0x40000000, 0x112a0, 0x16ce0, 0x40000000, 0x40000000, 0x112b0, 0x16da0, 0x40000000, 0x40000000
.long 0x112c0, 0x16e70, 0x40000000, 0x40000000, 0x112d0, 0x16f30, 0x40000000, 0x40000000, 0x112e0, 0x170f0, 0x40000000, 0x40000000, 0x112f0, 0x171b0, 0x40000000, 0x40000000
.long 0x0, 0x17200, 0x0, 0x0, 0x10, 0x17340, 0x10, 0x10, 0x20, 0x17480, 0x20, 0x20, 0x30, 0x175c0, 0x30, 0x30
.long 0x40, 0x17610, 0x40, 0x40, 0x50, 0x17750, 0x50, 0x50, 0x60, 0x17890, 0x60, 0x60, 0x70, 0x179d0, 0x70, 0x70
.long 0x80, 0x17a20, 0x80, 0x80, 0x90, 0x17b60, 0x90, 0x90, 0xa0, 0x17ca0, 0xa0, 0xa0, 0xb0, 0x17de0, 0xb0, 0xb0
.long 0xc0, 0x17e30, 0xc0, 0xc0, 0xd0, 0x17f70, 0xd0, 0xd0, 0xe0, 0x180b0, 0xe0, 0xe0, 0xf0, 0x181f0, 0xf0, 0xf0
.long 0x11000, 0x18200, 0x100, 0x100, 0x11010, 0x18340, 0x110, 0x110, 0x11020, 0x18480, 0x120, 0x120, 0x11030, 0x185c0, 0x130, 0x130
.long 0x11040, 0x18610, 0x140, 0x140, 0x11050, 0x18750, 0x40000000, 0x40000000, 0x11060, 0x18890, 0x40000000, 0x40000000, 0x11070, 0x189d0, 0x40000000, 0x40000000
.long 0x11080, 0x18a20, 0x40000000, 0x40000000, 0x11090, 0x18b60, 0x40000000, 0x40000000, 0x110a0, 0x18ca0, 0x40000000, 0x40000000, 0x110b0, 0x18de0, 0x40000000, 0x40000000
.long 0x110c0, 0x18e30, 0x40000000, 0x40000000, 0x110d0, 0x18f70, 0x40000000, 0x40000000, 0x110e0, 0x190b0, 0x40000000, 0x40000000, 0x110f0, 0x191f0, 0x40000000, 0x40000000
.long 0x200, 0x17240, 0x150, 0x150, 0x210, 0x17300, 0x160, 0x160, 0x220, 0x174c0, 0x170, 0x170, 0x230, 0x17580, 0x180, 0x180
.long 0x240, 0x17650, 0x190, 0x190, 0x250, 0x17710, 0x1a0, 0x1a0, 0x260, 0x178d0, 0x1b0, 0x1b0, 0x270, 0x17990, 0x1c0, 0x1c0
.long 0x280, 0x17a60, 0x1d0, 0x1d0, 0x290, 0x17b20, 0x1e0, 0x1e0, 0x2a0, 0x17ce0, 0x1f0, 0x1f0, 0x2b0, 0x17da0, 0x200, 0x200
.long 0x2c0, 0x17e70, 0x210, 0x210, 0x2d0, 0x17f30, 0x220, 0x220, 0x2e0, 0x180f0, 0x230, 0x230, 0x2f0, 0x181b0, 0x240, 0x240
.long 0x11200, 0x18240, 0x250, 0x250, 0x11210, 0x18300, 0x260, 0x260, 0x11220, 0x184c0, 0x270, 0x270, 0x11230, 0x18580, 0x280, 0x280
.long 0x11240, 0x18650, 0x290, 0x290, 0x11250, 0x18710, 0x40000000, 0x40000000, 0x11260, 0x188d0, 0x40000000, 0x40000000, 0x11270, 0x18990, 0x40000000, 0x40000000
.long 0x11280, 0x18a60, 0x40000000, 0x40000000, 0x11290, 0x18b20, 0x40000000, 0x40000000, 0x112a0, 0x18ce0, 0x40000000, 0x40000000, 0x112b0, 0x18da0, 0x40000000, 0x40000000
.long 0x112c0, 0x18e70, 0x40000000, 0x40000000, 0x112d0, 0x18f30, 0x40000000, 0x40000000, 0x112e0, 0x190f0, 0x40000000, 0x40000000, 0x112f0, 0x191b0, 0x40000000, 0x40000000
.long 0x0, 0x19200, 0x540, 0x40000000, 0x10, 0x19340, 0x550, 0x40000000, 0x20, 0x19480, 0x560, 0x40000000, 0x30, 0x195c0, 0x570, 0x40000000
.long 0x40, 0x19610, 0x580, 0x40000000, 0x50, 0x19750, 0x590, 0x40000000, 0x60, 0x19890, 0x5a0, 0x40000000, 0x70, 0x199d0, 0x5b0, 0x40000000
.long 0x80, 0x19a20, 0x5c0, 0x40000000, 0x90, 0x19b60, 0x5d0, 0x40000000, 0xa0, 0x19ca0, 0x5e0, 0x40000000, 0xb0, 0x19de0, 0x5f0, 0x40000000
.long 0xc0, 0x19e30, 0x600, 0x40000000, 0xd0, 0x19f70, 0x610, 0x40000000, 0xe0, 0x1a0b0, 0x620, 0x40000000, 0xf0, 0x1a1f0, 0x630, 0x40000000
.long 0x11000, 0x1a200, 0x640, 0x40000000, 0x11010, 0x1a340, 0x650, 0x40000000, 0x11020, 0x1a480, 0x660, 0x40000000, 0x11030, 0x1a5c0, 0x670, 0x40000000
.long 0x11040, 0x1a610, 0x680, 0x40000000, 0x11050, 0x1a750, 0x40000000, 0x40000000, 0x11060, 0x1a890, 0x40000000, 0x40000000, 0x11070, 0x1a9d0, 0x40000000, 0x40000000
.long 0x11080, 0x1aa20, 0x40000000, 0x40000000, 0x11090, 0x1ab60, 0x40000000, 0x40000000, 0x110a0, 0x1aca0, 0x40000000, 0x40000000, 0x110b0, 0x1ade0, 0x40000000, 0x40000000
.long 0x110c0, 0x1ae30, 0x40000000, 0x40000000, 0x110d0, 0x1af70, 0x40000000, 0x40000000, 0x110e0, 0x1b0b0, 0x40000000, 0x40000000, 0x110f0, 0x1b1f0, 0x40000000, 0x40000000
.long 0x200, 0x19240, 0x690, 0x40000000, 0x210, 0x19300, 0x6a0, 0x40000000, 0x220, 0x194c0, 0x6b0, 0x40000000, 0x230, 0x19580, 0x6c0, 0x40000000
.long 0x240, 0x19650, 0x6d0, 0x40000000, 0x250, 0x19710, 0x6e0, 0x40000000, 0x260, 0x198d0, 0x6f0, 0x40000000, 0x270, 0x19990, 0x700, 0x40000000
.long 0x280, 0x19a60, 0x710, 0x40000000, 0x290, 0x19b20, 0x720, 0x40000000, 0x2a0, 0x19ce0, 0x730, 0x40000000, 0x2b0, 0x19da0, 0x740, 0x40000000
.long 0x2c0, 0x19e70, 0x750, 0x40000000, 0x2d0, 0x19f30, 0x760, 0x40000000, 0x2e0, 0x1a0f0, 0x770, 0x40000000, 0x2f0, 0x1a1b0, 0x780, 0x40000000
.long 0x11200, 0x1a240, 0x790, 0x40000000, 0x11210, 0x1a300, 0x7a0, 0x40000000, 0x11220, 0x1a4c0, 0x7b0, 0x40000000, 0x11230, 0x1a580, 0x7c0, 0x40000000
.long 0x11240, 0x1a650, 0x7d0, 0x40000000, 0x11250, 0x1a710, 0x40000000, 0x40000000, 0x11260, 0x1a8d0, 0x40000000, 0x40000000, 0x11270, 0x1a990, 0x40000000, 0x40000000
.long 0x11280, 0x1aa60, 0x40000000, 0x40000000, 0x11290, 0x1ab20, 0x40000000, 0x40000000, 0x112a0, 0x1ace0, 0x40000000, 0x40000000, 0x112b0, 0x1ada0, 0x40000000, 0x40000000
.long 0x112c0, 0x1ae70, 0x40000000, 0x40000000, 0x112d0, 0x1af30, 0x40000000, 0x40000000, 0x112e0, 0x1b0f0, 0x40000000, 0x40000000, 0x112f0, 0x1b1b0, 0x40000000, 0x40000000
.long 0x0, 0x1d00, 0x0, 0x0, 0x10, 0x1d10, 0x8, 0x10, 0x20, 0x1d20, 0x10, 0x20, 0x30, 0x1d30, 0x18, 0x30
.long 0x40, 0x1d40, 0x20, 0x40, 0x50, 0x1d50, 0x28, 0x50, 0x60, 0x1d60, 0x30, 0x60, 0x70, 0x1d70, 0x38, 0x70
.long 0x80, 0x1d80, 0x40, 0x400, 0x90, 0x1d90, 0x48, 0x410, 0xa0, 0x1da0, 0x50, 0x40000000, 0xb0, 0x1db0, 0x58, 0x40000000
.long 0xc0, 0x1dc0, 0x60, 0x40000000, 0xd0, 0x1dd0, 0x68, 0x40000000, 0xe0, 0x1de0, 0x70, 0x40000000, 0xf0, 0x1df0, 0x78, 0x40000000
.long 0x300, 0x1d04, 0x80, 0x500, 0x310, 0x1d14, 0x88, 0x510, 0x320, 0x1d24, 0x90, 0x520, 0x330, 0x1d34, 0x98, 0x530
.long 0x340, 0x1d44, 0xa0, 0x540, 0x350, 0x1d54, 0xa8, 0x550, 0x360, 0x1d64, 0xb0, 0x560, 0x370, 0x1d74, 0xb8, 0x570
.long 0x380, 0x1d84, 0xc0, 0x900, 0x390, 0x1d94, 0xc8, 0x910, 0x3a0, 0x1da4, 0xd0, 0x40000000, 0x3b0, 0x1db4, 0xd8, 0x40000000
.long 0x3c0, 0x1dc4, 0xe0, 0x40000000, 0x3d0, 0x1dd4, 0xe8, 0x40000000, 0x3e0, 0x1de4, 0xf0, 0x40000000, 0x3f0, 0x1df4, 0xf8, 0x40000000
.long 0x600, 0x1d08, 0x100, 0xa00, 0x610, 0x1d18, 0x108, 0xa10, 0x620, 0x1d28, 0x110, 0xa20, 0x630, 0x1d38, 0x118, 0xa30
.long 0x640, 0x1d48, 0x120, 0xa40, 0x650, 0x1d58, 0x128, 0xa50, 0x660, 0x1d68, 0x130, 0xa60, 0x670, 0x1d78, 0x138, 0xa70
.long 0x680, 0x1d88, 0x140, 0xe00, 0x690, 0x1d98, 0x148, 0xe10, 0x6a0, 0x1da8, 0x150, 0x40000000, 0x6b0, 0x1db8, 0x158, 0x40000000
.long 0x6c0, 0x1dc8, 0x160, 0x40000000, 0x6d0, 0x1dd8, 0x168, 0x40000000, 0x6e0, 0x1de8, 0x170, 0x40000000, 0x6f0, 0x1df8, 0x178, 0x40000000
.long 0x900, 0x1d0c, 0x180, 0xf00, 0x910, 0x1d1c, 0x188, 0xf10, 0x920, 0x1d2c, 0x190, 0xf20, 0x930, 0x1d3c, 0x198, 0xf30
.long 0x940, 0x1d4c, 0x1a0, 0xf40, 0x950, 0x1d5c, 0x1a8, 0xf50, 0x960, 0x1d6c, 0x1b0, 0xf60, 0x970, 0x1d7c, 0x1b8, 0xf70
.long 0x980, 0x1d8c, 0x1c0, 0x1300, 0x990, 0x1d9c, 0x1c8, 0x1310, 0x9a0, 0x1dac, 0x1d0, 0x40000000, 0x9b0, 0x1dbc, 0x1d8, 0x40000000
.long 0x9c0, 0x1dcc, 0x1e0, 0x40000000, 0x9d0, 0x1ddc, 0x1e8, 0x40000000, 0x9e0, 0x1dec, 0x1f0, 0x40000000, 0x9f0, 0x1dfc, 0x1f8, 0x40000000
.long 0xc00, 0x2000, 0x200, 0x0, 0xc10, 0x2010, 0x208, 0x10, 0xc20, 0x2020, 0x210, 0x20, 0xc30, 0x2030, 0x218, 0x30
.long 0xc40, 0x2040, 0x220, 0x40, 0xc50, 0x2050, 0x228, 0x50, 0xc60, 0x2060, 0x230, 0x60, 0xc70, 0x2070, 0x238, 0x70
.long 0xc80, 0x2080, 0x240, 0x400, 0xc90, 0x2090, 0x248, 0x410, 0xca0, 0x20a0, 0x250, 0x40000000, 0xcb0, 0x20b0, 0x258, 0x40000000
.long 0xcc0, 0x20c0, 0x260, 0x40000000, 0xcd0, 0x20d0, 0x268, 0x40000000, 0xce0, 0x20e0, 0x270, 0x40000000, 0xcf0, 0x20f0, 0x278, 0x40000000
.long 0xf00, 0x2004, 0x280, 0x500, 0xf10, 0x2014, 0x288, 0x510, 0xf20, 0x2024, 0x290, 0x520, 0xf30, 0x2034, 0x298, 0x530
.long 0xf40, 0x2044, 0x2a0, 0x540, 0xf50, 0x2054, 0x2a8, 0x550, 0xf60, 0x2064, 0x2b0, 0x560, 0xf70, 0x2074, 0x2b8, 0x570
.long 0xf80, 0x2084, 0x2c0, 0x900, 0xf90, 0x2094, 0x2c8, 0x910, 0xfa0, 0x20a4, 0x2d0, 0x40000000, 0xfb0, 0x20b4, 0x2d8, 0x40000000
.long 0xfc0, 0x20c4, 0x2e0, 0x40000000, 0xfd0, 0x20d4, 0x2e8, 0x40000000, 0xfe0, 0x20e4, 0x2f0, 0x40000000, 0xff0, 0x20f4, 0x2f8, 0x40000000
.long 0x1200, 0x2008, 0x500, 0xa00, 0x1210, 0x2018, 0x500, 0xa10, 0x1220, 0x2028, 0x500, 0xa20, 0x1230, 0x2038, 0x500, 0xa30
.long 0x1240, 0x2048, 0x500, 0xa40, 0x1250, 0x2058, 0x500, 0xa50, 0x1260, 0x2068, 0x500, 0xa60, 0x1270, 0x2078, 0x500, 0xa70
.long 0x1280, 0x2088, 0x500, 0xe00, 0x1290, 0x2098, 0x500, 0xe10, 0x12a0, 0x20a8, 0x500, 0x40000000, 0x12b0, 0x20b8, 0x500, 0x40000000
.long 0x12c0, 0x20c8, 0x500, 0x40000000, 0x12d0, 0x20d8, 0x500, 0x40000000, 0x12e0, 0x20e8, 0x500, 0x40000000, 0x12f0, 0x20f8, 0x500, 0x40000000
.long 0x1500, 0x200c, 0x500, 0xf00, 0x1510, 0x201c, 0x500, 0xf10, 0x1520, 0x202c, 0x500, 0xf20, 0x1530, 0x203c, 0x500, 0xf30
.long 0x1540, 0x204c, 0x500, 0xf40, 0x1550, 0x205c, 0x500, 0xf50, 0x1560, 0x206c, 0x500, 0xf60, 0x1570, 0x207c, 0x500, 0xf70
.long 0x1580, 0x208c, 0x500, 0x1300, 0x1590, 0x209c, 0x500, 0x1310, 0x15a0, 0x20ac, 0x500, 0x40000000, 0x15b0, 0x20bc, 0x500, 0x40000000
.long 0x15c0, 0x20cc, 0x500, 0x40000000, 0x15d0, 0x20dc, 0x500, 0x40000000, 0x15e0, 0x20ec, 0x500, 0x40000000, 0x15f0, 0x20fc, 0x500, 0x40000000
.long 0x1800, 0x2300, 0x500, 0x0, 0x1810, 0x2310, 0x500, 0x10, 0x1820, 0x2320, 0x500, 0x20, 0x1830, 0x2330, 0x500, 0x30
.long 0x1840, 0x2340, 0x500, 0x40, 0x1850, 0x2350, 0x500, 0x50, 0x1860, 0x2360, 0x500, 0x60, 0x1870, 0x2370, 0x500, 0x70
.long 0x1880, 0x2380, 0x500, 0x400, 0x1890, 0x2390, 0x500, 0x410, 0x18a0, 0x23a0, 0x500, 0x40000000, 0x18b0, 0x23b0, 0x500, 0x40000000
.long 0x18c0, 0x23c0, 0x500, 0x40000000, 0x18d0, 0x23d0, 0x500, 0x40000000, 0x18e0, 0x23e0, 0x500, 0x40000000, 0x18f0, 0x23f0, 0x500, 0x40000000
.long 0x1b00, 0x2304, 0x500, 0x500, 0x1b10, 0x2314, 0x500, 0x510, 0x1b20, 0x2324, 0x500, 0x520, 0x1b30, 0x2334, 0x500, 0x530
.long 0x1b40, 0x2344, 0x500, 0x540, 0x1b50, 0x2354, 0x500, 0x550, 0x1b60, 0x2364, 0x500, 0x560, 0x1b70, 0x2374, 0x500, 0x570
.long 0x1b80, 0x2384, 0x500, 0x900, 0x1b90, 0x2394, 0x500, 0x910, 0x1ba0, 0x23a4, 0x500, 0x40000000, 0x1bb0, 0x23b4, 0x500, 0x40000000
.long 0x1bc0, 0x23c4, 0x500, 0x40000000, 0x1bd0, 0x23d4, 0x500, 0x40000000, 0x1be0, 0x23e4, 0x500, 0x40000000, 0x1bf0, 0x23f4, 0x500, 0x40000000
.long 0x1e00, 0x2308, 0x500, 0xa00, 0x1e10, 0x2318, 0x500, 0xa10, 0x1e20, 0x2328, 0x500, 0xa20, 0x1e30, 0x2338, 0x500, 0xa30
.long 0x1e40, 0x2348, 0x500, 0xa40, 0x1e50, 0x2358, 0x500, 0xa50, 0x1e60, 0x2368, 0x500, 0xa60, 0x1e70, 0x2378, 0x500, 0xa70
.long 0x1e80, 0x2388, 0x500, 0xe00, 0x1e90, 0x2398, 0x500, 0xe10, 0x1ea0, 0x23a8, 0x500, 0x40000000, 0x1eb0, 0x23b8, 0x500, 0x40000000
.long 0x1ec0, 0x23c8, 0x500, 0x40000000, 0x1ed0, 0x23d8, 0x500, 0x40000000, 0x1ee0, 0x23e8, 0x500, 0x40000000, 0x1ef0, 0x23f8, 0x500, 0x40000000
.long 0x2100, 0x230c, 0x500, 0xf00, 0x2110, 0x231c, 0x500, 0xf10, 0x2120, 0x232c, 0x500, 0xf20, 0x2130, 0x233c, 0x500, 0xf30
.long 0x2140, 0x234c, 0x500, 0xf40, 0x2150, 0x235c, 0x500, 0xf50, 0x2160, 0x236c, 0x500, 0xf60, 0x2170, 0x237c, 0x500, 0xf70
.long 0x2180, 0x238c, 0x500, 0x1300, 0x2190, 0x239c, 0x500, 0x1310, 0x21a0, 0x23ac, 0x500, 0x40000000, 0x21b0, 0x23bc, 0x500, 0x40000000
.long 0x21c0, 0x23cc, 0x500, 0x40000000, 0x21d0, 0x23dc, 0x500, 0x40000000, 0x21e0, 0x23ec, 0x500, 0x40000000, 0x21f0, 0x23fc, 0x500, 0x40000000
.long 0x2400, 0x2600, 0x500, 0x0, 0x2410, 0x2610, 0x500, 0x10, 0x2420, 0x2620, 0x500, 0x20, 0x2430, 0x2630, 0x500, 0x30
.long 0x2440, 0x2640, 0x500, 0x40, 0x2450, 0x2650, 0x500, 0x50, 0x2460, 0x2660, 0x500, 0x60, 0x2470, 0x2670, 0x500, 0x70
.long 0x2480, 0x2680, 0x500, 0x400, 0x2490, 0x2690, 0x500, 0x410, 0x24a0, 0x26a0, 0x500, 0x40000000, 0x24b0, 0x26b0, 0x500, 0x40000000
.long 0x24c0, 0x26c0, 0x500, 0x40000000, 0x24d0, 0x26d0, 0x500, 0x40000000, 0x24e0, 0x26e0, 0x500, 0x40000000, 0x24f0, 0x26f0, 0x500, 0x40000000
.long 0x2700, 0x2604, 0x500, 0x500, 0x2710, 0x2614, 0x500, 0x510, 0x2720, 0x2624, 0x500, 0x520, 0x2730, 0x2634, 0x500, 0x530
.long 0x2740, 0x2644, 0x500, 0x540, 0x2750, 0x2654, 0x500, 0x550, 0x2760, 0x2664, 0x500, 0x560, 0x2770, 0x2674, 0x500, 0x570
.long 0x2780, 0x2684, 0x500, 0x900, 0x2790, 0x2694, 0x500, 0x910, 0x27a0, 0x26a4, 0x500, 0x40000000, 0x27b0, 0x26b4, 0x500, 0x40000000
.long 0x27c0, 0x26c4, 0x500, 0x40000000, 0x27d0, 0x26d4, 0x500, 0x40000000, 0x27e0, 0x26e4, 0x500, 0x40000000, 0x27f0, 0x26f4, 0x500, 0x40000000
.long 0x2a00, 0x2608, 0x500, 0xa00, 0x2a10, 0x2618, 0x500, 0xa10, 0x2a20, 0x2628, 0x500, 0xa20, 0x2a30, 0x2638, 0x500, 0xa30
.long 0x2a40, 0x2648, 0x500, 0xa40, 0x2a50, 0x2658, 0x500, 0xa50, 0x2a60, 0x2668, 0x500, 0xa60, 0x2a70, 0x2678, 0x500, 0xa70
.long 0x2a80, 0x2688, 0x500, 0xe00, 0x2a90, 0x2698, 0x500, 0xe10, 0x2aa0, 0x26a8, 0x500, 0x40000000, 0x2ab0, 0x26b8, 0x500, 0x40000000
.long 0x2ac0, 0x26c8, 0x500, 0x40000000, 0x2ad0, 0x26d8, 0x500, 0x40000000, 0x2ae0, 0x26e8, 0x500, 0x40000000, 0x2af0, 0x26f8, 0x500, 0x40000000
.long 0x2d00, 0x260c, 0x500, 0xf00, 0x2d10, 0x261c, 0x500, 0xf10, 0x2d20, 0x262c, 0x500, 0xf20, 0x2d30, 0x263c, 0x500, 0xf30
.long 0x2d40, 0x264c, 0x500, 0xf40, 0x2d50, 0x265c, 0x500, 0xf50, 0x2d60, 0x266c, 0x500, 0xf60, 0x2d70, 0x267c, 0x500, 0xf70
.long 0x2d80, 0x268c, 0x500, 0x1300, 0x2d90, 0x269c, 0x500, 0x1310, 0x2da0, 0x26ac, 0x500, 0x40000000, 0x2db0, 0x26bc, 0x500, 0x40000000
.long 0x2dc0, 0x26cc, 0x500, 0x40000000, 0x2dd0, 0x26dc, 0x500, 0x40000000, 0x2de0, 0x26ec, 0x500, 0x40000000, 0x2df0, 0x26fc, 0x500, 0x40000000
.long 0x23200, 0x0, 0x1500, 0x0, 0x23220, 0x10, 0x1520, 0x10, 0x23240, 0x20, 0x1540, 0x20, 0x23260, 0x30, 0x1560, 0x30
.long 0x23300, 0x40, 0x1600, 0x40, 0x23320, 0x50, 0x1620, 0x50, 0x23340, 0x60, 0x1640, 0x60, 0x23360, 0x70, 0x1660, 0x70
.long 0x23400, 0x80, 0x1700, 0x80, 0x23420, 0x90, 0x1720, 0x90, 0x23440, 0xa0, 0x1740, 0xa0, 0x23460, 0xb0, 0x1760, 0xb0
.long 0x23500, 0xc0, 0x1800, 0xc0, 0x23520, 0xd0, 0x1820, 0xd0, 0x23540, 0xe0, 0x1840, 0xe0, 0x23560, 0xf0, 0x1860, 0xf0
.long 0x23a00, 0x100, 0x1508, 0x400, 0x23a20, 0x110, 0x1528, 0x410, 0x23a40, 0x120, 0x1548, 0x420, 0x23a60, 0x130, 0x1568, 0x430
.long 0x23b00, 0x140, 0x1608, 0x440, 0x23b20, 0x150, 0x1628, 0x450, 0x23b40, 0x160, 0x1648, 0x460, 0x23b60, 0x170, 0x1668, 0x470
.long 0x23c00, 0x180, 0x1708, 0x480, 0x23c20, 0x190, 0x1728, 0x490, 0x23c40, 0x1a0, 0x1748, 0x4a0, 0x23c60, 0x1b0, 0x1768, 0x4b0
.long 0x23d00, 0x1c0, 0x1808, 0x4c0, 0x23d20, 0x1d0, 0x1828, 0x4d0, 0x23d40, 0x1e0, 0x1848, 0x4e0, 0x23d60, 0x1f0, 0x1868, 0x4f0
.long 0x24200, 0x200, 0x1510, 0x800, 0x24220, 0x210, 0x1530, 0x810, 0x24240, 0x220, 0x1550, 0x820, 0x24260, 0x230, 0x1570, 0x830
.long 0x24300, 0x240, 0x1610, 0x840, 0x24320, 0x250, 0x1630, 0x850, 0x24340, 0x260, 0x1650, 0x860, 0x24360, 0x270, 0x1670, 0x870
.long 0x24400, 0x280, 0x1710, 0x880, 0x24420, 0x290, 0x1730, 0x890, 0x24440, 0x2a0, 0x1750, 0x8a0, 0x24460, 0x2b0, 0x1770, 0x8b0
.long 0x24500, 0x2c0, 0x1810, 0x8c0, 0x24520, 0x2d0, 0x1830, 0x8d0, 0x24540, 0x2e0, 0x1850, 0x8e0, 0x24560, 0x2f0, 0x1870, 0x8f0
.long 0x24a00, 0x300, 0x1518, 0xc00, 0x24a20, 0x310, 0x1538, 0xc10, 0x24a40, 0x320, 0x1558, 0xc20, 0x24a60, 0x330, 0x1578, 0xc30
.long 0x24b00, 0x340, 0x1618, 0xc40, 0x24b20, 0x350, 0x1638, 0xc50, 0x24b40, 0x360, 0x1658, 0xc60, 0x24b60, 0x370, 0x1678, 0xc70
.long 0x24c00, 0x380, 0x1718, 0xc80, 0x24c20, 0x390, 0x1738, 0xc90, 0x24c40, 0x3a0, 0x1758, 0xca0, 0x24c60, 0x3b0, 0x1778, 0xcb0
.long 0x24d00, 0x3c0, 0x1818, 0xcc0, 0x24d20, 0x3d0, 0x1838, 0xcd0, 0x24d40, 0x3e0, 0x1858, 0xce0, 0x24d60, 0x3f0, 0x1878, 0xcf0
.long 0x23218, 0xc00, 0x1580, 0x1000, 0x23238, 0xc10, 0x1588, 0x1010, 0x23258, 0xc20, 0x1590, 0x1020, 0x23278, 0xc30, 0x1598, 0x1030
.long 0x23318, 0xc40, 0x1680, 0x1040, 0x23338, 0xc50, 0x1688, 0x1050, 0x23358, 0xc60, 0x1690, 0x1060, 0x23378, 0xc70, 0x1698, 0x1070
.long 0x23418, 0xc80, 0x1780, 0x1080, 0x23438, 0xc90, 0x1788, 0x1090, 0x23458, 0xca0, 0x1790, 0x10a0, 0x23478, 0xcb0, 0x1798, 0x10b0
.long 0x23518, 0xcc0, 0x1880, 0x10c0, 0x23538, 0xcd0, 0x1888, 0x10d0, 0x23558, 0xce0, 0x1890, 0x10e0, 0x23578, 0xcf0, 0x1898, 0x10f0
.long 0x23a18, 0xd00, 0x1580, 0x40000000, 0x23a38, 0xd10, 0x1588, 0x40000000, 0x23a58, 0xd20, 0x1590, 0x40000000, 0x23a78, 0xd30, 0x1598, 0x40000000
.long 0x23b18, 0xd40, 0x1680, 0x40000000, 0x23b38, 0xd50, 0x1688, 0x40000000, 0x23b58, 0xd60, 0x1690, 0x40000000, 0x23b78, 0xd70, 0x1698, 0x40000000
.long 0x23c18, 0xd80, 0x1780, 0x40000000, 0x23c38, 0xd90, 0x1788, 0x40000000, 0x23c58, 0xda0, 0x1790, 0x40000000, 0x23c78, 0xdb0, 0x1798, 0x40000000
.long 0x23d18, 0xdc0, 0x1880, 0x40000000, 0x23d38, 0xdd0, 0x1888, 0x40000000, 0x23d58, 0xde0, 0x1890, 0x40000000, 0x23d78, 0xdf0, 0x1898, 0x40000000
.long 0x24218, 0xe00, 0x1580, 0x40000000, 0x24238, 0xe10, 0x1588, 0x40000000, 0x24258, 0xe20, 0x1590, 0x40000000, 0x24278, 0xe30, 0x1598, 0x40000000
.long 0x24318, 0xe40, 0x1680, 0x40000000, 0x24338, 0xe50, 0x1688, 0x40000000, 0x24358, 0xe60, 0x1690, 0x40000000, 0x24378, 0xe70, 0x1698, 0x40000000
.long 0x24418, 0xe80, 0x1780, 0x40000000, 0x24438, 0xe90, 0x1788, 0x40000000, 0x24458, 0xea0, 0x1790, 0x40000000, 0x24478, 0xeb0, 0x1798, 0x40000000
.long 0x24518, 0xec0, 0x1880, 0x40000000, 0x24538, 0xed0, 0x1888, 0x40000000, 0x24558, 0xee0, 0x1890, 0x40000000, 0x24578, 0xef0, 0x1898, 0x40000000
.long 0x24a18, 0xf00, 0x1580, 0x40000000, 0x24a38, 0xf10, 0x1588, 0x40000000, 0x24a58, 0xf20, 0x1590, 0x40000000, 0x24a78, 0xf30, 0x1598, 0x40000000
.long 0x24b18, 0xf40, 0x1680, 0x40000000, 0x24b38, 0xf50, 0x1688, 0x40000000, 0x24b58, 0xf60, 0x1690, 0x40000000, 0x24b78, 0xf70, 0x1698, 0x40000000
.long 0x24c18, 0xf80, 0x1780, 0x40000000, 0x24c38, 0xf90, 0x1788, 0x40000000, 0x24c58, 0xfa0, 0x1790, 0x40000000, 0x24c78, 0xfb0, 0x1798, 0x40000000
.long 0x24d18, 0xfc0, 0x1880, 0x40000000, 0x24d38, 0xfd0, 0x1888, 0x40000000, 0x24d58, 0xfe0, 0x1890, 0x40000000, 0x24d78, 0xff0, 0x1898, 0x40000000
.long 0x25200, 0x2000, 0x1580, 0x40000000, 0x25220, 0x2010, 0x1588, 0x40000000, 0x25240, 0x2020, 0x1590, 0x40000000, 0x25260, 0x2030, 0x1598, 0x40000000
.long 0x25300, 0x2040, 0x1680, 0x40000000, 0x25320, 0x2050, 0x1688, 0x40000000, 0x25340, 0x2060, 0x1690, 0x40000000, 0x25360, 0x2070, 0x1698, 0x40000000
.long 0x25400, 0x2080, 0x1780, 0x40000000, 0x25420, 0x2090, 0x1788, 0x40000000, 0x25440, 0x20a0, 0x1790, 0x40000000, 0x25460, 0x20b0, 0x1798, 0x40000000
.long 0x25500, 0x20c0, 0x1880, 0x40000000, 0x25520, 0x20d0, 0x1888, 0x40000000, 0x25540, 0x20e0, 0x1890, 0x40000000, 0x25560, 0x20f0, 0x1898, 0x40000000
.long 0x25a00, 0x2100, 0x1580, 0x40000000, 0x25a20, 0x2110, 0x1588, 0x40000000, 0x25a40, 0x2120, 0x1590, 0x40000000, 0x25a60, 0x2130, 0x1598, 0x40000000
.long 0x25b00, 0x2140, 0x1680, 0x40000000, 0x25b20, 0x2150, 0x1688, 0x40000000, 0x25b40, 0x2160, 0x1690, 0x40000000, 0x25b60, 0x2170, 0x1698, 0x40000000
.long 0x25c00, 0x2180, 0x1780, 0x40000000, 0x25c20, 0x2190, 0x1788, 0x40000000, 0x25c40, 0x21a0, 0x1790, 0x40000000, 0x25c60, 0x21b0, 0x1798, 0x40000000
.long 0x25d00, 0x21c0, 0x1880, 0x40000000, 0x25d20, 0x21d0, 0x1888, 0x40000000, 0x25d40, 0x21e0, 0x1890, 0x40000000, 0x25d60, 0x21f0, 0x1898, 0x40000000
.long 0x26200, 0x2200, 0x1580, 0x40000000, 0x26220, 0x2210, 0x1588, 0x40000000, 0x26240, 0x2220, 0x1590, 0x40000000, 0x26260, 0x2230, 0x1598, 0x40000000
.long 0x26300, 0x2240, 0x1680, 0x40000000, 0x26320, 0x2250, 0x1688, 0x40000000, 0x26340, 0x2260, 0x1690, 0x40000000, 0x26360, 0x2270, 0x1698, 0x40000000
.long 0x26400, 0x2280, 0x1780, 0x40000000, 0x26420, 0x2290, 0x1788, 0x40000000, 0x26440, 0x22a0, 0x1790, 0x40000000, 0x26460, 0x22b0, 0x1798, 0x40000000
.long 0x26500, 0x22c0, 0x1880, 0x40000000, 0x26520, 0x22d0, 0x1888, 0x40000000, 0x26540, 0x22e0, 0x1890, 0x40000000, 0x26560, 0x22f0, 0x1898, 0x40000000
.long 0x26a00, 0x2300, 0x1580, 0x40000000, 0x26a20, 0x2310, 0x1588, 0x40000000, 0x26a40, 0x2320, 0x1590, 0x40000000, 0x26a60, 0x2330, 0x1598, 0x40000000
.long 0x26b00, 0x2340, 0x1680, 0x40000000, 0x26b20, 0x2350, 0x1688, 0x40000000, 0x26b40, 0x2360, 0x1690, 0x40000000, 0x26b60, 0x2370, 0x1698, 0x40000000
.long 0x26c00, 0x2380, 0x1780, 0x40000000, 0x26c20, 0x2390, 0x1788, 0x40000000, 0x26c40, 0x23a0, 0x1790, 0x40000000, 0x26c60, 0x23b0, 0x1798, 0x40000000
.long 0x26d00, 0x23c0, 0x1880, 0x40000000, 0x26d20, 0x23d0, 0x1888, 0x40000000, 0x26d40, 0x23e0, 0x1890, 0x40000000, 0x26d60, 0x23f0, 0x1898, 0x40000000
.long 0x25218, 0x2c00, 0x1580, 0x40000000, 0x25238, 0x2c10, 0x1588, 0x40000000, 0x25258, 0x2c20, 0x1590, 0x40000000, 0x25278, 0x2c30, 0x1598, 0x40000000
.long 0x25318, 0x2c40, 0x1680, 0x40000000, 0x25338, 0x2c50, 0x1688, 0x40000000, 0x25358, 0x2c60, 0x1690, 0x40000000, 0x25378, 0x2c70, 0x1698, 0x40000000
.long 0x25418, 0x2c80, 0x1780, 0x40000000, 0x25438, 0x2c90, 0x1788, 0x40000000, 0x25458, 0x2ca0, 0x1790, 0x40000000, 0x25478, 0x2cb0, 0x1798, 0x40000000
.long 0x25518, 0x2cc0, 0x1880, 0x40000000, 0x25538, 0x2cd0, 0x1888, 0x40000000, 0x25558, 0x2ce0, 0x1890, 0x40000000, 0x25578, 0x2cf0, 0x1898, 0x40000000
.long 0x25a18, 0x2d00, 0x1580, 0x40000000, 0x25a38, 0x2d10, 0x1588, 0x40000000, 0x25a58, 0x2d20, 0x1590, 0x40000000, 0x25a78, 0x2d30, 0x1598, 0x40000000
.long 0x25b18, 0x2d40, 0x1680, 0x40000000, 0x25b38, 0x2d50, 0x1688, 0x40000000, 0x25b58, 0x2d60, 0x1690, 0x40000000, 0x25b78, 0x2d70, 0x1698, 0x40000000
.long 0x25c18, 0x2d80, 0x1780, 0x40000000, 0x25c38, 0x2d90, 0x1788, 0x40000000, 0x25c58, 0x2da0, 0x1790, 0x40000000, 0x25c78, 0x2db0, 0x1798, 0x40000000
.long 0x25d18, 0x2dc0, 0x1880, 0x40000000, 0x25d38, 0x2dd0, 0x1888, 0x40000000, 0x25d58, 0x2de0, 0x1890, 0x40000000, 0x25d78, 0x2df0, 0x1898, 0x40000000
.long 0x26218, 0x2e00, 0x1580, 0x40000000, 0x26238, 0x2e10, 0x1588, 0x40000000, 0x26258, 0x2e20, 0x1590, 0x40000000, 0x26278, 0x2e30, 0x1598, 0x40000000
.long 0x26318, 0x2e40, 0x1680, 0x40000000, 0x26338, 0x2e50, 0x1688, 0x40000000, 0x26358, 0x2e60, 0x1690, 0x40000000, 0x26378, 0x2e70, 0x1698, 0x40000000
.long 0x26418, 0x2e80, 0x1780, 0x40000000, 0x26438, 0x2e90, 0x1788, 0x40000000, 0x26458, 0x2ea0, 0x1790, 0x40000000, 0x26478, 0x2eb0, 0x1798, 0x40000000
.long 0x26518, 0x2ec0, 0x1880, 0x40000000, 0x26538, 0x2ed0, 0x1888, 0x40000000, 0x26558, 0x2ee0, 0x1890, 0x40000000, 0x26578, 0x2ef0, 0x1898, 0x40000000
.long 0x26a18, 0x2f00, 0x1580, 0x40000000, 0x26a38, 0x2f10, 0x1588, 0x40000000, 0x26a58, 0x2f20, 0x1590, 0x40000000, 0x26a78, 0x2f30, 0x1598, 0x40000000
.long 0x26b18, 0x2f40, 0x1680, 0x40000000, 0x26b38, 0x2f50, 0x1688, 0x40000000, 0x26b58, 0x2f60, 0x1690, 0x40000000, 0x26b78, 0x2f70, 0x1698, 0x40000000
.long 0x26c18, 0x2f80, 0x1780, 0x40000000, 0x26c38, 0x2f90, 0x1788, 0x40000000, 0x26c58, 0x2fa0, 0x1790, 0x40000000, 0x26c78, 0x2fb0, 0x1798, 0x40000000
.long 0x26d18, 0x2fc0, 0x1880, 0x40000000, 0x26d38, 0x2fd0, 0x1888, 0x40000000, 0x26d58, 0x2fe0, 0x1890, 0x40000000, 0x26d78, 0x2ff0, 0x1898, 0x40000000
.long 0x13200, 0x13610, 0x13290, 0x13680, 0x13210, 0x13600, 0x13298, 0x13688, 0x13208, 0x13618, 0x132a0, 0x136b0, 0x13218, 0x13608, 0x132a8, 0x136b8
.long 0x13340, 0x13750, 0x133d0, 0x137c0, 0x13350, 0x13740, 0x133d8, 0x137c8, 0x13348, 0x13758, 0x133e0, 0x137f0, 0x13358, 0x13748, 0x133e8, 0x137f8
.long 0x13480, 0x13890, 0x13410, 0x13800, 0x13490, 0x13880, 0x13418, 0x13808, 0x13488, 0x13898, 0x13420, 0x13830, 0x13498, 0x13888, 0x13428, 0x13838
.long 0x135c0, 0x139d0, 0x13550, 0x13940, 0x135d0, 0x139c0, 0x13558, 0x13948, 0x135c8, 0x139d8, 0x13560, 0x13970, 0x135d8, 0x139c8, 0x13568, 0x13978
.long 0x13220, 0x13630, 0x132b0, 0x136a0, 0x13230, 0x13620, 0x132b8, 0x136a8, 0x13228, 0x13638, 0x13280, 0x13690, 0x13238, 0x13628, 0x13288, 0x13698
.long 0x13360, 0x13770, 0x133f0, 0x137e0, 0x13370, 0x13760, 0x133f8, 0x137e8, 0x13368, 0x13778, 0x133c0, 0x137d0, 0x13378, 0x13768, 0x133c8, 0x137d8
.long 0x134a0, 0x138b0, 0x13430, 0x13820, 0x134b0, 0x138a0, 0x13438, 0x13828, 0x134a8, 0x138b8, 0x13400, 0x13810, 0x134b8, 0x138a8, 0x13408, 0x13818
.long 0x135e0, 0x139f0, 0x13570, 0x13960, 0x135f0, 0x139e0, 0x13578, 0x13968, 0x135e8, 0x139f8, 0x13540, 0x13950, 0x135f8, 0x139e8, 0x13548, 0x13958
.long 0x13a20, 0x13e30, 0x13ab0, 0x13ea0, 0x13a30, 0x13e20, 0x13ab8, 0x13ea8, 0x13a28, 0x13e38, 0x13a80, 0x13e90, 0x13a38, 0x13e28, 0x13a88, 0x13e98
.long 0x13b60, 0x13f70, 0x13bf0, 0x13fe0, 0x13b70, 0x13f60, 0x13bf8, 0x13fe8, 0x13b68, 0x13f78, 0x13bc0, 0x13fd0, 0x13b78, 0x13f68, 0x13bc8, 0x13fd8
.long 0x13ca0, 0x140b0, 0x13c30, 0x14020, 0x13cb0, 0x140a0, 0x13c38, 0x14028, 0x13ca8, 0x140b8, 0x13c00, 0x14010, 0x13cb8, 0x140a8, 0x13c08, 0x14018
.long 0x13de0, 0x141f0, 0x13d70, 0x14160, 0x13df0, 0x141e0, 0x13d78, 0x14168, 0x13de8, 0x141f8, 0x13d40, 0x14150, 0x13df8, 0x141e8, 0x13d48, 0x14158
.long 0x13a00, 0x13e10, 0x13a90, 0x13e80, 0x13a10, 0x13e00, 0x13a98, 0x13e88, 0x13a08, 0x13e18, 0x13aa0, 0x13eb0, 0x13a18, 0x13e08, 0x13aa8, 0x13eb8
.long 0x13b40, 0x13f50, 0x13bd0, 0x13fc0, 0x13b50, 0x13f40, 0x13bd8, 0x13fc8, 0x13b48, 0x13f58, 0x13be0, 0x13ff0, 0x13b58, 0x13f48, 0x13be8, 0x13ff8
.long 0x13c80, 0x14090, 0x13c10, 0x14000, 0x13c90, 0x14080, 0x13c18, 0x14008, 0x13c88, 0x14098, 0x13c20, 0x14030, 0x13c98, 0x14088, 0x13c28, 0x14038
.long 0x13dc0, 0x141d0, 0x13d50, 0x14140, 0x13dd0, 0x141c0, 0x13d58, 0x14148, 0x13dc8, 0x141d8, 0x13d60, 0x14170, 0x13dd8, 0x141c8, 0x13d68, 0x14178
.long 0x13280, 0x13690, 0x13290, 0x13680, 0x13288, 0x13698, 0x13298, 0x13688, 0x13290, 0x13680, 0x132a0, 0x136b0, 0x13298, 0x13688, 0x132a8, 0x136b8
.long 0x133c0, 0x137d0, 0x133d0, 0x137c0, 0x133c8, 0x137d8, 0x133d8, 0x137c8, 0x133d0, 0x137c0, 0x133e0, 0x137f0, 0x133d8, 0x137c8, 0x133e8, 0x137f8
.long 0x13400, 0x13810, 0x13410, 0x13800, 0x13408, 0x13818, 0x13418, 0x13808, 0x13410, 0x13800, 0x13420, 0x13830, 0x13418, 0x13808, 0x13428, 0x13838
.long 0x13540, 0x13950, 0x13550, 0x13940, 0x13548, 0x13958, 0x13558, 0x13948, 0x13550, 0x13940, 0x13560, 0x13970, 0x13558, 0x13948, 0x13568, 0x13978
.long 0x132a0, 0x136b0, 0x132b0, 0x136a0, 0x132a8, 0x136b8, 0x132b8, 0x136a8, 0x132b0, 0x136a0, 0x13280, 0x13690, 0x132b8, 0x136a8, 0x13288, 0x13698
.long 0x133e0, 0x137f0, 0x133f0, 0x137e0, 0x133e8, 0x137f8, 0x133f8, 0x137e8, 0x133f0, 0x137e0, 0x133c0, 0x137d0, 0x133f8, 0x137e8, 0x133c8, 0x137d8
.long 0x13420, 0x13830, 0x13430, 0x13820, 0x13428, 0x13838, 0x13438, 0x13828, 0x13430, 0x13820, 0x13400, 0x13810, 0x13438, 0x13828, 0x13408, 0x13818
.long 0x13560, 0x13970, 0x13570, 0x13960, 0x13568, 0x13978, 0x13578, 0x13968, 0x13570, 0x13960, 0x13540, 0x13950, 0x13578, 0x13968, 0x13548, 0x13958
.long 0x13aa0, 0x13eb0, 0x13ab0, 0x13ea0, 0x13aa8, 0x13eb8, 0x13ab8, 0x13ea8, 0x13ab0, 0x13ea0, 0x13a80, 0x13e90, 0x13ab8, 0x13ea8, 0x13a88, 0x13e98
.long 0x13be0, 0x13ff0, 0x13bf0, 0x13fe0, 0x13be8, 0x13ff8, 0x13bf8, 0x13fe8, 0x13bf0, 0x13fe0, 0x13bc0, 0x13fd0, 0x13bf8, 0x13fe8, 0x13bc8, 0x13fd8
.long 0x13c20, 0x14030, 0x13c30, 0x14020, 0x13c28, 0x14038, 0x13c38, 0x14028, 0x13c30, 0x14020, 0x13c00, 0x14010, 0x13c38, 0x14028, 0x13c08, 0x14018
.long 0x13d60, 0x14170, 0x13d70, 0x14160, 0x13d68, 0x14178, 0x13d78, 0x14168, 0x13d70, 0x14160, 0x13d40, 0x14150, 0x13d78, 0x14168, 0x13d48, 0x14158
.long 0x13a80, 0x13e90, 0x13a90, 0x13e80, 0x13a88, 0x13e98, 0x13a98, 0x13e88, 0x13a90, 0x13e80, 0x13aa0, 0x13eb0, 0x13a98, 0x13e88, 0x13aa8, 0x13eb8
.long 0x13bc0, 0x13fd0, 0x13bd0, 0x13fc0, 0x13bc8, 0x13fd8, 0x13bd8, 0x13fc8, 0x13bd0, 0x13fc0, 0x13be0, 0x13ff0, 0x13bd8, 0x13fc8, 0x13be8, 0x13ff8
.long 0x13c00, 0x14010, 0x13c10, 0x14000, 0x13c08, 0x14018, 0x13c18, 0x14008, 0x13c10, 0x14000, 0x13c20, 0x14030, 0x13c18, 0x14008, 0x13c28, 0x14038
.long 0x13d40, 0x14150, 0x13d50, 0x14140, 0x13d48, 0x14158, 0x13d58, 0x14148, 0x13d50, 0x14140, 0x13d60, 0x14170, 0x13d58, 0x14148, 0x13d68, 0x14178
.long 0x13240, 0x13650, 0x132d0, 0x136c0, 0x13250, 0x13640, 0x132d8, 0x136c8, 0x13248, 0x13658, 0x132e0, 0x136f0, 0x13258, 0x13648, 0x132e8, 0x136f8
.long 0x13300, 0x13710, 0x13390, 0x13780, 0x13310, 0x13700, 0x13398, 0x13788, 0x13308, 0x13718, 0x133a0, 0x137b0, 0x13318, 0x13708, 0x133a8, 0x137b8
.long 0x134c0, 0x138d0, 0x13450, 0x13840, 0x134d0, 0x138c0, 0x13458, 0x13848, 0x134c8, 0x138d8, 0x13460, 0x13870, 0x134d8, 0x138c8, 0x13468, 0x13878
.long 0x13580, 0x13990, 0x13510, 0x13900, 0x13590, 0x13980, 0x13518, 0x13908, 0x13588, 0x13998, 0x13520, 0x13930, 0x13598, 0x13988, 0x13528, 0x13938
.long 0x13260, 0x13670, 0x132f0, 0x136e0, 0x13270, 0x13660, 0x132f8, 0x136e8, 0x13268, 0x13678, 0x132c0, 0x136d0, 0x13278, 0x13668, 0x132c8, 0x136d8
.long 0x13320, 0x13730, 0x133b0, 0x137a0, 0x13330, 0x13720, 0x133b8, 0x137a8, 0x13328, 0x13738, 0x13380, 0x13790, 0x13338, 0x13728, 0x13388, 0x13798
.long 0x134e0, 0x138f0, 0x13470, 0x13860, 0x134f0, 0x138e0, 0x13478, 0x13868, 0x134e8, 0x138f8, 0x13440, 0x13850, 0x134f8, 0x138e8, 0x13448, 0x13858
.long 0x135a0, 0x139b0, 0x13530, 0x13920, 0x135b0, 0x139a0, 0x13538, 0x13928, 0x135a8, 0x139b8, 0x13500, 0x13910, 0x135b8, 0x139a8, 0x13508, 0x13918
.long 0x13a60, 0x13e70, 0x13af0, 0x13ee0, 0x13a70, 0x13e60, 0x13af8, 0x13ee8, 0x13a68, 0x13e78, 0x13ac0, 0x13ed0, 0x13a78, 0x13e68, 0x13ac8, 0x13ed8
.long 0x13b20, 0x13f30, 0x13bb0, 0x13fa0, 0x13b30, 0x13f20, 0x13bb8, 0x13fa8, 0x13b28, 0x13f38, 0x13b80, 0x13f90, 0x13b38, 0x13f28, 0x13b88, 0x13f98
.long 0x13ce0, 0x140f0, 0x13c70, 0x14060, 0x13cf0, 0x140e0, 0x13c78, 0x14068, 0x13ce8, 0x140f8, 0x13c40, 0x14050, 0x13cf8, 0x140e8, 0x13c48, 0x14058
.long 0x13da0, 0x141b0, 0x13d30, 0x14120, 0x13db0, 0x141a0, 0x13d38, 0x14128, 0x13da8, 0x141b8, 0x13d00, 0x14110, 0x13db8, 0x141a8, 0x13d08, 0x14118
.long 0x13a40, 0x13e50, 0x13ad0, 0x13ec0, 0x13a50, 0x13e40, 0x13ad8, 0x13ec8, 0x13a48, 0x13e58, 0x13ae0, 0x13ef0, 0x13a58, 0x13e48, 0x13ae8, 0x13ef8
.long 0x13b00, 0x13f10, 0x13b90, 0x13f80, 0x13b10, 0x13f00, 0x13b98, 0x13f88, 0x13b08, 0x13f18, 0x13ba0, 0x13fb0, 0x13b18, 0x13f08, 0x13ba8, 0x13fb8
.long 0x13cc0, 0x140d0, 0x13c50, 0x14040, 0x13cd0, 0x140c0, 0x13c58, 0x14048, 0x13cc8, 0x140d8, 0x13c60, 0x14070, 0x13cd8, 0x140c8, 0x13c68, 0x14078
.long 0x13d80, 0x14190, 0x13d10, 0x14100, 0x13d90, 0x14180, 0x13d18, 0x14108, 0x13d88, 0x14198, 0x13d20, 0x14130, 0x13d98, 0x14188, 0x13d28, 0x14138
.long 0x132c0, 0x136d0, 0x132d0, 0x136c0, 0x132c8, 0x136d8, 0x132d8, 0x136c8, 0x132d0, 0x136c0, 0x132e0, 0x136f0, 0x132d8, 0x136c8, 0x132e8, 0x136f8
.long 0x13380, 0x13790, 0x13390, 0x13780, 0x13388, 0x13798, 0x13398, 0x13788, 0x13390, 0x13780, 0x133a0, 0x137b0, 0x13398, 0x13788, 0x133a8, 0x137b8
.long 0x13440, 0x13850, 0x13450, 0x13840, 0x13448, 0x13858, 0x13458, 0x13848, 0x13450, 0x13840, 0x13460, 0x13870, 0x13458, 0x13848, 0x13468, 0x13878
.long 0x13500, 0x13910, 0x13510, 0x13900, 0x13508, 0x13918, 0x13518, 0x13908, 0x13510, 0x13900, 0x13520, 0x13930, 0x13518, 0x13908, 0x13528, 0x13938
.long 0x132e0, 0x136f0, 0x132f0, 0x136e0, 0x132e8, 0x136f8, 0x132f8, 0x136e8, 0x132f0, 0x136e0, 0x132c0, 0x136d0, 0x132f8, 0x136e8, 0x132c8, 0x136d8
.long 0x133a0, 0x137b0, 0x133b0, 0x137a0, 0x133a8, 0x137b8, 0x133b8, 0x137a8, 0x133b0, 0x137a0, 0x13380, 0x13790, 0x133b8, 0x137a8, 0x13388, 0x13798
.long 0x13460, 0x13870, 0x13470, 0x13860, 0x13468, 0x13878, 0x13478, 0x13868, 0x13470, 0x13860, 0x13440, 0x13850, 0x13478, 0x13868, 0x13448, 0x13858
.long 0x13520, 0x13930, 0x13530, 0x13920, 0x13528, 0x13938, 0x13538, 0x13928, 0x13530, 0x13920, 0x13500, 0x13910, 0x13538, 0x13928, 0x13508, 0x13918
.long 0x13ae0, 0x13ef0, 0x13af0, 0x13ee0, 0x13ae8, 0x13ef8, 0x13af8, 0x13ee8, 0x13af0, 0x13ee0, 0x13ac0, 0x13ed0, 0x13af8, 0x13ee8, 0x13ac8, 0x13ed8
.long 0x13ba0, 0x13fb0, 0x13bb0, 0x13fa0, 0x13ba8, 0x13fb8, 0x13bb8, 0x13fa8, 0x13bb0, 0x13fa0, 0x13b80, 0x13f90, 0x13bb8, 0x13fa8, 0x13b88, 0x13f98
.long 0x13c60, 0x14070, 0x13c70, 0x14060, 0x13c68, 0x14078, 0x13c78, 0x14068, 0x13c70, 0x14060, 0x13c40, 0x14050, 0x13c78, 0x14068, 0x13c48, 0x14058
.long 0x13d20, 0x14130, 0x13d30, 0x14120, 0x13d28, 0x14138, 0x13d38, 0x14128, 0x13d30, 0x14120, 0x13d00, 0x14110, 0x13d38, 0x14128, 0x13d08, 0x14118
.long 0x13ac0, 0x13ed0, 0x13ad0, 0x13ec0, 0x13ac8, 0x13ed8, 0x13ad8, 0x13ec8, 0x13ad0, 0x13ec0, 0x13ae0, 0x13ef0, 0x13ad8, 0x13ec8, 0x13ae8, 0x13ef8
.long 0x13b80, 0x13f90, 0x13b90, 0x13f80, 0x13b88, 0x13f98, 0x13b98, 0x13f88, 0x13b90, 0x13f80, 0x13ba0, 0x13fb0, 0x13b98, 0x13f88, 0x13ba8, 0x13fb8
.long 0x13c40, 0x14050, 0x13c50, 0x14040, 0x13c48, 0x14058, 0x13c58, 0x14048, 0x13c50, 0x14040, 0x13c60, 0x14070, 0x13c58, 0x14048, 0x13c68, 0x14078
.long 0x13d00, 0x14110, 0x13d10, 0x14100, 0x13d08, 0x14118, 0x13d18, 0x14108, 0x13d10, 0x14100, 0x13d20, 0x14130, 0x13d18, 0x14108, 0x13d28, 0x14138
.long 0x1d00, 0x0, 0x1d00, 0x2300, 0x1d60, 0x10, 0x1d60, 0x2360, 0x1dc0, 0x20, 0x1dc0, 0x23c0, 0x1e20, 0x30, 0x1e20, 0x2420
.long 0x1e80, 0x40, 0x800, 0x800, 0x1ee0, 0x50, 0x800, 0x800, 0x1f40, 0x60, 0x800, 0x800, 0x1fa0, 0x70, 0x800, 0x800
.long 0x2000, 0x80, 0x1e80, 0x2480, 0x2060, 0x90, 0x1ee0, 0x800, 0x20c0, 0xa0, 0x1f40, 0x800, 0x2120, 0xb0, 0x1fa0, 0x800
.long 0x2180, 0xc0, 0x800, 0x800, 0x21e0, 0xd0, 0x800, 0x800, 0x2240, 0xe0, 0x800, 0x800, 0x22a0, 0xf0, 0x800, 0x800
.long 0x2300, 0x100, 0x2000, 0x800, 0x2360, 0x110, 0x2060, 0x800, 0x23c0, 0x120, 0x20c0, 0x800, 0x2420, 0x130, 0x2120, 0x800
.long 0x2480, 0x140, 0x800, 0x800, 0x1d10, 0x150, 0x800, 0x800, 0x1d70, 0x160, 0x800, 0x800, 0x1dd0, 0x170, 0x800, 0x800
.long 0x1e30, 0x180, 0x2180, 0x800, 0x1e90, 0x190, 0x21e0, 0x800, 0x1ef0, 0x1a0, 0x2240, 0x800, 0x1f50, 0x1b0, 0x22a0, 0x800
.long 0x1fb0, 0x1c0, 0x800, 0x800, 0x2010, 0x1d0, 0x800, 0x800, 0x2070, 0x1e0, 0x800, 0x800, 0x20d0, 0x1f0, 0x800, 0x800
.long 0x2130, 0x200, 0x800, 0x800, 0x2190, 0x210, 0x800, 0x800, 0x21f0, 0x220, 0x800, 0x800, 0x2250, 0x230, 0x800, 0x800
.long 0x22b0, 0x240, 0x24e0, 0x2ae0, 0x2310, 0x250, 0x2540, 0x2b40, 0x2370, 0x260, 0x25a0, 0x2ba0, 0x23d0, 0x270, 0x2600, 0x2c00
.long 0x2430, 0x280, 0x800, 0x800, 0x2490, 0x290, 0x800, 0x800, 0x1d20, 0x2a0, 0x800, 0x800, 0x1d80, 0x2b0, 0x800, 0x800
.long 0x1de0, 0x2c0, 0x2660, 0x2c60, 0x1e40, 0x2d0, 0x26c0, 0x800, 0x1ea0, 0x2e0, 0x2720, 0x800, 0x1f00, 0x2f0, 0x2780, 0x800
.long 0x1f60, 0x300, 0x800, 0x800, 0x1fc0, 0x310, 0x800, 0x800, 0x2020, 0x320, 0x800, 0x800, 0x2080, 0x330, 0x800, 0x800
.long 0x20e0, 0x340, 0x27e0, 0x800, 0x2140, 0x350, 0x2840, 0x800, 0x21a0, 0x360, 0x28a0, 0x800, 0x2200, 0x370, 0x2900, 0x800
.long 0x2260, 0x380, 0x800, 0x800, 0x22c0, 0x390, 0x800, 0x800, 0x2320, 0x3a0, 0x800, 0x800, 0x2380, 0x3b0, 0x800, 0x800
.long 0x23e0, 0x3c0, 0x2960, 0x800, 0x2440, 0x3d0, 0x29c0, 0x800, 0x24a0, 0x3e0, 0x2a20, 0x800, 0x1d30, 0x3f0, 0x2a80, 0x800
.long 0x1d90, 0x400, 0x1d00, 0x2300, 0x1df0, 0x410, 0x1d60, 0x2360, 0x1e50, 0x420, 0x1dc0, 0x23c0, 0x1eb0, 0x430, 0x1e20, 0x2420
.long 0x1f10, 0x440, 0x800, 0x800, 0x1f70, 0x450, 0x800, 0x800, 0x1fd0, 0x460, 0x800, 0x800, 0x2030, 0x470, 0x800, 0x800
.long 0x2090, 0x480, 0x1e80, 0x2480, 0x20f0, 0x490, 0x1ee0, 0x800, 0x2150, 0x4a0, 0x1f40, 0x800, 0x21b0, 0x4b0, 0x1fa0, 0x800
.long 0x2210, 0x4c0, 0x800, 0x800, 0x2270, 0x4d0, 0x800, 0x800, 0x22d0, 0x4e0, 0x800, 0x800, 0x2330, 0x4f0, 0x800, 0x800
.long 0x2390, 0x500, 0x2000, 0x800, 0x23f0, 0x510, 0x2060, 0x800, 0x2450, 0x520, 0x20c0, 0x800, 0x24b0, 0x530, 0x2120, 0x800
.long 0x1d40, 0x540, 0x800, 0x800, 0x1da0, 0x550, 0x800, 0x800, 0x1e00, 0x560, 0x800, 0x800, 0x1e60, 0x570, 0x800, 0x800
.long 0x1ec0, 0x580, 0x2180, 0x800, 0x1f20, 0x590, 0x21e0, 0x800, 0x1f80, 0x5a0, 0x2240, 0x800, 0x1fe0, 0x5b0, 0x22a0, 0x800
.long 0x2040, 0x5c0, 0x800, 0x800, 0x20a0, 0x5d0, 0x800, 0x800, 0x2100, 0x5e0, 0x800, 0x800, 0x2160, 0x5f0, 0x800, 0x800
.long 0x21c0, 0x600, 0x800, 0x800, 0x2220, 0x610, 0x800, 0x800, 0x2280, 0x620, 0x800, 0x800, 0x22e0, 0x630, 0x800, 0x800
.long 0x2340, 0x640, 0x24e0, 0x2ae0, 0x23a0, 0x650, 0x2540, 0x2b40, 0x2400, 0x660, 0x25a0, 0x2ba0, 0x2460, 0x670, 0x2600, 0x2c00
.long 0x24c0, 0x680, 0x800, 0x800, 0x1d50, 0x690, 0x800, 0x800, 0x1db0, 0x6a0, 0x800, 0x800, 0x1e10, 0x6b0, 0x800, 0x800
.long 0x1e70, 0x6c0, 0x2660, 0x2c60, 0x1ed0, 0x6d0, 0x26c0, 0x800, 0x1f30, 0x6e0, 0x2720, 0x800, 0x1f90, 0x6f0, 0x2780, 0x800
.long 0x1ff0, 0x700, 0x800, 0x800, 0x2050, 0x710, 0x800, 0x800, 0x20b0, 0x720, 0x800, 0x800, 0x2110, 0x730, 0x800, 0x800
.long 0x2170, 0x740, 0x27e0, 0x800, 0x21d0, 0x750, 0x2840, 0x800, 0x2230, 0x760, 0x28a0, 0x800, 0x2290, 0x770, 0x2900, 0x800
.long 0x22f0, 0x780, 0x800, 0x800, 0x2350, 0x790, 0x800, 0x800, 0x23b0, 0x7a0, 0x800, 0x800, 0x2410, 0x7b0, 0x800, 0x800
.long 0x2470, 0x7c0, 0x2960, 0x800, 0x24d0, 0x7d0, 0x29c0, 0x800, 0x24e0, 0x7e0, 0x2a20, 0x800, 0x2540, 0x7f0, 0x2a80, 0x800
.long 0x25a0, 0x800, 0x1d00, 0x2300, 0x2600, 0x810, 0x1d60, 0x2360, 0x2660, 0x820, 0x1dc0, 0x23c0, 0x26c0, 0x830, 0x1e20, 0x2420
.long 0x2720, 0x840, 0x800, 0x800, 0x2780, 0x850, 0x800, 0x800, 0x27e0, 0x860, 0x800, 0x800, 0x2840, 0x870, 0x800, 0x800
.long 0x28a0, 0x880, 0x1e80, 0x2480, 0x2900, 0x890, 0x1ee0, 0x800, 0x2960, 0x8a0, 0x1f40, 0x800, 0x29c0, 0x8b0, 0x1fa0, 0x800
.long 0x2a20, 0x8c0, 0x800, 0x800, 0x2a80, 0x8d0, 0x800, 0x800, 0x2ae0, 0x8e0, 0x800, 0x800, 0x2b40, 0x8f0, 0x800, 0x800
.long 0x2ba0, 0x900, 0x2000, 0x800, 0x2c00, 0x910, 0x2060, 0x800, 0x2c60, 0x920, 0x20c0, 0x800, 0x24f0, 0x930, 0x2120, 0x800
.long 0x2550, 0x940, 0x800, 0x800, 0x25b0, 0x950, 0x800, 0x800, 0x2610, 0x960, 0x800, 0x800, 0x2670, 0x970, 0x800, 0x800
.long 0x26d0, 0x980, 0x2180, 0x800, 0x2730, 0x990, 0x21e0, 0x800, 0x2790, 0x9a0, 0x2240, 0x800, 0x27f0, 0x9b0, 0x22a0, 0x800
.long 0x2850, 0x9c0, 0x800, 0x800, 0x28b0, 0x9d0, 0x800, 0x800, 0x2910, 0x9e0, 0x800, 0x800, 0x2970, 0x9f0, 0x800, 0x800
.long 0x29d0, 0xa00, 0x800, 0x800, 0x2a30, 0xa10, 0x800, 0x800, 0x2a90, 0xa20, 0x800, 0x800, 0x2af0, 0xa30, 0x800, 0x800
.long 0x2b50, 0xa40, 0x24e0, 0x2ae0, 0x2bb0, 0xa50, 0x2540, 0x2b40, 0x2c10, 0xa60, 0x25a0, 0x2ba0, 0x2c70, 0xa70, 0x2600, 0x2c00
.long 0x2500, 0xa80, 0x800, 0x800, 0x2560, 0xa90, 0x800, 0x800, 0x25c0, 0xaa0, 0x800, 0x800, 0x2620, 0xab0, 0x800, 0x800
.long 0x2680, 0xac0, 0x2660, 0x2c60, 0x26e0, 0xad0, 0x26c0, 0x800, 0x2740, 0xae0, 0x2720, 0x800, 0x27a0, 0xaf0, 0x2780, 0x800
.long 0x2800, 0xb00, 0x800, 0x800, 0x2860, 0xb10, 0x800, 0x800, 0x28c0, 0xb20, 0x800, 0x800, 0x2920, 0xb30, 0x800, 0x800
.long 0x2980, 0xb40, 0x27e0, 0x800, 0x29e0, 0xb50, 0x2840, 0x800, 0x2a40, 0xb60, 0x28a0, 0x800, 0x2aa0, 0xb70, 0x2900, 0x800
.long 0x2b00, 0xb80, 0x800, 0x800, 0x2b60, 0xb90, 0x800, 0x800, 0x2bc0, 0xba0, 0x800, 0x800, 0x2c20, 0xbb0, 0x800, 0x800
.long 0x2c80, 0xbc0, 0x2960, 0x800, 0x2510, 0xbd0, 0x29c0, 0x800, 0x2570, 0xbe0, 0x2a20, 0x800, 0x25d0, 0xbf0, 0x2a80, 0x800
.long 0x2630, 0xc00, 0x1d00, 0x2300, 0x2690, 0xc10, 0x1d60, 0x2360, 0x26f0, 0xc20, 0x1dc0, 0x23c0, 0x2750, 0xc30, 0x1e20, 0x2420
.long 0x27b0, 0xc40, 0x800, 0x800, 0x2810, 0xc50, 0x800, 0x800, 0x2870, 0xc60, 0x800, 0x800, 0x28d0, 0xc70, 0x800, 0x800
.long 0x2930, 0xc80, 0x1e80, 0x2480, 0x2990, 0xc90, 0x1ee0, 0x800, 0x29f0, 0xca0, 0x1f40, 0x800, 0x2a50, 0xcb0, 0x1fa0, 0x800
.long 0x2ab0, 0xcc0, 0x800, 0x800, 0x2b10, 0xcd0, 0x800, 0x800, 0x2b70, 0xce0, 0x800, 0x800, 0x2bd0, 0xcf0, 0x800, 0x800
.long 0x2c30, 0xd00, 0x2000, 0x800, 0x2c90, 0xd10, 0x2060, 0x800, 0x2520, 0xd20, 0x20c0, 0x800, 0x2580, 0xd30, 0x2120, 0x800
.long 0x25e0, 0xd40, 0x800, 0x800, 0x2640, 0xd50, 0x800, 0x800, 0x26a0, 0xd60, 0x800, 0x800, 0x2700, 0xd70, 0x800, 0x800
.long 0x2760, 0xd80, 0x2180, 0x800, 0x27c0, 0xd90, 0x21e0, 0x800, 0x2820, 0xda0, 0x2240, 0x800, 0x2880, 0xdb0, 0x22a0, 0x800
.long 0x28e0, 0xdc0, 0x800, 0x800, 0x2940, 0xdd0, 0x800, 0x800, 0x29a0, 0xde0, 0x800, 0x800, 0x2a00, 0xdf0, 0x800, 0x800
.long 0x2a60, 0xe00, 0x800, 0x800, 0x2ac0, 0xe10, 0x800, 0x800, 0x2b20, 0xe20, 0x800, 0x800, 0x2b80, 0xe30, 0x800, 0x800
.long 0x2be0, 0xe40, 0x24e0, 0x2ae0, 0x2c40, 0xe50, 0x2540, 0x2b40, 0x2ca0, 0xe60, 0x25a0, 0x2ba0, 0x2530, 0xe70, 0x2600, 0x2c00
.long 0x2590, 0xe80, 0x800, 0x800, 0x25f0, 0xe90, 0x800, 0x800, 0x2650, 0xea0, 0x800, 0x800, 0x26b0, 0xeb0, 0x800, 0x800
.long 0x2710, 0xec0, 0x2660, 0x2c60, 0x2770, 0xed0, 0x26c0, 0x800, 0x27d0, 0xee0, 0x2720, 0x800, 0x2830, 0xef0, 0x2780, 0x800
.long 0x2890, 0xf00, 0x800, 0x800, 0x28f0, 0xf10, 0x800, 0x800, 0x2950, 0xf20, 0x800, 0x800, 0x29b0, 0xf30, 0x800, 0x800
.long 0x2a10, 0xf40, 0x27e0, 0x800, 0x2a70, 0xf50, 0x2840, 0x800, 0x2ad0, 0xf60, 0x28a0, 0x800, 0x2b30, 0xf70, 0x2900, 0x800
.long 0x2b90, 0xf80, 0x800, 0x800, 0x2bf0, 0xf90, 0x800, 0x800, 0x2c50, 0xfa0, 0x800, 0x800, 0x2cb0, 0xfb0, 0x800, 0x800
.long 0x1100, 0x40000000, 0x2960, 0x800, 0x1100, 0x40000000, 0x29c0, 0x800, 0x1100, 0x40000000, 0x2a20, 0x800, 0x1100, 0x40000000, 0x2a80, 0x800
.long 0x0, 0x20, 0x0, 0x0, 0x800, 0x800, 0x0, 0x10, 0x8, 0x800, 0x0, 0x20, 0x800, 0x800, 0x0, 0x30
.long 0x28, 0x48, 0x0, 0x4000, 0x800, 0x800, 0x0, 0x4010, 0x30, 0x800, 0x0, 0x4020, 0x800, 0x800, 0x0, 0x4030
.long 0x50, 0x70, 0x0, 0x8000, 0x800, 0x800, 0x0, 0x8010, 0x58, 0x800, 0x0, 0x8020, 0x800, 0x800, 0x0, 0x8030
.long 0x78, 0x98, 0x0, 0xc000, 0x800, 0x800, 0x0, 0xc010, 0x80, 0x800, 0x0, 0xc020, 0x800, 0x800, 0x0, 0xc030
.long 0x10, 0x800, 0x0, 0x1000, 0x800, 0x800, 0x0, 0x1010, 0x18, 0x800, 0x0, 0x1020, 0x800, 0x800, 0x0, 0x1030
.long 0x38, 0x800, 0x0, 0x5000, 0x800, 0x800, 0x0, 0x5010, 0x40, 0x800, 0x0, 0x5020, 0x800, 0x800, 0x0, 0x5030
.long 0x60, 0x800, 0x0, 0x9000, 0x800, 0x800, 0x0, 0x9010, 0x68, 0x800, 0x0, 0x9020, 0x800, 0x800, 0x0, 0x9030
.long 0x88, 0x800, 0x0, 0xd000, 0x800, 0x800, 0x0, 0xd010, 0x90, 0x800, 0x0, 0xd020, 0x800, 0x800, 0x0, 0xd030
.long 0x800, 0x800, 0x0, 0x2000, 0x320, 0x340, 0x0, 0x2010, 0x800, 0x800, 0x0, 0x2020, 0x328, 0x800, 0x0, 0x2030
.long 0x800, 0x800, 0x0, 0x6000, 0x348, 0x368, 0x0, 0x6010, 0x800, 0x800, 0x0, 0x6020, 0x350, 0x800, 0x0, 0x6030
.long 0x800, 0x800, 0x0, 0xa000, 0x370, 0x390, 0x0, 0xa010, 0x800, 0x800, 0x0, 0xa020, 0x378, 0x800, 0x0, 0xa030
.long 0x800, 0x800, 0x0, 0xe000, 0x398, 0x3b8, 0x0, 0xe010, 0x800, 0x800, 0x0, 0xe020, 0x3a0, 0x800, 0x0, 0xe030
.long 0x800, 0x800, 0x0, 0x3000, 0x330, 0x800, 0x0, 0x3010, 0x800, 0x800, 0x0, 0x3020, 0x338, 0x800, 0x0, 0x3030
.long 0x800, 0x800, 0x0, 0x7000, 0x358, 0x800, 0x0, 0x7010, 0x800, 0x800, 0x0, 0x7020, 0x360, 0x800, 0x0, 0x7030
.long 0x800, 0x800, 0x0, 0xb000, 0x380, 0x800, 0x0, 0xb010, 0x800, 0x800, 0x0, 0xb020, 0x388, 0x800, 0x0, 0xb030
.long 0x800, 0x800, 0x0, 0xf000, 0x3a8, 0x800, 0x0, 0xf010, 0x800, 0x800, 0x0, 0xf020, 0x3b0, 0x800, 0x0, 0xf030
.long 0x0, 0x20, 0x0, 0x40, 0x800, 0x800, 0x0, 0x50, 0x8, 0x800, 0x0, 0x60, 0x800, 0x800, 0x0, 0x70
.long 0x28, 0x48, 0x0, 0x4040, 0x800, 0x800, 0x0, 0x4050, 0x30, 0x800, 0x0, 0x4060, 0x800, 0x800, 0x0, 0x4070
.long 0x50, 0x70, 0x0, 0x8040, 0x800, 0x800, 0x0, 0x8050, 0x58, 0x800, 0x0, 0x8060, 0x800, 0x800, 0x0, 0x8070
.long 0x78, 0x98, 0x0, 0xc040, 0x800, 0x800, 0x0, 0xc050, 0x80, 0x800, 0x0, 0xc060, 0x800, 0x800, 0x0, 0xc070
.long 0x10, 0x800, 0x0, 0x1040, 0x800, 0x800, 0x0, 0x1050, 0x18, 0x800, 0x0, 0x1060, 0x800, 0x800, 0x0, 0x1070
.long 0x38, 0x800, 0x0, 0x5040, 0x800, 0x800, 0x0, 0x5050, 0x40, 0x800, 0x0, 0x5060, 0x800, 0x800, 0x0, 0x5070
.long 0x60, 0x800, 0x0, 0x9040, 0x800, 0x800, 0x0, 0x9050, 0x68, 0x800, 0x0, 0x9060, 0x800, 0x800, 0x0, 0x9070
.long 0x88, 0x800, 0x0, 0xd040, 0x800, 0x800, 0x0, 0xd050, 0x90, 0x800, 0x0, 0xd060, 0x800, 0x800, 0x0, 0xd070
.long 0x800, 0x800, 0x0, 0x2040, 0x320, 0x340, 0x0, 0x2050, 0x800, 0x800, 0x0, 0x2060, 0x328, 0x800, 0x0, 0x2070
.long 0x800, 0x800, 0x0, 0x6040, 0x348, 0x368, 0x0, 0x6050, 0x800, 0x800, 0x0, 0x6060, 0x350, 0x800, 0x0, 0x6070
.long 0x800, 0x800, 0x0, 0xa040, 0x370, 0x390, 0x0, 0xa050, 0x800, 0x800, 0x0, 0xa060, 0x378, 0x800, 0x0, 0xa070
.long 0x800, 0x800, 0x0, 0xe040, 0x398, 0x3b8, 0x0, 0xe050, 0x800, 0x800, 0x0, 0xe060, 0x3a0, 0x800, 0x0, 0xe070
.long 0x800, 0x800, 0x0, 0x3040, 0x330, 0x800, 0x0, 0x3050, 0x800, 0x800, 0x0, 0x3060, 0x338, 0x800, 0x0, 0x3070
.long 0x800, 0x800, 0x0, 0x7040, 0x358, 0x800, 0x0, 0x7050, 0x800, 0x800, 0x0, 0x7060, 0x360, 0x800, 0x0, 0x7070
.long 0x800, 0x800, 0x0, 0xb040, 0x380, 0x800, 0x0, 0xb050, 0x800, 0x800, 0x0, 0xb060, 0x388, 0x800, 0x0, 0xb070
.long 0x800, 0x800, 0x0, 0xf040, 0x3a8, 0x800, 0x0, 0xf050, 0x800, 0x800, 0x0, 0xf060, 0x3b0, 0x800, 0x0, 0xf070
.long 0x0, 0x20, 0x0, 0x80, 0x800, 0x800, 0x0, 0x90, 0x8, 0x800, 0x0, 0xa0, 0x800, 0x800, 0x0, 0xb0
.long 0x28, 0x48, 0x0, 0x4080, 0x800, 0x800, 0x0, 0x4090, 0x30, 0x800, 0x0, 0x40a0, 0x800, 0x800, 0x0, 0x40b0
.long 0x50, 0x70, 0x0, 0x8080, 0x800, 0x800, 0x0, 0x8090, 0x58, 0x800, 0x0, 0x80a0, 0x800, 0x800, 0x0, 0x80b0
.long 0x78, 0x98, 0x0, 0xc080, 0x800, 0x800, 0x0, 0xc090, 0x80, 0x800, 0x0, 0xc0a0, 0x800, 0x800, 0x0, 0xc0b0
.long 0x10, 0x800, 0x0, 0x1080, 0x800, 0x800, 0x0, 0x1090, 0x18, 0x800, 0x0, 0x10a0, 0x800, 0x800, 0x0, 0x10b0
.long 0x38, 0x800, 0x0, 0x5080, 0x800, 0x800, 0x0, 0x5090, 0x40, 0x800, 0x0, 0x50a0, 0x800, 0x800, 0x0, 0x50b0
.long 0x60, 0x800, 0x0, 0x9080, 0x800, 0x800, 0x0, 0x9090, 0x68, 0x800, 0x0, 0x90a0, 0x800, 0x800, 0x0, 0x90b0
.long 0x88, 0x800, 0x0, 0xd080, 0x800, 0x800, 0x0, 0xd090, 0x90, 0x800, 0x0, 0xd0a0, 0x800, 0x800, 0x0, 0xd0b0
.long 0x800, 0x800, 0x0, 0x2080, 0x320, 0x340, 0x0, 0x2090, 0x800, 0x800, 0x0, 0x20a0, 0x328, 0x800, 0x0, 0x20b0
.long 0x800, 0x800, 0x0, 0x6080, 0x348, 0x368, 0x0, 0x6090, 0x800, 0x800, 0x0, 0x60a0, 0x350, 0x800, 0x0, 0x60b0
.long 0x800, 0x800, 0x0, 0xa080, 0x370, 0x390, 0x0, 0xa090, 0x800, 0x800, 0x0, 0xa0a0, 0x378, 0x800, 0x0, 0xa0b0
.long 0x800, 0x800, 0x0, 0xe080, 0x398, 0x3b8, 0x0, 0xe090, 0x800, 0x800, 0x0, 0xe0a0, 0x3a0, 0x800, 0x0, 0xe0b0
.long 0x800, 0x800, 0x0, 0x3080, 0x330, 0x800, 0x0, 0x3090, 0x800, 0x800, 0x0, 0x30a0, 0x338, 0x800, 0x0, 0x30b0
.long 0x800, 0x800, 0x0, 0x7080, 0x358, 0x800, 0x0, 0x7090, 0x800, 0x800, 0x0, 0x70a0, 0x360, 0x800, 0x0, 0x70b0
.long 0x800, 0x800, 0x0, 0xb080, 0x380, 0x800, 0x0, 0xb090, 0x800, 0x800, 0x0, 0xb0a0, 0x388, 0x800, 0x0, 0xb0b0
.long 0x800, 0x800, 0x0, 0xf080, 0x3a8, 0x800, 0x0, 0xf090, 0x800, 0x800, 0x0, 0xf0a0, 0x3b0, 0x800, 0x0, 0xf0b0
.long 0x0, 0x20, 0x0, 0xc0, 0x800, 0x800, 0x0, 0xd0, 0x8, 0x800, 0x0, 0xe0, 0x800, 0x800, 0x0, 0xf0
.long 0x28, 0x48, 0x0, 0x40c0, 0x800, 0x800, 0x0, 0x40d0, 0x30, 0x800, 0x0, 0x40e0, 0x800, 0x800, 0x0, 0x40f0
.long 0x50, 0x70, 0x0, 0x80c0, 0x800, 0x800, 0x0, 0x80d0, 0x58, 0x800, 0x0, 0x80e0, 0x800, 0x800, 0x0, 0x80f0
.long 0x78, 0x98, 0x0, 0xc0c0, 0x800, 0x800, 0x0, 0xc0d0, 0x80, 0x800, 0x0, 0xc0e0, 0x800, 0x800, 0x0, 0xc0f0
.long 0x10, 0x800, 0x0, 0x10c0, 0x800, 0x800, 0x0, 0x10d0, 0x18, 0x800, 0x0, 0x10e0, 0x800, 0x800, 0x0, 0x10f0
.long 0x38, 0x800, 0x0, 0x50c0, 0x800, 0x800, 0x0, 0x50d0, 0x40, 0x800, 0x0, 0x50e0, 0x800, 0x800, 0x0, 0x50f0
.long 0x60, 0x800, 0x0, 0x90c0, 0x800, 0x800, 0x0, 0x90d0, 0x68, 0x800, 0x0, 0x90e0, 0x800, 0x800, 0x0, 0x90f0
.long 0x88, 0x800, 0x0, 0xd0c0, 0x800, 0x800, 0x0, 0xd0d0, 0x90, 0x800, 0x0, 0xd0e0, 0x800, 0x800, 0x0, 0xd0f0
.long 0x800, 0x800, 0x0, 0x20c0, 0x320, 0x340, 0x0, 0x20d0, 0x800, 0x800, 0x0, 0x20e0, 0x328, 0x800, 0x0, 0x20f0
.long 0x800, 0x800, 0x0, 0x60c0, 0x348, 0x368, 0x0, 0x60d0, 0x800, 0x800, 0x0, 0x60e0, 0x350, 0x800, 0x0, 0x60f0
.long 0x800, 0x800, 0x0, 0xa0c0, 0x370, 0x390, 0x0, 0xa0d0, 0x800, 0x800, 0x0, 0xa0e0, 0x378, 0x800, 0x0, 0xa0f0
.long 0x800, 0x800, 0x0, 0xe0c0, 0x398, 0x3b8, 0x0, 0xe0d0, 0x800, 0x800, 0x0, 0xe0e0, 0x3a0, 0x800, 0x0, 0xe0f0
.long 0x800, 0x800, 0x0, 0x30c0, 0x330, 0x800, 0x0, 0x30d0, 0x800, 0x800, 0x0, 0x30e0, 0x338, 0x800, 0x0, 0x30f0
.long 0x800, 0x800, 0x0, 0x70c0, 0x358, 0x800, 0x0, 0x70d0, 0x800, 0x800, 0x0, 0x70e0, 0x360, 0x800, 0x0, 0x70f0
.long 0x800, 0x800, 0x0, 0xb0c0, 0x380, 0x800, 0x0, 0xb0d0, 0x800, 0x800, 0x0, 0xb0e0, 0x388, 0x800, 0x0, 0xb0f0
.long 0x800, 0x800, 0x0, 0xf0c0, 0x3a8, 0x800, 0x0, 0xf0d0, 0x800, 0x800, 0x0, 0xf0e0, 0x3b0, 0x800, 0x0, 0xf0f0
M_tblend:
.size M_tbl, 28672
.section .rodata,"a"
.p2align 6
.amdhsa_kernel parallel_sum__linear_kernel_hedgehog__glu_gated_swiglu__prompt_kernel
  .amdhsa_next_free_vgpr 512
  .amdhsa_next_free_sgpr 102
  .amdhsa_accum_offset 256
  .amdhsa_group_segment_fixed_size 0
  .amdhsa_kernarg_size 88
  .amdhsa_user_sgpr_count 2
  .amdhsa_user_sgpr_kernarg_segment_ptr 1
  .amdhsa_system_sgpr_workgroup_id_x 1
  .amdhsa_float_denorm_mode_32 3
.end_amdhsa_kernel
```
